```python
import torch

def _softmax(x, axis=-1):
    return torch.softmax(x, dim=axis)
def _gelu(x):
    return torch.nn.functional.gelu(x, approximate="tanh")
def _silu(x):
    return torch.nn.functional.silu(x)
def _sigmoid(x):
    return torch.sigmoid(x)
def _layernorm(x, axis=-1, eps=1e-5):
    m = x.mean(dim=axis, keepdim=True)
    v = x.var(dim=axis, keepdim=True, unbiased=False)
    return (x - m) / torch.sqrt(v + eps)
def _scatter_add(tgt, idx, src, axis=0):
    return tgt.clone().index_add_(axis, idx, src)
def _segment_sum(src, seg, n):
    out = torch.zeros((n,) + src.shape[1:], dtype=src.dtype)
    return out.index_add_(0, seg, src)
def _pad(x, pw):
    flat = tuple(v for pair in reversed(pw) for v in pair)
    return torch.nn.functional.pad(x, flat)

kernel_name = 'gated_mix__compressed_kv_cla__linear_kernel_hedgehog__prompt'

def setup_inputs():

    _w = (lambda a: (lambda t: t.to(torch.bfloat16) if t.is_floating_point() else t)(torch.as_tensor(a)))
    def _A_setup():
        B, H, Sq, Sk, D, M = 1, 32, 2048, 2048, 128, 512
        Dc = 4 * D
        return {
            "x": _w((lambda *s: torch.randn(*s, dtype=torch.bfloat16) * 0.05)(B, Sq, M)),
            "c_kv": _w((lambda *s: torch.randn(*s, dtype=torch.bfloat16) * 0.8)(B, Sk, Dc)),
            "w_q": _w((lambda *s: torch.randn(*s, dtype=torch.bfloat16) * 6.4)(M, H, D) * (M ** -0.5)),
            "w_uk": _w((lambda *s: torch.randn(*s, dtype=torch.bfloat16) * 6.4)(Dc, H, D) * (Dc ** -0.5)),
            "w_uv": _w((lambda *s: torch.randn(*s, dtype=torch.bfloat16) * 0.8)(Dc, H, D) * (Dc ** -0.5)),
            "w_o": _w((lambda *s: torch.randn(*s, dtype=torch.bfloat16) * 0.8)(H, D, M) * ((H * D) ** -0.5)),
        }
    _A_in = _A_setup()

    def _B_setup():
        B, S, D, H = 1, 2048, 512, 32
        Dh = D // H
        return {
            "x": _w((lambda *s: torch.randn(*s, dtype=torch.bfloat16) * 0.05)(B, S, D)),
            "wqkv": _w((lambda *s: torch.randn(*s, dtype=torch.bfloat16) * 1.6)(D, 3 * D)),
            "w_phi": _w((lambda *s: torch.randn(*s, dtype=torch.bfloat16) * 1.6)(H, Dh, Dh) * (Dh ** -0.5)),
            "wo": _w((lambda *s: torch.randn(*s, dtype=torch.bfloat16) * 0.05)(D, D)),
        }
    _B_in = _B_setup()

    return {
        "A_x": _A_in["x"],
        "A_c_kv": _A_in["c_kv"],
        "A_w_q": _A_in["w_q"],
        "A_w_uk": _A_in["w_uk"],
        "A_w_uv": _A_in["w_uv"],
        "A_w_o": _A_in["w_o"],
        "B_x": _B_in["x"],
        "B_wqkv": _B_in["wqkv"],
        "B_w_phi": _B_in["w_phi"],
        "B_wo": _B_in["wo"],
        "gate_w": _w((lambda *s: torch.randn(*s, dtype=torch.bfloat16) * 0.05)(512) * 16.0),
    }

def reference(A_x, A_c_kv, A_w_q, A_w_uk, A_w_uv, A_w_o, B_x, B_wqkv, B_w_phi, B_wo, gate_w):
    def _A_ref(x, c_kv, w_q, w_uk, w_uv, w_o):
        B, Sq, M = x.shape[0], x.shape[1], x.shape[2]
        Sk = c_kv.shape[1]
        H, D = w_q.shape[1], w_q.shape[2]
        q = torch.einsum("bqm,mhd->bhqd", x, w_q)
        k = torch.einsum("bkc,chd->bhkd", c_kv, w_uk)
        v = torch.einsum("bkc,chd->bhkd", c_kv, w_uv)
        scores = torch.einsum("bhqd,bhkd->bhqk", q, k) * (D ** -0.5)
        off = Sk - Sq
        qi = torch.arange(Sq)[:, None]
        kj = torch.arange(Sk)[None, :]
        cmask = kj <= (qi + off)
        scores = torch.where(cmask[None, None], scores, -1e9)
        p = _softmax(scores, axis=-1)
        ctx = torch.einsum("bhqk,bhkd->bhqd", p, v)
        return torch.einsum("bhqd,hdm->bqm", ctx, w_o)

    def _B_ref(x, wqkv, w_phi, wo):
        B, S, D = x.shape
        H = 32; Dh = D // H
        qkv = (lambda x, *d: x.permute(*d))((x @ wqkv).reshape(B, S, 3, H, Dh), 2, 0, 3, 1, 4)
        q, k, v = qkv[0], qkv[1], qkv[2]
        pq = torch.einsum("bhsd,hdf->bhsf", q, w_phi)
        pk = torch.einsum("bhsd,hdf->bhsf", k, w_phi)
        phi_q = torch.concatenate([_softmax(pq, axis=-1), _softmax(-pq, axis=-1)], axis=-1)
        phi_k = torch.concatenate([_softmax(pk, axis=-1), _softmax(-pk, axis=-1)], axis=-1)
        kv = torch.einsum("bhsf,bhsd->bhfd", phi_k, v)
        z  = torch.einsum("bhsf->bhf", phi_k)
        num = torch.einsum("bhqf,bhfd->bhqd", phi_q, kv)
        den = torch.einsum("bhqf,bhf->bhq", phi_q, z)[..., None] + 1e-6
        o = num / den
        return (lambda x, *d: x.permute(*d))(o, 0, 2, 1, 3).reshape(B, S, D) @ wo

    x = A_x
    g = _sigmoid((x * gate_w).sum(-1, keepdims=True))
    a = _A_ref(x, A_c_kv, A_w_q, A_w_uk, A_w_uv, A_w_o)
    b = _B_ref(x, B_wqkv, B_w_phi, B_wo)
    return g * a + (1 - g) * b
```

```asm
; @launch kernel=proj_kernel grid=(256,1,1) block=(512,1,1) lds=163840
; @launch kernel=attn_kernel grid=(256,1,1) block=(512,1,1) lds=163840
; @launch kernel=oproj_kernel grid=(256,1,1) block=(256,1,1) lds=163840
.amdgcn_target "amdgcn-amd-amdhsa--gfx950"
.text
.globl proj_kernel
.p2align 8
.type proj_kernel,@function
proj_kernel:
    s_cmp_ge_u32 s2, 256
    s_cbranch_scc1 L_k1_end
    s_load_dwordx8 s[4:11], s[0:1], 8
    s_load_dwordx2 s[20:21], s[0:1], 104
    s_load_dwordx2 s[64:65], s[0:1], 0
    s_load_dwordx2 s[66:67], s[0:1], 16
    s_load_dwordx2 s[68:69], s[0:1], 56
    s_load_dwordx2 s[76:77], s[0:1], 64
    s_load_dwordx2 s[80:81], s[0:1], 80
    s_and_b32 s40, s2, 7
    s_lshl_b32 s40, s40, 2
    s_bfe_u32 s3, s2, 0x20003
    s_add_u32 s40, s40, s3
    s_lshr_b32 s41, s2, 5
    v_lshrrev_b32 v1, 6, v0
    s_nop 0
    v_readfirstlane_b32 s42, v1
    v_and_b32 v2, 63, v0
    s_lshr_b32 s45, s40, 4
    s_and_b32 s44, s40, 15
    s_lshl_b32 s44, s44, 9
    s_lshr_b32 s48, s42, 2
    s_and_b32 s49, s42, 3
    s_lshl_b32 s46, s42, 5
    s_lshl_b32 s47, s41, 8
    s_add_u32 s46, s46, s47
    s_lshl_b32 s47, s48, 7
    s_waitcnt lgkmcnt(0)
    s_mov_b32 s24, s4
    s_mov_b32 s25, s5
    s_mov_b32 s26, 0x200000
    s_mov_b32 s27, 0x00020000
    s_cmp_eq_u32 s45, 0
    s_cselect_b32 s28, s8, s10
    s_cselect_b32 s29, s9, s11
    s_mov_b32 s30, 0x400000
    s_mov_b32 s31, 0x00020000
    s_mov_b32 s32, s20
    s_mov_b32 s33, s21
    s_mov_b32 s34, 0x10000000
    s_mov_b32 s35, 0x00020000
    s_mov_b32 s52, 262144

    v_lshrrev_b32 v3, 3, v2
    v_add_u32 v3, s46, v3
    v_lshrrev_b32 v4, 4, v2
    v_and_b32 v5, 7, v2
    v_xor_b32 v5, v5, v4
    v_xor_b32 v6, 4, v5
    v_lshlrev_b32 v5, 4, v5
    v_lshlrev_b32 v6, 4, v6

    v_add_u32 v7, 0, v3
    v_lshl_add_u32 v8, v7, 10, v5
    v_add_u32 v7, 8, v3
    v_lshl_add_u32 v9, v7, 10, v6
    v_add_u32 v7, 16, v3
    v_lshl_add_u32 v10, v7, 10, v5
    v_add_u32 v7, 24, v3
    v_lshl_add_u32 v11, v7, 10, v6
    v_and_b32 v3, 31, v2
    v_lshrrev_b32 v4, 5, v2
    v_add_u32 v5, s47, v3
    v_bfe_u32 v6, v3, 1, 3
    v_xor_b32 v6, v6, v4
    v_lshlrev_b32 v6, 4, v6
    v_lshl_add_u32 v16, v5, 7, v6

    v_xor_b32 v17, 32, v16
    v_xor_b32 v18, 64, v16
    v_xor_b32 v19, 96, v16
    v_add_u32 v20, 65536, v16
    v_add_u32 v21, 65536, v17
    v_add_u32 v22, 65536, v18
    v_add_u32 v23, 65536, v19
    v_bfe_u32 v3, v2, 2, 2
    v_lshl_add_u32 v4, v4, 3, v3
    v_lshlrev_b32 v4, 8, v4
    v_and_b32 v5, 3, v2
    v_lshlrev_b32 v5, 3, v5
    v_bfe_u32 v6, v2, 4, 1
    v_lshl_add_u32 v5, v6, 5, v5
    v_add_u32 v4, v4, v5
    v_add_u32 v4, 98304, v4
    s_bfe_u32 s50, s2, 0x20003
    s_lshl_b32 s50, s50, 1
    s_lshr_b32 s51, s2, 5
    s_add_u32 s50, s50, s51
    s_and_b32 s50, s50, 7
    s_lshl_b32 s51, s52, 1
    s_mul_i32 s51, s51, s50
    s_lshl_b32 s50, s50, 7
    s_lshl_b32 s55, s52, 4
    s_lshl_b32 s53, s42, 12
    s_lshl_b32 s54, s42, 11

    s_lshr_b32 s46, s49, 1
    s_lshl_b32 s46, s46, 13
    v_add_u32 v4, s46, v4
    s_and_b32 s46, s49, 1
    s_lshl_b32 s46, s46, 1

    s_add_u32 s47, s46, 0
    v_xor_b32 v5, s47, v3
    v_lshl_add_u32 v24, v5, 6, v4
    s_add_u32 s47, s46, 1
    v_xor_b32 v5, s47, v3
    v_lshl_add_u32 v25, v5, 6, v4
    v_lshrrev_b32 v4, 4, v2
    v_and_b32 v5, 15, v2
    v_lshlrev_b32 v6, 2, v4
    v_xor_b32 v5, v5, v6
    v_lshlrev_b32 v5, 4, v5
    s_lshl_b32 s46, s48, 8
    s_add_u32 s46, s46, s44
    v_add_u32 v5, s46, v5
    s_lshl_b32 s46, s49, 3
    v_add_u32 v4, s46, v4

    v_add_u32 v6, 0, v4
    v_lshl_add_u32 v12, v6, 13, v5
    v_add_u32 v6, 4, v4
    v_lshl_add_u32 v13, v6, 13, v5
    s_lshl_b32 s70, s2, 3
    s_add_u32 s70, s70, s42
    s_cmp_ge_u32 s70, 1920
    s_cbranch_scc1 L_pf_1
    s_sub_u32 s71, s70, 512
    s_mov_b32 s74, 0x400000
    s_cmp_lt_u32 s70, 512
    s_cselect_b32 s72, s64, s66
    s_cselect_b32 s73, s65, s67
    s_cselect_b32 s74, 0x200000, s74
    s_cselect_b32 s71, s70, s71
    s_sub_u32 s3, s70, 1536
    s_cmp_ge_u32 s70, 1536
    s_cselect_b32 s72, s68, s72
    s_cselect_b32 s73, s69, s73
    s_cselect_b32 s74, 0x180000, s74
    s_cselect_b32 s71, s3, s71
    s_mov_b32 s75, 0x00020000
    s_lshl_b32 s71, s71, 12
    v_lshlrev_b32 v6, 6, v2
    buffer_load_dword v240, v6, s[72:75], s71 offen
L_pf_1:
    s_cmp_lg_u32 s70, 1920
    s_cbranch_scc1 L_pf_1b
    s_movk_i32 s78, 16384
    s_mov_b32 s79, 0x00020000
    s_movk_i32 s82, 1024
    s_mov_b32 s83, 0x00020000
    v_lshlrev_b32 v6, 7, v2
    s_movk_i32 s3, 8192
    buffer_load_dword v241, v6, s[76:79], 0 offen
    buffer_load_dword v242, v6, s[76:79], s3 offen
    buffer_load_dword v243, v6, s[80:83], 0 offen
L_pf_1b:

    s_cmp_ge_u32 s42, 4
    s_cselect_b64 vcc, -1, 0
    s_add_u32 m0, s53, 0
    s_nop 0
    buffer_load_dwordx4 v8, s[24:27], s50 offen lds
    s_add_u32 m0, s53, 1024
    s_nop 0
    buffer_load_dwordx4 v9, s[24:27], s50 offen lds
    s_add_u32 m0, s53, 2048
    s_nop 0
    buffer_load_dwordx4 v10, s[24:27], s50 offen lds
    s_add_u32 m0, s53, 3072
    s_nop 0
    buffer_load_dwordx4 v11, s[24:27], s50 offen lds
    s_add_u32 s50, s50, 128
    s_and_b32 s50, s50, 1023
    s_add_u32 m0, s54, 98304
    s_nop 0
    buffer_load_dwordx4 v12, s[28:31], s51 offen lds
    s_add_u32 m0, s54, 99328
    s_nop 0
    buffer_load_dwordx4 v13, s[28:31], s51 offen lds
    s_add_u32 s51, s51, s52
    s_cmp_eq_u32 s51, s55
    s_cselect_b32 s51, 0, s51
    s_add_u32 m0, s54, 114688
    s_nop 0
    buffer_load_dwordx4 v12, s[28:31], s51 offen lds
    s_add_u32 m0, s54, 115712
    s_nop 0
    buffer_load_dwordx4 v13, s[28:31], s51 offen lds
    s_add_u32 s51, s51, s52
    s_cmp_eq_u32 s51, s55
    s_cselect_b32 s51, 0, s51
    s_add_u32 m0, s53, 32768
    s_nop 0
    buffer_load_dwordx4 v8, s[24:27], s50 offen lds
    s_add_u32 m0, s53, 33792
    s_nop 0
    buffer_load_dwordx4 v9, s[24:27], s50 offen lds
    s_add_u32 m0, s54, 131072
    s_nop 0
    buffer_load_dwordx4 v12, s[28:31], s51 offen lds
    s_add_u32 m0, s54, 132096
    s_nop 0
    buffer_load_dwordx4 v13, s[28:31], s51 offen lds
    s_add_u32 s51, s51, s52
    s_cmp_eq_u32 s51, s55
    s_cselect_b32 s51, 0, s51
    s_add_u32 m0, s53, 34816
    s_nop 0
    buffer_load_dwordx4 v10, s[24:27], s50 offen lds
    s_add_u32 m0, s53, 35840
    s_nop 0
    buffer_load_dwordx4 v11, s[24:27], s50 offen lds
    s_add_u32 s50, s50, 128
    s_and_b32 s50, s50, 1023
    v_mov_b32 v48, v16
    v_mov_b32 v49, v17
    v_mov_b32 v50, v18
    v_mov_b32 v51, v19
    v_mov_b32 v52, v20
    v_mov_b32 v53, v21
    v_mov_b32 v54, v22
    v_mov_b32 v55, v23
    v_mov_b32 v56, v24
    v_mov_b32 v57, v25
    s_and_b32 s57, s40, 15
    s_lshl_b32 s57, s57, 1
    s_lshr_b32 s46, s49, 1
    s_add_u32 s57, s57, s46
    s_and_b32 s49, s49, 1

    s_cmp_eq_u32 s45, 1
    s_cbranch_scc1 L_k1_vtype

    s_lshl_b32 s46, s57, 19
    s_add_u32 s46, s46, 0x1000000
    s_lshl_b32 s47, s41, 16
    s_add_u32 s46, s46, s47
    s_lshl_b32 s47, s48, 15
    s_add_u32 s46, s46, s47
    s_lshl_b32 s47, s49, 12
    s_add_u32 s46, s46, s47
    v_lshlrev_b32 v5, 4, v2

    s_mov_b32 s90, s46
    v_mov_b32 v14, v5
    v_add_u32 v15, 2048, v5
    s_waitcnt vmcnt(8)
    s_barrier
    ds_read_b64_tr_b16 v[224:225], v56 offset:0
    ds_read_b64_tr_b16 v[226:227], v56 offset:1024
    ds_read_b128 v[192:195], v48 offset:0
    ds_read_b64_tr_b16 v[228:229], v57 offset:0
    ds_read_b64_tr_b16 v[230:231], v57 offset:1024
    ds_read_b128 v[196:199], v48 offset:4096
    ds_read_b128 v[200:203], v48 offset:8192
    ds_read_b128 v[204:207], v48 offset:12288
    s_waitcnt lgkmcnt(5)
    v_mfma_f32_32x32x16_bf16 v[64:79], v[224:227], v[192:195], 0
    ds_read_b64_tr_b16 v[232:233], v56 offset:4096
    ds_read_b64_tr_b16 v[234:235], v56 offset:5120
    s_waitcnt lgkmcnt(5)
    v_mfma_f32_32x32x16_bf16 v[80:95], v[228:231], v[192:195], 0
    ds_read_b128 v[208:211], v49 offset:0
    s_waitcnt lgkmcnt(5)
    v_mfma_f32_32x32x16_bf16 v[96:111], v[224:227], v[196:199], 0
    ds_read_b64_tr_b16 v[236:237], v57 offset:4096
    ds_read_b64_tr_b16 v[238:239], v57 offset:5120
    s_waitcnt lgkmcnt(7)
    v_mfma_f32_32x32x16_bf16 v[112:127], v[228:231], v[196:199], 0
    ds_read_b128 v[212:215], v49 offset:4096
    s_waitcnt lgkmcnt(7)
    v_mfma_f32_32x32x16_bf16 v[128:143], v[224:227], v[200:203], 0
    ds_read_b128 v[216:219], v49 offset:8192
    s_waitcnt lgkmcnt(8)
    v_mfma_f32_32x32x16_bf16 v[144:159], v[228:231], v[200:203], 0
    ds_read_b128 v[220:223], v49 offset:12288
    s_waitcnt lgkmcnt(8)
    v_mfma_f32_32x32x16_bf16 v[160:175], v[224:227], v[204:207], 0
    v_mfma_f32_32x32x16_bf16 v[176:191], v[228:231], v[204:207], 0
    s_waitcnt lgkmcnt(5)
    v_mfma_f32_32x32x16_bf16 v[64:79], v[232:235], v[208:211], v[64:79]
    s_waitcnt vmcnt(4)
    s_barrier
    ds_read_b64_tr_b16 v[224:225], v56 offset:16384
    ds_read_b64_tr_b16 v[226:227], v56 offset:17408
    s_cbranch_vccnz L_sk_2
    s_add_u32 m0, s54, 147456
    s_nop 0
    buffer_load_dwordx4 v12, s[28:31], s51 offen lds
L_sk_2:
    s_waitcnt lgkmcnt(5)
    v_mfma_f32_32x32x16_bf16 v[80:95], v[236:239], v[208:211], v[80:95]
    ds_read_b128 v[192:195], v50 offset:0
    s_waitcnt lgkmcnt(5)
    v_mfma_f32_32x32x16_bf16 v[96:111], v[232:235], v[212:215], v[96:111]
    ds_read_b64_tr_b16 v[228:229], v57 offset:16384
    ds_read_b64_tr_b16 v[230:231], v57 offset:17408
    s_cbranch_vccz L_sk_3
    s_add_u32 m0, s54, 147456
    s_nop 0
    buffer_load_dwordx4 v12, s[28:31], s51 offen lds
L_sk_3:
    s_waitcnt lgkmcnt(7)
    v_mfma_f32_32x32x16_bf16 v[112:127], v[236:239], v[212:215], v[112:127]
    ds_read_b128 v[196:199], v50 offset:4096
    s_waitcnt lgkmcnt(7)
    v_mfma_f32_32x32x16_bf16 v[128:143], v[232:235], v[216:219], v[128:143]
    ds_read_b128 v[200:203], v50 offset:8192
    s_cbranch_vccnz L_sk_4
    s_add_u32 m0, s54, 148480
    s_nop 0
    buffer_load_dwordx4 v13, s[28:31], s51 offen lds
    s_add_u32 s51, s51, s52
    s_cmp_eq_u32 s51, s55
    s_cselect_b32 s51, 0, s51
L_sk_4:
    s_waitcnt lgkmcnt(8)
    v_mfma_f32_32x32x16_bf16 v[144:159], v[236:239], v[216:219], v[144:159]
    ds_read_b128 v[204:207], v50 offset:12288
    s_waitcnt lgkmcnt(8)
    v_mfma_f32_32x32x16_bf16 v[160:175], v[232:235], v[220:223], v[160:175]
    s_cbranch_vccz L_sk_5
    s_add_u32 m0, s54, 148480
    s_nop 0
    buffer_load_dwordx4 v13, s[28:31], s51 offen lds
    s_add_u32 s51, s51, s52
    s_cmp_eq_u32 s51, s55
    s_cselect_b32 s51, 0, s51
L_sk_5:
    v_mfma_f32_32x32x16_bf16 v[176:191], v[236:239], v[220:223], v[176:191]
    s_waitcnt lgkmcnt(5)
    v_mfma_f32_32x32x16_bf16 v[64:79], v[224:227], v[192:195], v[64:79]
    ds_read_b64_tr_b16 v[232:233], v56 offset:20480
    ds_read_b64_tr_b16 v[234:235], v56 offset:21504
    s_cbranch_vccnz L_sk_6
    s_add_u32 m0, s53, 65536
    s_nop 0
    buffer_load_dwordx4 v8, s[24:27], s50 offen lds
L_sk_6:
    s_waitcnt lgkmcnt(5)
    v_mfma_f32_32x32x16_bf16 v[80:95], v[228:231], v[192:195], v[80:95]
    ds_read_b128 v[208:211], v51 offset:0
    s_waitcnt lgkmcnt(5)
    v_mfma_f32_32x32x16_bf16 v[96:111], v[224:227], v[196:199], v[96:111]
    ds_read_b64_tr_b16 v[236:237], v57 offset:20480
    ds_read_b64_tr_b16 v[238:239], v57 offset:21504
    s_cbranch_vccz L_sk_7
    s_add_u32 m0, s53, 65536
    s_nop 0
    buffer_load_dwordx4 v8, s[24:27], s50 offen lds
L_sk_7:
    s_waitcnt lgkmcnt(7)
    v_mfma_f32_32x32x16_bf16 v[112:127], v[228:231], v[196:199], v[112:127]
    ds_read_b128 v[212:215], v51 offset:4096
    s_waitcnt lgkmcnt(7)
    v_mfma_f32_32x32x16_bf16 v[128:143], v[224:227], v[200:203], v[128:143]
    ds_read_b128 v[216:219], v51 offset:8192
    s_cbranch_vccnz L_sk_8
    s_add_u32 m0, s53, 66560
    s_nop 0
    buffer_load_dwordx4 v9, s[24:27], s50 offen lds
L_sk_8:
    s_waitcnt lgkmcnt(8)
    v_mfma_f32_32x32x16_bf16 v[144:159], v[228:231], v[200:203], v[144:159]
    ds_read_b128 v[220:223], v51 offset:12288
    s_waitcnt lgkmcnt(8)
    v_mfma_f32_32x32x16_bf16 v[160:175], v[224:227], v[204:207], v[160:175]
    s_cbranch_vccz L_sk_9
    s_add_u32 m0, s53, 66560
    s_nop 0
    buffer_load_dwordx4 v9, s[24:27], s50 offen lds
L_sk_9:
    v_mfma_f32_32x32x16_bf16 v[176:191], v[228:231], v[204:207], v[176:191]
    s_waitcnt lgkmcnt(5)
    v_mfma_f32_32x32x16_bf16 v[64:79], v[232:235], v[208:211], v[64:79]
    s_waitcnt vmcnt(4)
    s_barrier
    ds_read_b64_tr_b16 v[224:225], v56 offset:32768
    ds_read_b64_tr_b16 v[226:227], v56 offset:33792
    s_cbranch_vccnz L_sk_10
    s_add_u32 m0, s54, 98304
    s_nop 0
    buffer_load_dwordx4 v12, s[28:31], s51 offen lds
L_sk_10:
    s_waitcnt lgkmcnt(5)
    v_mfma_f32_32x32x16_bf16 v[80:95], v[236:239], v[208:211], v[80:95]
    ds_read_b128 v[192:195], v48 offset:32768
    s_waitcnt lgkmcnt(5)
    v_mfma_f32_32x32x16_bf16 v[96:111], v[232:235], v[212:215], v[96:111]
    ds_read_b64_tr_b16 v[228:229], v57 offset:32768
    ds_read_b64_tr_b16 v[230:231], v57 offset:33792
    s_cbranch_vccz L_sk_11
    s_add_u32 m0, s54, 98304
    s_nop 0
    buffer_load_dwordx4 v12, s[28:31], s51 offen lds
L_sk_11:
    s_waitcnt lgkmcnt(7)
    v_mfma_f32_32x32x16_bf16 v[112:127], v[236:239], v[212:215], v[112:127]
    ds_read_b128 v[196:199], v48 offset:36864
    s_waitcnt lgkmcnt(7)
    v_mfma_f32_32x32x16_bf16 v[128:143], v[232:235], v[216:219], v[128:143]
    ds_read_b128 v[200:203], v48 offset:40960
    s_cbranch_vccnz L_sk_12
    s_add_u32 m0, s54, 99328
    s_nop 0
    buffer_load_dwordx4 v13, s[28:31], s51 offen lds
    s_add_u32 s51, s51, s52
    s_cmp_eq_u32 s51, s55
    s_cselect_b32 s51, 0, s51
L_sk_12:
    s_waitcnt lgkmcnt(8)
    v_mfma_f32_32x32x16_bf16 v[144:159], v[236:239], v[216:219], v[144:159]
    ds_read_b128 v[204:207], v48 offset:45056
    s_waitcnt lgkmcnt(8)
    v_mfma_f32_32x32x16_bf16 v[160:175], v[232:235], v[220:223], v[160:175]
    s_cbranch_vccz L_sk_13
    s_add_u32 m0, s54, 99328
    s_nop 0
    buffer_load_dwordx4 v13, s[28:31], s51 offen lds
    s_add_u32 s51, s51, s52
    s_cmp_eq_u32 s51, s55
    s_cselect_b32 s51, 0, s51
L_sk_13:
    v_mfma_f32_32x32x16_bf16 v[176:191], v[236:239], v[220:223], v[176:191]
    s_waitcnt lgkmcnt(5)
    v_mfma_f32_32x32x16_bf16 v[64:79], v[224:227], v[192:195], v[64:79]
    ds_read_b64_tr_b16 v[232:233], v56 offset:36864
    ds_read_b64_tr_b16 v[234:235], v56 offset:37888
    s_cbranch_vccnz L_sk_14
    s_add_u32 m0, s53, 67584
    s_nop 0
    buffer_load_dwordx4 v10, s[24:27], s50 offen lds
L_sk_14:
    s_waitcnt lgkmcnt(5)
    v_mfma_f32_32x32x16_bf16 v[80:95], v[228:231], v[192:195], v[80:95]
    ds_read_b128 v[208:211], v49 offset:32768
    s_waitcnt lgkmcnt(5)
    v_mfma_f32_32x32x16_bf16 v[96:111], v[224:227], v[196:199], v[96:111]
    ds_read_b64_tr_b16 v[236:237], v57 offset:36864
    ds_read_b64_tr_b16 v[238:239], v57 offset:37888
    s_cbranch_vccz L_sk_15
    s_add_u32 m0, s53, 67584
    s_nop 0
    buffer_load_dwordx4 v10, s[24:27], s50 offen lds
L_sk_15:
    s_waitcnt lgkmcnt(7)
    v_mfma_f32_32x32x16_bf16 v[112:127], v[228:231], v[196:199], v[112:127]
    ds_read_b128 v[212:215], v49 offset:36864
    s_waitcnt lgkmcnt(7)
    v_mfma_f32_32x32x16_bf16 v[128:143], v[224:227], v[200:203], v[128:143]
    ds_read_b128 v[216:219], v49 offset:40960
    s_cbranch_vccnz L_sk_16
    s_add_u32 m0, s53, 68608
    s_nop 0
    buffer_load_dwordx4 v11, s[24:27], s50 offen lds
    s_add_u32 s50, s50, 128
    s_and_b32 s50, s50, 1023
L_sk_16:
    s_waitcnt lgkmcnt(8)
    v_mfma_f32_32x32x16_bf16 v[144:159], v[228:231], v[200:203], v[144:159]
    ds_read_b128 v[220:223], v49 offset:45056
    s_waitcnt lgkmcnt(8)
    v_mfma_f32_32x32x16_bf16 v[160:175], v[224:227], v[204:207], v[160:175]
    s_cbranch_vccz L_sk_17
    s_add_u32 m0, s53, 68608
    s_nop 0
    buffer_load_dwordx4 v11, s[24:27], s50 offen lds
    s_add_u32 s50, s50, 128
    s_and_b32 s50, s50, 1023
L_sk_17:
    v_mfma_f32_32x32x16_bf16 v[176:191], v[228:231], v[204:207], v[176:191]
    s_waitcnt lgkmcnt(5)
    v_mfma_f32_32x32x16_bf16 v[64:79], v[232:235], v[208:211], v[64:79]
    s_waitcnt vmcnt(4)
    s_barrier
    ds_read_b64_tr_b16 v[224:225], v56 offset:49152
    ds_read_b64_tr_b16 v[226:227], v56 offset:50176
    s_cbranch_vccnz L_sk_18
    s_add_u32 m0, s54, 114688
    s_nop 0
    buffer_load_dwordx4 v12, s[28:31], s51 offen lds
L_sk_18:
    s_waitcnt lgkmcnt(5)
    v_mfma_f32_32x32x16_bf16 v[80:95], v[236:239], v[208:211], v[80:95]
    ds_read_b128 v[192:195], v50 offset:32768
    s_waitcnt lgkmcnt(5)
    v_mfma_f32_32x32x16_bf16 v[96:111], v[232:235], v[212:215], v[96:111]
    ds_read_b64_tr_b16 v[228:229], v57 offset:49152
    ds_read_b64_tr_b16 v[230:231], v57 offset:50176
    s_cbranch_vccz L_sk_19
    s_add_u32 m0, s54, 114688
    s_nop 0
    buffer_load_dwordx4 v12, s[28:31], s51 offen lds
L_sk_19:
    s_waitcnt lgkmcnt(7)
    v_mfma_f32_32x32x16_bf16 v[112:127], v[236:239], v[212:215], v[112:127]
    ds_read_b128 v[196:199], v50 offset:36864
    s_waitcnt lgkmcnt(7)
    v_mfma_f32_32x32x16_bf16 v[128:143], v[232:235], v[216:219], v[128:143]
    ds_read_b128 v[200:203], v50 offset:40960
    s_cbranch_vccnz L_sk_20
    s_add_u32 m0, s54, 115712
    s_nop 0
    buffer_load_dwordx4 v13, s[28:31], s51 offen lds
    s_add_u32 s51, s51, s52
    s_cmp_eq_u32 s51, s55
    s_cselect_b32 s51, 0, s51
L_sk_20:
    s_waitcnt lgkmcnt(8)
    v_mfma_f32_32x32x16_bf16 v[144:159], v[236:239], v[216:219], v[144:159]
    ds_read_b128 v[204:207], v50 offset:45056
    s_waitcnt lgkmcnt(8)
    v_mfma_f32_32x32x16_bf16 v[160:175], v[232:235], v[220:223], v[160:175]
    s_cbranch_vccz L_sk_21
    s_add_u32 m0, s54, 115712
    s_nop 0
    buffer_load_dwordx4 v13, s[28:31], s51 offen lds
    s_add_u32 s51, s51, s52
    s_cmp_eq_u32 s51, s55
    s_cselect_b32 s51, 0, s51
L_sk_21:
    v_mfma_f32_32x32x16_bf16 v[176:191], v[236:239], v[220:223], v[176:191]
    s_waitcnt lgkmcnt(5)
    v_mfma_f32_32x32x16_bf16 v[64:79], v[224:227], v[192:195], v[64:79]
    ds_read_b64_tr_b16 v[232:233], v56 offset:53248
    ds_read_b64_tr_b16 v[234:235], v56 offset:54272
    s_cbranch_vccnz L_sk_22
    s_add_u32 m0, s53, 0
    s_nop 0
    buffer_load_dwordx4 v8, s[24:27], s50 offen lds
L_sk_22:
    s_waitcnt lgkmcnt(5)
    v_mfma_f32_32x32x16_bf16 v[80:95], v[228:231], v[192:195], v[80:95]
    ds_read_b128 v[208:211], v51 offset:32768
    s_waitcnt lgkmcnt(5)
    v_mfma_f32_32x32x16_bf16 v[96:111], v[224:227], v[196:199], v[96:111]
    ds_read_b64_tr_b16 v[236:237], v57 offset:53248
    ds_read_b64_tr_b16 v[238:239], v57 offset:54272
    s_cbranch_vccz L_sk_23
    s_add_u32 m0, s53, 0
    s_nop 0
    buffer_load_dwordx4 v8, s[24:27], s50 offen lds
L_sk_23:
    s_waitcnt lgkmcnt(7)
    v_mfma_f32_32x32x16_bf16 v[112:127], v[228:231], v[196:199], v[112:127]
    ds_read_b128 v[212:215], v51 offset:36864
    s_waitcnt lgkmcnt(7)
    v_mfma_f32_32x32x16_bf16 v[128:143], v[224:227], v[200:203], v[128:143]
    ds_read_b128 v[216:219], v51 offset:40960
    s_cbranch_vccnz L_sk_24
    s_add_u32 m0, s53, 1024
    s_nop 0
    buffer_load_dwordx4 v9, s[24:27], s50 offen lds
L_sk_24:
    s_waitcnt lgkmcnt(8)
    v_mfma_f32_32x32x16_bf16 v[144:159], v[228:231], v[200:203], v[144:159]
    ds_read_b128 v[220:223], v51 offset:45056
    s_waitcnt lgkmcnt(8)
    v_mfma_f32_32x32x16_bf16 v[160:175], v[224:227], v[204:207], v[160:175]
    s_cbranch_vccz L_sk_25
    s_add_u32 m0, s53, 1024
    s_nop 0
    buffer_load_dwordx4 v9, s[24:27], s50 offen lds
L_sk_25:
    v_mfma_f32_32x32x16_bf16 v[176:191], v[228:231], v[204:207], v[176:191]
    s_waitcnt lgkmcnt(5)
    v_mfma_f32_32x32x16_bf16 v[64:79], v[232:235], v[208:211], v[64:79]
    s_waitcnt vmcnt(4)
    s_barrier
    ds_read_b64_tr_b16 v[224:225], v56 offset:0
    ds_read_b64_tr_b16 v[226:227], v56 offset:1024
    s_cbranch_vccnz L_sk_26
    s_add_u32 m0, s54, 131072
    s_nop 0
    buffer_load_dwordx4 v12, s[28:31], s51 offen lds
L_sk_26:
    s_waitcnt lgkmcnt(5)
    v_mfma_f32_32x32x16_bf16 v[80:95], v[236:239], v[208:211], v[80:95]
    ds_read_b128 v[192:195], v52 offset:0
    s_waitcnt lgkmcnt(5)
    v_mfma_f32_32x32x16_bf16 v[96:111], v[232:235], v[212:215], v[96:111]
    ds_read_b64_tr_b16 v[228:229], v57 offset:0
    ds_read_b64_tr_b16 v[230:231], v57 offset:1024
    s_cbranch_vccz L_sk_27
    s_add_u32 m0, s54, 131072
    s_nop 0
    buffer_load_dwordx4 v12, s[28:31], s51 offen lds
L_sk_27:
    s_waitcnt lgkmcnt(7)
    v_mfma_f32_32x32x16_bf16 v[112:127], v[236:239], v[212:215], v[112:127]
    ds_read_b128 v[196:199], v52 offset:4096
    s_waitcnt lgkmcnt(7)
    v_mfma_f32_32x32x16_bf16 v[128:143], v[232:235], v[216:219], v[128:143]
    ds_read_b128 v[200:203], v52 offset:8192
    s_cbranch_vccnz L_sk_28
    s_add_u32 m0, s54, 132096
    s_nop 0
    buffer_load_dwordx4 v13, s[28:31], s51 offen lds
    s_add_u32 s51, s51, s52
    s_cmp_eq_u32 s51, s55
    s_cselect_b32 s51, 0, s51
L_sk_28:
    s_waitcnt lgkmcnt(8)
    v_mfma_f32_32x32x16_bf16 v[144:159], v[236:239], v[216:219], v[144:159]
    ds_read_b128 v[204:207], v52 offset:12288
    s_waitcnt lgkmcnt(8)
    v_mfma_f32_32x32x16_bf16 v[160:175], v[232:235], v[220:223], v[160:175]
    s_cbranch_vccz L_sk_29
    s_add_u32 m0, s54, 132096
    s_nop 0
    buffer_load_dwordx4 v13, s[28:31], s51 offen lds
    s_add_u32 s51, s51, s52
    s_cmp_eq_u32 s51, s55
    s_cselect_b32 s51, 0, s51
L_sk_29:
    v_mfma_f32_32x32x16_bf16 v[176:191], v[236:239], v[220:223], v[176:191]
    s_waitcnt lgkmcnt(5)
    v_mfma_f32_32x32x16_bf16 v[64:79], v[224:227], v[192:195], v[64:79]
    ds_read_b64_tr_b16 v[232:233], v56 offset:4096
    ds_read_b64_tr_b16 v[234:235], v56 offset:5120
    s_cbranch_vccnz L_sk_30
    s_add_u32 m0, s53, 2048
    s_nop 0
    buffer_load_dwordx4 v10, s[24:27], s50 offen lds
L_sk_30:
    s_waitcnt lgkmcnt(5)
    v_mfma_f32_32x32x16_bf16 v[80:95], v[228:231], v[192:195], v[80:95]
    ds_read_b128 v[208:211], v53 offset:0
    s_waitcnt lgkmcnt(5)
    v_mfma_f32_32x32x16_bf16 v[96:111], v[224:227], v[196:199], v[96:111]
    ds_read_b64_tr_b16 v[236:237], v57 offset:4096
    ds_read_b64_tr_b16 v[238:239], v57 offset:5120
    s_cbranch_vccz L_sk_31
    s_add_u32 m0, s53, 2048
    s_nop 0
    buffer_load_dwordx4 v10, s[24:27], s50 offen lds
L_sk_31:
    s_waitcnt lgkmcnt(7)
    v_mfma_f32_32x32x16_bf16 v[112:127], v[228:231], v[196:199], v[112:127]
    ds_read_b128 v[212:215], v53 offset:4096
    s_waitcnt lgkmcnt(7)
    v_mfma_f32_32x32x16_bf16 v[128:143], v[224:227], v[200:203], v[128:143]
    ds_read_b128 v[216:219], v53 offset:8192
    s_cbranch_vccnz L_sk_32
    s_add_u32 m0, s53, 3072
    s_nop 0
    buffer_load_dwordx4 v11, s[24:27], s50 offen lds
    s_add_u32 s50, s50, 128
    s_and_b32 s50, s50, 1023
L_sk_32:
    s_waitcnt lgkmcnt(8)
    v_mfma_f32_32x32x16_bf16 v[144:159], v[228:231], v[200:203], v[144:159]
    ds_read_b128 v[220:223], v53 offset:12288
    s_waitcnt lgkmcnt(8)
    v_mfma_f32_32x32x16_bf16 v[160:175], v[224:227], v[204:207], v[160:175]
    s_cbranch_vccz L_sk_33
    s_add_u32 m0, s53, 3072
    s_nop 0
    buffer_load_dwordx4 v11, s[24:27], s50 offen lds
    s_add_u32 s50, s50, 128
    s_and_b32 s50, s50, 1023
L_sk_33:
    v_mfma_f32_32x32x16_bf16 v[176:191], v[228:231], v[204:207], v[176:191]
    s_waitcnt lgkmcnt(5)
    v_mfma_f32_32x32x16_bf16 v[64:79], v[232:235], v[208:211], v[64:79]
    s_waitcnt vmcnt(4)
    s_barrier
    ds_read_b64_tr_b16 v[224:225], v56 offset:16384
    ds_read_b64_tr_b16 v[226:227], v56 offset:17408
    s_cbranch_vccnz L_sk_34
    s_add_u32 m0, s54, 147456
    s_nop 0
    buffer_load_dwordx4 v12, s[28:31], s51 offen lds
L_sk_34:
    s_waitcnt lgkmcnt(5)
    v_mfma_f32_32x32x16_bf16 v[80:95], v[236:239], v[208:211], v[80:95]
    ds_read_b128 v[192:195], v54 offset:0
    s_waitcnt lgkmcnt(5)
    v_mfma_f32_32x32x16_bf16 v[96:111], v[232:235], v[212:215], v[96:111]
    ds_read_b64_tr_b16 v[228:229], v57 offset:16384
    ds_read_b64_tr_b16 v[230:231], v57 offset:17408
    s_cbranch_vccz L_sk_35
    s_add_u32 m0, s54, 147456
    s_nop 0
    buffer_load_dwordx4 v12, s[28:31], s51 offen lds
L_sk_35:
    s_waitcnt lgkmcnt(7)
    v_mfma_f32_32x32x16_bf16 v[112:127], v[236:239], v[212:215], v[112:127]
    ds_read_b128 v[196:199], v54 offset:4096
    s_waitcnt lgkmcnt(7)
    v_mfma_f32_32x32x16_bf16 v[128:143], v[232:235], v[216:219], v[128:143]
    ds_read_b128 v[200:203], v54 offset:8192
    s_cbranch_vccnz L_sk_36
    s_add_u32 m0, s54, 148480
    s_nop 0
    buffer_load_dwordx4 v13, s[28:31], s51 offen lds
    s_add_u32 s51, s51, s52
    s_cmp_eq_u32 s51, s55
    s_cselect_b32 s51, 0, s51
L_sk_36:
    s_waitcnt lgkmcnt(8)
    v_mfma_f32_32x32x16_bf16 v[144:159], v[236:239], v[216:219], v[144:159]
    ds_read_b128 v[204:207], v54 offset:12288
    s_waitcnt lgkmcnt(8)
    v_mfma_f32_32x32x16_bf16 v[160:175], v[232:235], v[220:223], v[160:175]
    s_cbranch_vccz L_sk_37
    s_add_u32 m0, s54, 148480
    s_nop 0
    buffer_load_dwordx4 v13, s[28:31], s51 offen lds
    s_add_u32 s51, s51, s52
    s_cmp_eq_u32 s51, s55
    s_cselect_b32 s51, 0, s51
L_sk_37:
    v_mfma_f32_32x32x16_bf16 v[176:191], v[236:239], v[220:223], v[176:191]
    s_waitcnt lgkmcnt(5)
    v_mfma_f32_32x32x16_bf16 v[64:79], v[224:227], v[192:195], v[64:79]
    ds_read_b64_tr_b16 v[232:233], v56 offset:20480
    ds_read_b64_tr_b16 v[234:235], v56 offset:21504
    s_cbranch_vccnz L_sk_38
    s_add_u32 m0, s53, 32768
    s_nop 0
    buffer_load_dwordx4 v8, s[24:27], s50 offen lds
L_sk_38:
    s_waitcnt lgkmcnt(5)
    v_mfma_f32_32x32x16_bf16 v[80:95], v[228:231], v[192:195], v[80:95]
    ds_read_b128 v[208:211], v55 offset:0
    s_waitcnt lgkmcnt(5)
    v_mfma_f32_32x32x16_bf16 v[96:111], v[224:227], v[196:199], v[96:111]
    ds_read_b64_tr_b16 v[236:237], v57 offset:20480
    ds_read_b64_tr_b16 v[238:239], v57 offset:21504
    s_cbranch_vccz L_sk_39
    s_add_u32 m0, s53, 32768
    s_nop 0
    buffer_load_dwordx4 v8, s[24:27], s50 offen lds
L_sk_39:
    s_waitcnt lgkmcnt(7)
    v_mfma_f32_32x32x16_bf16 v[112:127], v[228:231], v[196:199], v[112:127]
    ds_read_b128 v[212:215], v55 offset:4096
    s_waitcnt lgkmcnt(7)
    v_mfma_f32_32x32x16_bf16 v[128:143], v[224:227], v[200:203], v[128:143]
    ds_read_b128 v[216:219], v55 offset:8192
    s_cbranch_vccnz L_sk_40
    s_add_u32 m0, s53, 33792
    s_nop 0
    buffer_load_dwordx4 v9, s[24:27], s50 offen lds
L_sk_40:
    s_waitcnt lgkmcnt(8)
    v_mfma_f32_32x32x16_bf16 v[144:159], v[228:231], v[200:203], v[144:159]
    ds_read_b128 v[220:223], v55 offset:12288
    s_waitcnt lgkmcnt(8)
    v_mfma_f32_32x32x16_bf16 v[160:175], v[224:227], v[204:207], v[160:175]
    s_cbranch_vccz L_sk_41
    s_add_u32 m0, s53, 33792
    s_nop 0
    buffer_load_dwordx4 v9, s[24:27], s50 offen lds
L_sk_41:
    v_mfma_f32_32x32x16_bf16 v[176:191], v[228:231], v[204:207], v[176:191]
    s_waitcnt lgkmcnt(5)
    v_mfma_f32_32x32x16_bf16 v[64:79], v[232:235], v[208:211], v[64:79]
    s_waitcnt vmcnt(4)
    s_barrier
    ds_read_b64_tr_b16 v[224:225], v56 offset:32768
    ds_read_b64_tr_b16 v[226:227], v56 offset:33792
    s_cbranch_vccnz L_sk_42
    s_add_u32 m0, s54, 98304
    s_nop 0
    buffer_load_dwordx4 v12, s[28:31], s51 offen lds
L_sk_42:
    s_waitcnt lgkmcnt(5)
    v_mfma_f32_32x32x16_bf16 v[80:95], v[236:239], v[208:211], v[80:95]
    ds_read_b128 v[192:195], v48 offset:0
    s_waitcnt lgkmcnt(5)
    v_mfma_f32_32x32x16_bf16 v[96:111], v[232:235], v[212:215], v[96:111]
    ds_read_b64_tr_b16 v[228:229], v57 offset:32768
    ds_read_b64_tr_b16 v[230:231], v57 offset:33792
    s_cbranch_vccz L_sk_43
    s_add_u32 m0, s54, 98304
    s_nop 0
    buffer_load_dwordx4 v12, s[28:31], s51 offen lds
L_sk_43:
    s_waitcnt lgkmcnt(7)
    v_mfma_f32_32x32x16_bf16 v[112:127], v[236:239], v[212:215], v[112:127]
    ds_read_b128 v[196:199], v48 offset:4096
    s_waitcnt lgkmcnt(7)
    v_mfma_f32_32x32x16_bf16 v[128:143], v[232:235], v[216:219], v[128:143]
    ds_read_b128 v[200:203], v48 offset:8192
    s_cbranch_vccnz L_sk_44
    s_add_u32 m0, s54, 99328
    s_nop 0
    buffer_load_dwordx4 v13, s[28:31], s51 offen lds
    s_add_u32 s51, s51, s52
    s_cmp_eq_u32 s51, s55
    s_cselect_b32 s51, 0, s51
L_sk_44:
    s_waitcnt lgkmcnt(8)
    v_mfma_f32_32x32x16_bf16 v[144:159], v[236:239], v[216:219], v[144:159]
    ds_read_b128 v[204:207], v48 offset:12288
    s_waitcnt lgkmcnt(8)
    v_mfma_f32_32x32x16_bf16 v[160:175], v[232:235], v[220:223], v[160:175]
    s_cbranch_vccz L_sk_45
    s_add_u32 m0, s54, 99328
    s_nop 0
    buffer_load_dwordx4 v13, s[28:31], s51 offen lds
    s_add_u32 s51, s51, s52
    s_cmp_eq_u32 s51, s55
    s_cselect_b32 s51, 0, s51
L_sk_45:
    v_mfma_f32_32x32x16_bf16 v[176:191], v[236:239], v[220:223], v[176:191]
    s_waitcnt lgkmcnt(5)
    v_mfma_f32_32x32x16_bf16 v[64:79], v[224:227], v[192:195], v[64:79]
    ds_read_b64_tr_b16 v[232:233], v56 offset:36864
    ds_read_b64_tr_b16 v[234:235], v56 offset:37888
    s_cbranch_vccnz L_sk_46
    s_add_u32 m0, s53, 34816
    s_nop 0
    buffer_load_dwordx4 v10, s[24:27], s50 offen lds
L_sk_46:
    s_waitcnt lgkmcnt(5)
    v_mfma_f32_32x32x16_bf16 v[80:95], v[228:231], v[192:195], v[80:95]
    ds_read_b128 v[208:211], v49 offset:0
    s_waitcnt lgkmcnt(5)
    v_mfma_f32_32x32x16_bf16 v[96:111], v[224:227], v[196:199], v[96:111]
    ds_read_b64_tr_b16 v[236:237], v57 offset:36864
    ds_read_b64_tr_b16 v[238:239], v57 offset:37888
    s_cbranch_vccz L_sk_47
    s_add_u32 m0, s53, 34816
    s_nop 0
    buffer_load_dwordx4 v10, s[24:27], s50 offen lds
L_sk_47:
    s_waitcnt lgkmcnt(7)
    v_mfma_f32_32x32x16_bf16 v[112:127], v[228:231], v[196:199], v[112:127]
    ds_read_b128 v[212:215], v49 offset:4096
    s_waitcnt lgkmcnt(7)
    v_mfma_f32_32x32x16_bf16 v[128:143], v[224:227], v[200:203], v[128:143]
    ds_read_b128 v[216:219], v49 offset:8192
    s_cbranch_vccnz L_sk_48
    s_add_u32 m0, s53, 35840
    s_nop 0
    buffer_load_dwordx4 v11, s[24:27], s50 offen lds
    s_add_u32 s50, s50, 128
    s_and_b32 s50, s50, 1023
L_sk_48:
    s_waitcnt lgkmcnt(8)
    v_mfma_f32_32x32x16_bf16 v[144:159], v[228:231], v[200:203], v[144:159]
    ds_read_b128 v[220:223], v49 offset:12288
    s_waitcnt lgkmcnt(8)
    v_mfma_f32_32x32x16_bf16 v[160:175], v[224:227], v[204:207], v[160:175]
    s_cbranch_vccz L_sk_49
    s_add_u32 m0, s53, 35840
    s_nop 0
    buffer_load_dwordx4 v11, s[24:27], s50 offen lds
    s_add_u32 s50, s50, 128
    s_and_b32 s50, s50, 1023
L_sk_49:
    v_mfma_f32_32x32x16_bf16 v[176:191], v[228:231], v[204:207], v[176:191]
    s_waitcnt lgkmcnt(5)
    v_mfma_f32_32x32x16_bf16 v[64:79], v[232:235], v[208:211], v[64:79]
    s_waitcnt vmcnt(4)
    s_barrier
    ds_read_b64_tr_b16 v[224:225], v56 offset:49152
    ds_read_b64_tr_b16 v[226:227], v56 offset:50176
    s_cbranch_vccnz L_sk_50
    s_add_u32 m0, s54, 114688
    s_nop 0
    buffer_load_dwordx4 v12, s[28:31], s51 offen lds
L_sk_50:
    s_waitcnt lgkmcnt(5)
    v_mfma_f32_32x32x16_bf16 v[80:95], v[236:239], v[208:211], v[80:95]
    ds_read_b128 v[192:195], v50 offset:0
    s_waitcnt lgkmcnt(5)
    v_mfma_f32_32x32x16_bf16 v[96:111], v[232:235], v[212:215], v[96:111]
    ds_read_b64_tr_b16 v[228:229], v57 offset:49152
    ds_read_b64_tr_b16 v[230:231], v57 offset:50176
    s_cbranch_vccz L_sk_51
    s_add_u32 m0, s54, 114688
    s_nop 0
    buffer_load_dwordx4 v12, s[28:31], s51 offen lds
L_sk_51:
    s_waitcnt lgkmcnt(7)
    v_mfma_f32_32x32x16_bf16 v[112:127], v[236:239], v[212:215], v[112:127]
    ds_read_b128 v[196:199], v50 offset:4096
    s_waitcnt lgkmcnt(7)
    v_mfma_f32_32x32x16_bf16 v[128:143], v[232:235], v[216:219], v[128:143]
    ds_read_b128 v[200:203], v50 offset:8192
    s_cbranch_vccnz L_sk_52
    s_add_u32 m0, s54, 115712
    s_nop 0
    buffer_load_dwordx4 v13, s[28:31], s51 offen lds
    s_add_u32 s51, s51, s52
    s_cmp_eq_u32 s51, s55
    s_cselect_b32 s51, 0, s51
L_sk_52:
    s_waitcnt lgkmcnt(8)
    v_mfma_f32_32x32x16_bf16 v[144:159], v[236:239], v[216:219], v[144:159]
    ds_read_b128 v[204:207], v50 offset:12288
    s_waitcnt lgkmcnt(8)
    v_mfma_f32_32x32x16_bf16 v[160:175], v[232:235], v[220:223], v[160:175]
    s_cbranch_vccz L_sk_53
    s_add_u32 m0, s54, 115712
    s_nop 0
    buffer_load_dwordx4 v13, s[28:31], s51 offen lds
    s_add_u32 s51, s51, s52
    s_cmp_eq_u32 s51, s55
    s_cselect_b32 s51, 0, s51
L_sk_53:
    v_mfma_f32_32x32x16_bf16 v[176:191], v[236:239], v[220:223], v[176:191]
    s_waitcnt lgkmcnt(5)
    v_mfma_f32_32x32x16_bf16 v[64:79], v[224:227], v[192:195], v[64:79]
    ds_read_b64_tr_b16 v[232:233], v56 offset:53248
    ds_read_b64_tr_b16 v[234:235], v56 offset:54272
    s_cbranch_vccnz L_sk_54
    s_add_u32 m0, s53, 65536
    s_nop 0
    buffer_load_dwordx4 v8, s[24:27], s50 offen lds
L_sk_54:
    s_waitcnt lgkmcnt(5)
    v_mfma_f32_32x32x16_bf16 v[80:95], v[228:231], v[192:195], v[80:95]
    ds_read_b128 v[208:211], v51 offset:0
    s_waitcnt lgkmcnt(5)
    v_mfma_f32_32x32x16_bf16 v[96:111], v[224:227], v[196:199], v[96:111]
    ds_read_b64_tr_b16 v[236:237], v57 offset:53248
    ds_read_b64_tr_b16 v[238:239], v57 offset:54272
    s_cbranch_vccz L_sk_55
    s_add_u32 m0, s53, 65536
    s_nop 0
    buffer_load_dwordx4 v8, s[24:27], s50 offen lds
L_sk_55:
    s_waitcnt lgkmcnt(7)
    v_mfma_f32_32x32x16_bf16 v[112:127], v[228:231], v[196:199], v[112:127]
    ds_read_b128 v[212:215], v51 offset:4096
    s_waitcnt lgkmcnt(7)
    v_mfma_f32_32x32x16_bf16 v[128:143], v[224:227], v[200:203], v[128:143]
    ds_read_b128 v[216:219], v51 offset:8192
    s_cbranch_vccnz L_sk_56
    s_add_u32 m0, s53, 66560
    s_nop 0
    buffer_load_dwordx4 v9, s[24:27], s50 offen lds
L_sk_56:
    s_waitcnt lgkmcnt(8)
    v_mfma_f32_32x32x16_bf16 v[144:159], v[228:231], v[200:203], v[144:159]
    ds_read_b128 v[220:223], v51 offset:12288
    s_waitcnt lgkmcnt(8)
    v_mfma_f32_32x32x16_bf16 v[160:175], v[224:227], v[204:207], v[160:175]
    s_cbranch_vccz L_sk_57
    s_add_u32 m0, s53, 66560
    s_nop 0
    buffer_load_dwordx4 v9, s[24:27], s50 offen lds
L_sk_57:
    v_mfma_f32_32x32x16_bf16 v[176:191], v[228:231], v[204:207], v[176:191]
    s_waitcnt lgkmcnt(5)
    v_mfma_f32_32x32x16_bf16 v[64:79], v[232:235], v[208:211], v[64:79]
    s_waitcnt vmcnt(4)
    s_barrier
    ds_read_b64_tr_b16 v[224:225], v56 offset:0
    ds_read_b64_tr_b16 v[226:227], v56 offset:1024
    s_cbranch_vccnz L_sk_58
    s_add_u32 m0, s54, 131072
    s_nop 0
    buffer_load_dwordx4 v12, s[28:31], s51 offen lds
L_sk_58:
    s_waitcnt lgkmcnt(5)
    v_mfma_f32_32x32x16_bf16 v[80:95], v[236:239], v[208:211], v[80:95]
    ds_read_b128 v[192:195], v48 offset:32768
    s_waitcnt lgkmcnt(5)
    v_mfma_f32_32x32x16_bf16 v[96:111], v[232:235], v[212:215], v[96:111]
    ds_read_b64_tr_b16 v[228:229], v57 offset:0
    ds_read_b64_tr_b16 v[230:231], v57 offset:1024
    s_cbranch_vccz L_sk_59
    s_add_u32 m0, s54, 131072
    s_nop 0
    buffer_load_dwordx4 v12, s[28:31], s51 offen lds
L_sk_59:
    s_waitcnt lgkmcnt(7)
    v_mfma_f32_32x32x16_bf16 v[112:127], v[236:239], v[212:215], v[112:127]
    ds_read_b128 v[196:199], v48 offset:36864
    s_waitcnt lgkmcnt(7)
    v_mfma_f32_32x32x16_bf16 v[128:143], v[232:235], v[216:219], v[128:143]
    ds_read_b128 v[200:203], v48 offset:40960
    s_cbranch_vccnz L_sk_60
    s_add_u32 m0, s54, 132096
    s_nop 0
    buffer_load_dwordx4 v13, s[28:31], s51 offen lds
    s_add_u32 s51, s51, s52
    s_cmp_eq_u32 s51, s55
    s_cselect_b32 s51, 0, s51
L_sk_60:
    s_waitcnt lgkmcnt(8)
    v_mfma_f32_32x32x16_bf16 v[144:159], v[236:239], v[216:219], v[144:159]
    ds_read_b128 v[204:207], v48 offset:45056
    s_waitcnt lgkmcnt(8)
    v_mfma_f32_32x32x16_bf16 v[160:175], v[232:235], v[220:223], v[160:175]
    s_cbranch_vccz L_sk_61
    s_add_u32 m0, s54, 132096
    s_nop 0
    buffer_load_dwordx4 v13, s[28:31], s51 offen lds
    s_add_u32 s51, s51, s52
    s_cmp_eq_u32 s51, s55
    s_cselect_b32 s51, 0, s51
L_sk_61:
    v_mfma_f32_32x32x16_bf16 v[176:191], v[236:239], v[220:223], v[176:191]
    s_waitcnt lgkmcnt(5)
    v_mfma_f32_32x32x16_bf16 v[64:79], v[224:227], v[192:195], v[64:79]
    ds_read_b64_tr_b16 v[232:233], v56 offset:4096
    ds_read_b64_tr_b16 v[234:235], v56 offset:5120
    s_cbranch_vccnz L_sk_62
    s_add_u32 m0, s53, 67584
    s_nop 0
    buffer_load_dwordx4 v10, s[24:27], s50 offen lds
L_sk_62:
    s_waitcnt lgkmcnt(5)
    v_mfma_f32_32x32x16_bf16 v[80:95], v[228:231], v[192:195], v[80:95]
    ds_read_b128 v[208:211], v49 offset:32768
    s_waitcnt lgkmcnt(5)
    v_mfma_f32_32x32x16_bf16 v[96:111], v[224:227], v[196:199], v[96:111]
    ds_read_b64_tr_b16 v[236:237], v57 offset:4096
    ds_read_b64_tr_b16 v[238:239], v57 offset:5120
    s_cbranch_vccz L_sk_63
    s_add_u32 m0, s53, 67584
    s_nop 0
    buffer_load_dwordx4 v10, s[24:27], s50 offen lds
L_sk_63:
    s_waitcnt lgkmcnt(7)
    v_mfma_f32_32x32x16_bf16 v[112:127], v[228:231], v[196:199], v[112:127]
    ds_read_b128 v[212:215], v49 offset:36864
    s_waitcnt lgkmcnt(7)
    v_mfma_f32_32x32x16_bf16 v[128:143], v[224:227], v[200:203], v[128:143]
    ds_read_b128 v[216:219], v49 offset:40960
    s_cbranch_vccnz L_sk_64
    s_add_u32 m0, s53, 68608
    s_nop 0
    buffer_load_dwordx4 v11, s[24:27], s50 offen lds
    s_add_u32 s50, s50, 128
    s_and_b32 s50, s50, 1023
L_sk_64:
    s_waitcnt lgkmcnt(8)
    v_mfma_f32_32x32x16_bf16 v[144:159], v[228:231], v[200:203], v[144:159]
    ds_read_b128 v[220:223], v49 offset:45056
    s_waitcnt lgkmcnt(8)
    v_mfma_f32_32x32x16_bf16 v[160:175], v[224:227], v[204:207], v[160:175]
    s_cbranch_vccz L_sk_65
    s_add_u32 m0, s53, 68608
    s_nop 0
    buffer_load_dwordx4 v11, s[24:27], s50 offen lds
    s_add_u32 s50, s50, 128
    s_and_b32 s50, s50, 1023
L_sk_65:
    v_mfma_f32_32x32x16_bf16 v[176:191], v[228:231], v[204:207], v[176:191]
    s_waitcnt lgkmcnt(5)
    v_mfma_f32_32x32x16_bf16 v[64:79], v[232:235], v[208:211], v[64:79]
    s_waitcnt vmcnt(4)
    s_barrier
    ds_read_b64_tr_b16 v[224:225], v56 offset:16384
    ds_read_b64_tr_b16 v[226:227], v56 offset:17408
    s_cbranch_vccnz L_sk_66
    s_add_u32 m0, s54, 147456
    s_nop 0
    buffer_load_dwordx4 v12, s[28:31], s51 offen lds
L_sk_66:
    s_waitcnt lgkmcnt(5)
    v_mfma_f32_32x32x16_bf16 v[80:95], v[236:239], v[208:211], v[80:95]
    ds_read_b128 v[192:195], v50 offset:32768
    s_waitcnt lgkmcnt(5)
    v_mfma_f32_32x32x16_bf16 v[96:111], v[232:235], v[212:215], v[96:111]
    ds_read_b64_tr_b16 v[228:229], v57 offset:16384
    ds_read_b64_tr_b16 v[230:231], v57 offset:17408
    s_cbranch_vccz L_sk_67
    s_add_u32 m0, s54, 147456
    s_nop 0
    buffer_load_dwordx4 v12, s[28:31], s51 offen lds
L_sk_67:
    s_waitcnt lgkmcnt(7)
    v_mfma_f32_32x32x16_bf16 v[112:127], v[236:239], v[212:215], v[112:127]
    ds_read_b128 v[196:199], v50 offset:36864
    s_waitcnt lgkmcnt(7)
    v_mfma_f32_32x32x16_bf16 v[128:143], v[232:235], v[216:219], v[128:143]
    ds_read_b128 v[200:203], v50 offset:40960
    s_cbranch_vccnz L_sk_68
    s_add_u32 m0, s54, 148480
    s_nop 0
    buffer_load_dwordx4 v13, s[28:31], s51 offen lds
    s_add_u32 s51, s51, s52
    s_cmp_eq_u32 s51, s55
    s_cselect_b32 s51, 0, s51
L_sk_68:
    s_waitcnt lgkmcnt(8)
    v_mfma_f32_32x32x16_bf16 v[144:159], v[236:239], v[216:219], v[144:159]
    ds_read_b128 v[204:207], v50 offset:45056
    s_waitcnt lgkmcnt(8)
    v_mfma_f32_32x32x16_bf16 v[160:175], v[232:235], v[220:223], v[160:175]
    s_cbranch_vccz L_sk_69
    s_add_u32 m0, s54, 148480
    s_nop 0
    buffer_load_dwordx4 v13, s[28:31], s51 offen lds
    s_add_u32 s51, s51, s52
    s_cmp_eq_u32 s51, s55
    s_cselect_b32 s51, 0, s51
L_sk_69:
    v_mfma_f32_32x32x16_bf16 v[176:191], v[236:239], v[220:223], v[176:191]
    s_waitcnt lgkmcnt(5)
    v_mfma_f32_32x32x16_bf16 v[64:79], v[224:227], v[192:195], v[64:79]
    ds_read_b64_tr_b16 v[232:233], v56 offset:20480
    ds_read_b64_tr_b16 v[234:235], v56 offset:21504
    s_cbranch_vccnz L_sk_70
    s_add_u32 m0, s53, 0
    s_nop 0
    buffer_load_dwordx4 v8, s[24:27], s50 offen lds
L_sk_70:
    s_waitcnt lgkmcnt(5)
    v_mfma_f32_32x32x16_bf16 v[80:95], v[228:231], v[192:195], v[80:95]
    ds_read_b128 v[208:211], v51 offset:32768
    s_waitcnt lgkmcnt(5)
    v_mfma_f32_32x32x16_bf16 v[96:111], v[224:227], v[196:199], v[96:111]
    ds_read_b64_tr_b16 v[236:237], v57 offset:20480
    ds_read_b64_tr_b16 v[238:239], v57 offset:21504
    s_cbranch_vccz L_sk_71
    s_add_u32 m0, s53, 0
    s_nop 0
    buffer_load_dwordx4 v8, s[24:27], s50 offen lds
L_sk_71:
    s_waitcnt lgkmcnt(7)
    v_mfma_f32_32x32x16_bf16 v[112:127], v[228:231], v[196:199], v[112:127]
    ds_read_b128 v[212:215], v51 offset:36864
    s_waitcnt lgkmcnt(7)
    v_mfma_f32_32x32x16_bf16 v[128:143], v[224:227], v[200:203], v[128:143]
    ds_read_b128 v[216:219], v51 offset:40960
    s_cbranch_vccnz L_sk_72
    s_add_u32 m0, s53, 1024
    s_nop 0
    buffer_load_dwordx4 v9, s[24:27], s50 offen lds
L_sk_72:
    s_waitcnt lgkmcnt(8)
    v_mfma_f32_32x32x16_bf16 v[144:159], v[228:231], v[200:203], v[144:159]
    ds_read_b128 v[220:223], v51 offset:45056
    s_waitcnt lgkmcnt(8)
    v_mfma_f32_32x32x16_bf16 v[160:175], v[224:227], v[204:207], v[160:175]
    s_cbranch_vccz L_sk_73
    s_add_u32 m0, s53, 1024
    s_nop 0
    buffer_load_dwordx4 v9, s[24:27], s50 offen lds
L_sk_73:
    v_mfma_f32_32x32x16_bf16 v[176:191], v[228:231], v[204:207], v[176:191]
    s_waitcnt lgkmcnt(5)
    v_mfma_f32_32x32x16_bf16 v[64:79], v[232:235], v[208:211], v[64:79]
    s_waitcnt vmcnt(4)
    s_barrier
    ds_read_b64_tr_b16 v[224:225], v56 offset:32768
    ds_read_b64_tr_b16 v[226:227], v56 offset:33792
    s_cbranch_vccnz L_sk_74
    s_add_u32 m0, s54, 98304
    s_nop 0
    buffer_load_dwordx4 v12, s[28:31], s51 offen lds
L_sk_74:
    s_waitcnt lgkmcnt(5)
    v_mfma_f32_32x32x16_bf16 v[80:95], v[236:239], v[208:211], v[80:95]
    ds_read_b128 v[192:195], v52 offset:0
    s_waitcnt lgkmcnt(5)
    v_mfma_f32_32x32x16_bf16 v[96:111], v[232:235], v[212:215], v[96:111]
    ds_read_b64_tr_b16 v[228:229], v57 offset:32768
    ds_read_b64_tr_b16 v[230:231], v57 offset:33792
    s_cbranch_vccz L_sk_75
    s_add_u32 m0, s54, 98304
    s_nop 0
    buffer_load_dwordx4 v12, s[28:31], s51 offen lds
L_sk_75:
    s_waitcnt lgkmcnt(7)
    v_mfma_f32_32x32x16_bf16 v[112:127], v[236:239], v[212:215], v[112:127]
    ds_read_b128 v[196:199], v52 offset:4096
    s_waitcnt lgkmcnt(7)
    v_mfma_f32_32x32x16_bf16 v[128:143], v[232:235], v[216:219], v[128:143]
    ds_read_b128 v[200:203], v52 offset:8192
    s_cbranch_vccnz L_sk_76
    s_add_u32 m0, s54, 99328
    s_nop 0
    buffer_load_dwordx4 v13, s[28:31], s51 offen lds
    s_add_u32 s51, s51, s52
    s_cmp_eq_u32 s51, s55
    s_cselect_b32 s51, 0, s51
L_sk_76:
    s_waitcnt lgkmcnt(8)
    v_mfma_f32_32x32x16_bf16 v[144:159], v[236:239], v[216:219], v[144:159]
    ds_read_b128 v[204:207], v52 offset:12288
    s_waitcnt lgkmcnt(8)
    v_mfma_f32_32x32x16_bf16 v[160:175], v[232:235], v[220:223], v[160:175]
    s_cbranch_vccz L_sk_77
    s_add_u32 m0, s54, 99328
    s_nop 0
    buffer_load_dwordx4 v13, s[28:31], s51 offen lds
    s_add_u32 s51, s51, s52
    s_cmp_eq_u32 s51, s55
    s_cselect_b32 s51, 0, s51
L_sk_77:
    v_mfma_f32_32x32x16_bf16 v[176:191], v[236:239], v[220:223], v[176:191]
    s_waitcnt lgkmcnt(5)
    v_mfma_f32_32x32x16_bf16 v[64:79], v[224:227], v[192:195], v[64:79]
    ds_read_b64_tr_b16 v[232:233], v56 offset:36864
    ds_read_b64_tr_b16 v[234:235], v56 offset:37888
    s_cbranch_vccnz L_sk_78
    s_add_u32 m0, s53, 2048
    s_nop 0
    buffer_load_dwordx4 v10, s[24:27], s50 offen lds
L_sk_78:
    s_waitcnt lgkmcnt(5)
    v_mfma_f32_32x32x16_bf16 v[80:95], v[228:231], v[192:195], v[80:95]
    ds_read_b128 v[208:211], v53 offset:0
    s_waitcnt lgkmcnt(5)
    v_mfma_f32_32x32x16_bf16 v[96:111], v[224:227], v[196:199], v[96:111]
    ds_read_b64_tr_b16 v[236:237], v57 offset:36864
    ds_read_b64_tr_b16 v[238:239], v57 offset:37888
    s_cbranch_vccz L_sk_79
    s_add_u32 m0, s53, 2048
    s_nop 0
    buffer_load_dwordx4 v10, s[24:27], s50 offen lds
L_sk_79:
    s_waitcnt lgkmcnt(7)
    v_mfma_f32_32x32x16_bf16 v[112:127], v[228:231], v[196:199], v[112:127]
    ds_read_b128 v[212:215], v53 offset:4096
    s_waitcnt lgkmcnt(7)
    v_mfma_f32_32x32x16_bf16 v[128:143], v[224:227], v[200:203], v[128:143]
    ds_read_b128 v[216:219], v53 offset:8192
    s_cbranch_vccnz L_sk_80
    s_add_u32 m0, s53, 3072
    s_nop 0
    buffer_load_dwordx4 v11, s[24:27], s50 offen lds
    s_add_u32 s50, s50, 128
    s_and_b32 s50, s50, 1023
L_sk_80:
    s_waitcnt lgkmcnt(8)
    v_mfma_f32_32x32x16_bf16 v[144:159], v[228:231], v[200:203], v[144:159]
    ds_read_b128 v[220:223], v53 offset:12288
    s_waitcnt lgkmcnt(8)
    v_mfma_f32_32x32x16_bf16 v[160:175], v[224:227], v[204:207], v[160:175]
    s_cbranch_vccz L_sk_81
    s_add_u32 m0, s53, 3072
    s_nop 0
    buffer_load_dwordx4 v11, s[24:27], s50 offen lds
    s_add_u32 s50, s50, 128
    s_and_b32 s50, s50, 1023
L_sk_81:
    v_mfma_f32_32x32x16_bf16 v[176:191], v[228:231], v[204:207], v[176:191]
    s_waitcnt lgkmcnt(5)
    v_mfma_f32_32x32x16_bf16 v[64:79], v[232:235], v[208:211], v[64:79]
    s_waitcnt vmcnt(4)
    s_barrier
    ds_read_b64_tr_b16 v[224:225], v56 offset:49152
    ds_read_b64_tr_b16 v[226:227], v56 offset:50176
    s_cbranch_vccnz L_sk_82
    s_add_u32 m0, s54, 114688
    s_nop 0
    buffer_load_dwordx4 v12, s[28:31], s51 offen lds
L_sk_82:
    s_waitcnt lgkmcnt(5)
    v_mfma_f32_32x32x16_bf16 v[80:95], v[236:239], v[208:211], v[80:95]
    ds_read_b128 v[192:195], v54 offset:0
    s_waitcnt lgkmcnt(5)
    v_mfma_f32_32x32x16_bf16 v[96:111], v[232:235], v[212:215], v[96:111]
    ds_read_b64_tr_b16 v[228:229], v57 offset:49152
    ds_read_b64_tr_b16 v[230:231], v57 offset:50176
    s_cbranch_vccz L_sk_83
    s_add_u32 m0, s54, 114688
    s_nop 0
    buffer_load_dwordx4 v12, s[28:31], s51 offen lds
L_sk_83:
    s_waitcnt lgkmcnt(7)
    v_mfma_f32_32x32x16_bf16 v[112:127], v[236:239], v[212:215], v[112:127]
    ds_read_b128 v[196:199], v54 offset:4096
    s_waitcnt lgkmcnt(7)
    v_mfma_f32_32x32x16_bf16 v[128:143], v[232:235], v[216:219], v[128:143]
    ds_read_b128 v[200:203], v54 offset:8192
    s_cbranch_vccnz L_sk_84
    s_add_u32 m0, s54, 115712
    s_nop 0
    buffer_load_dwordx4 v13, s[28:31], s51 offen lds
    s_add_u32 s51, s51, s52
    s_cmp_eq_u32 s51, s55
    s_cselect_b32 s51, 0, s51
L_sk_84:
    s_waitcnt lgkmcnt(8)
    v_mfma_f32_32x32x16_bf16 v[144:159], v[236:239], v[216:219], v[144:159]
    ds_read_b128 v[204:207], v54 offset:12288
    s_waitcnt lgkmcnt(8)
    v_mfma_f32_32x32x16_bf16 v[160:175], v[232:235], v[220:223], v[160:175]
    s_cbranch_vccz L_sk_85
    s_add_u32 m0, s54, 115712
    s_nop 0
    buffer_load_dwordx4 v13, s[28:31], s51 offen lds
    s_add_u32 s51, s51, s52
    s_cmp_eq_u32 s51, s55
    s_cselect_b32 s51, 0, s51
L_sk_85:
    v_mfma_f32_32x32x16_bf16 v[176:191], v[236:239], v[220:223], v[176:191]
    s_waitcnt lgkmcnt(5)
    v_mfma_f32_32x32x16_bf16 v[64:79], v[224:227], v[192:195], v[64:79]
    ds_read_b64_tr_b16 v[232:233], v56 offset:53248
    ds_read_b64_tr_b16 v[234:235], v56 offset:54272
    s_cbranch_vccnz L_sk_86
    s_add_u32 m0, s53, 32768
    s_nop 0
    buffer_load_dwordx4 v8, s[24:27], s50 offen lds
L_sk_86:
    s_waitcnt lgkmcnt(5)
    v_mfma_f32_32x32x16_bf16 v[80:95], v[228:231], v[192:195], v[80:95]
    ds_read_b128 v[208:211], v55 offset:0
    s_waitcnt lgkmcnt(5)
    v_mfma_f32_32x32x16_bf16 v[96:111], v[224:227], v[196:199], v[96:111]
    ds_read_b64_tr_b16 v[236:237], v57 offset:53248
    ds_read_b64_tr_b16 v[238:239], v57 offset:54272
    s_cbranch_vccz L_sk_87
    s_add_u32 m0, s53, 32768
    s_nop 0
    buffer_load_dwordx4 v8, s[24:27], s50 offen lds
L_sk_87:
    s_waitcnt lgkmcnt(7)
    v_mfma_f32_32x32x16_bf16 v[112:127], v[228:231], v[196:199], v[112:127]
    ds_read_b128 v[212:215], v55 offset:4096
    s_waitcnt lgkmcnt(7)
    v_mfma_f32_32x32x16_bf16 v[128:143], v[224:227], v[200:203], v[128:143]
    ds_read_b128 v[216:219], v55 offset:8192
    s_cbranch_vccnz L_sk_88
    s_add_u32 m0, s53, 33792
    s_nop 0
    buffer_load_dwordx4 v9, s[24:27], s50 offen lds
L_sk_88:
    s_waitcnt lgkmcnt(8)
    v_mfma_f32_32x32x16_bf16 v[144:159], v[228:231], v[200:203], v[144:159]
    ds_read_b128 v[220:223], v55 offset:12288
    s_waitcnt lgkmcnt(8)
    v_mfma_f32_32x32x16_bf16 v[160:175], v[224:227], v[204:207], v[160:175]
    s_cbranch_vccz L_sk_89
    s_add_u32 m0, s53, 33792
    s_nop 0
    buffer_load_dwordx4 v9, s[24:27], s50 offen lds
L_sk_89:
    v_mfma_f32_32x32x16_bf16 v[176:191], v[228:231], v[204:207], v[176:191]
    s_waitcnt lgkmcnt(5)
    v_mfma_f32_32x32x16_bf16 v[64:79], v[232:235], v[208:211], v[64:79]
    s_waitcnt vmcnt(4)
    s_barrier
    ds_read_b64_tr_b16 v[224:225], v56 offset:0
    ds_read_b64_tr_b16 v[226:227], v56 offset:1024
    s_cbranch_vccnz L_sk_90
    s_add_u32 m0, s54, 131072
    s_nop 0
    buffer_load_dwordx4 v12, s[28:31], s51 offen lds
L_sk_90:
    s_waitcnt lgkmcnt(5)
    v_mfma_f32_32x32x16_bf16 v[80:95], v[236:239], v[208:211], v[80:95]
    ds_read_b128 v[192:195], v48 offset:0
    s_waitcnt lgkmcnt(5)
    v_mfma_f32_32x32x16_bf16 v[96:111], v[232:235], v[212:215], v[96:111]
    ds_read_b64_tr_b16 v[228:229], v57 offset:0
    ds_read_b64_tr_b16 v[230:231], v57 offset:1024
    s_cbranch_vccz L_sk_91
    s_add_u32 m0, s54, 131072
    s_nop 0
    buffer_load_dwordx4 v12, s[28:31], s51 offen lds
L_sk_91:
    s_waitcnt lgkmcnt(7)
    v_mfma_f32_32x32x16_bf16 v[112:127], v[236:239], v[212:215], v[112:127]
    ds_read_b128 v[196:199], v48 offset:4096
    s_waitcnt lgkmcnt(7)
    v_mfma_f32_32x32x16_bf16 v[128:143], v[232:235], v[216:219], v[128:143]
    ds_read_b128 v[200:203], v48 offset:8192
    s_cbranch_vccnz L_sk_92
    s_add_u32 m0, s54, 132096
    s_nop 0
    buffer_load_dwordx4 v13, s[28:31], s51 offen lds
    s_add_u32 s51, s51, s52
    s_cmp_eq_u32 s51, s55
    s_cselect_b32 s51, 0, s51
L_sk_92:
    s_waitcnt lgkmcnt(8)
    v_mfma_f32_32x32x16_bf16 v[144:159], v[236:239], v[216:219], v[144:159]
    ds_read_b128 v[204:207], v48 offset:12288
    s_waitcnt lgkmcnt(8)
    v_mfma_f32_32x32x16_bf16 v[160:175], v[232:235], v[220:223], v[160:175]
    s_cbranch_vccz L_sk_93
    s_add_u32 m0, s54, 132096
    s_nop 0
    buffer_load_dwordx4 v13, s[28:31], s51 offen lds
    s_add_u32 s51, s51, s52
    s_cmp_eq_u32 s51, s55
    s_cselect_b32 s51, 0, s51
L_sk_93:
    v_mfma_f32_32x32x16_bf16 v[176:191], v[236:239], v[220:223], v[176:191]
    s_waitcnt lgkmcnt(5)
    v_mfma_f32_32x32x16_bf16 v[64:79], v[224:227], v[192:195], v[64:79]
    ds_read_b64_tr_b16 v[232:233], v56 offset:4096
    ds_read_b64_tr_b16 v[234:235], v56 offset:5120
    s_cbranch_vccnz L_sk_94
    s_add_u32 m0, s53, 34816
    s_nop 0
    buffer_load_dwordx4 v10, s[24:27], s50 offen lds
L_sk_94:
    s_waitcnt lgkmcnt(5)
    v_mfma_f32_32x32x16_bf16 v[80:95], v[228:231], v[192:195], v[80:95]
    ds_read_b128 v[208:211], v49 offset:0
    s_waitcnt lgkmcnt(5)
    v_mfma_f32_32x32x16_bf16 v[96:111], v[224:227], v[196:199], v[96:111]
    ds_read_b64_tr_b16 v[236:237], v57 offset:4096
    ds_read_b64_tr_b16 v[238:239], v57 offset:5120
    s_cbranch_vccz L_sk_95
    s_add_u32 m0, s53, 34816
    s_nop 0
    buffer_load_dwordx4 v10, s[24:27], s50 offen lds
L_sk_95:
    s_waitcnt lgkmcnt(7)
    v_mfma_f32_32x32x16_bf16 v[112:127], v[228:231], v[196:199], v[112:127]
    ds_read_b128 v[212:215], v49 offset:4096
    s_waitcnt lgkmcnt(7)
    v_mfma_f32_32x32x16_bf16 v[128:143], v[224:227], v[200:203], v[128:143]
    ds_read_b128 v[216:219], v49 offset:8192
    s_cbranch_vccnz L_sk_96
    s_add_u32 m0, s53, 35840
    s_nop 0
    buffer_load_dwordx4 v11, s[24:27], s50 offen lds
    s_add_u32 s50, s50, 128
    s_and_b32 s50, s50, 1023
L_sk_96:
    s_waitcnt lgkmcnt(8)
    v_mfma_f32_32x32x16_bf16 v[144:159], v[228:231], v[200:203], v[144:159]
    ds_read_b128 v[220:223], v49 offset:12288
    s_waitcnt lgkmcnt(8)
    v_mfma_f32_32x32x16_bf16 v[160:175], v[224:227], v[204:207], v[160:175]
    s_cbranch_vccz L_sk_97
    s_add_u32 m0, s53, 35840
    s_nop 0
    buffer_load_dwordx4 v11, s[24:27], s50 offen lds
    s_add_u32 s50, s50, 128
    s_and_b32 s50, s50, 1023
L_sk_97:
    v_mfma_f32_32x32x16_bf16 v[176:191], v[228:231], v[204:207], v[176:191]
    s_waitcnt lgkmcnt(5)
    v_mfma_f32_32x32x16_bf16 v[64:79], v[232:235], v[208:211], v[64:79]
    s_waitcnt vmcnt(4)
    s_barrier
    ds_read_b64_tr_b16 v[224:225], v56 offset:16384
    ds_read_b64_tr_b16 v[226:227], v56 offset:17408
    s_cbranch_vccnz L_sk_98
    s_add_u32 m0, s54, 147456
    s_nop 0
    buffer_load_dwordx4 v12, s[28:31], s51 offen lds
L_sk_98:
    s_waitcnt lgkmcnt(5)
    v_mfma_f32_32x32x16_bf16 v[80:95], v[236:239], v[208:211], v[80:95]
    ds_read_b128 v[192:195], v50 offset:0
    s_waitcnt lgkmcnt(5)
    v_mfma_f32_32x32x16_bf16 v[96:111], v[232:235], v[212:215], v[96:111]
    ds_read_b64_tr_b16 v[228:229], v57 offset:16384
    ds_read_b64_tr_b16 v[230:231], v57 offset:17408
    s_cbranch_vccz L_sk_99
    s_add_u32 m0, s54, 147456
    s_nop 0
    buffer_load_dwordx4 v12, s[28:31], s51 offen lds
L_sk_99:
    s_waitcnt lgkmcnt(7)
    v_mfma_f32_32x32x16_bf16 v[112:127], v[236:239], v[212:215], v[112:127]
    ds_read_b128 v[196:199], v50 offset:4096
    s_waitcnt lgkmcnt(7)
    v_mfma_f32_32x32x16_bf16 v[128:143], v[232:235], v[216:219], v[128:143]
    ds_read_b128 v[200:203], v50 offset:8192
    s_cbranch_vccnz L_sk_100
    s_add_u32 m0, s54, 148480
    s_nop 0
    buffer_load_dwordx4 v13, s[28:31], s51 offen lds
    s_add_u32 s51, s51, s52
    s_cmp_eq_u32 s51, s55
    s_cselect_b32 s51, 0, s51
L_sk_100:
    s_waitcnt lgkmcnt(8)
    v_mfma_f32_32x32x16_bf16 v[144:159], v[236:239], v[216:219], v[144:159]
    ds_read_b128 v[204:207], v50 offset:12288
    s_waitcnt lgkmcnt(8)
    v_mfma_f32_32x32x16_bf16 v[160:175], v[232:235], v[220:223], v[160:175]
    s_cbranch_vccz L_sk_101
    s_add_u32 m0, s54, 148480
    s_nop 0
    buffer_load_dwordx4 v13, s[28:31], s51 offen lds
    s_add_u32 s51, s51, s52
    s_cmp_eq_u32 s51, s55
    s_cselect_b32 s51, 0, s51
L_sk_101:
    v_mfma_f32_32x32x16_bf16 v[176:191], v[236:239], v[220:223], v[176:191]
    s_waitcnt lgkmcnt(5)
    v_mfma_f32_32x32x16_bf16 v[64:79], v[224:227], v[192:195], v[64:79]
    ds_read_b64_tr_b16 v[232:233], v56 offset:20480
    ds_read_b64_tr_b16 v[234:235], v56 offset:21504
    s_waitcnt lgkmcnt(5)
    v_mfma_f32_32x32x16_bf16 v[80:95], v[228:231], v[192:195], v[80:95]
    ds_read_b128 v[208:211], v51 offset:0
    s_load_dwordx2 s[4:5], s[0:1], 104
    s_load_dwordx2 s[24:25], s[0:1], 0
    s_load_dwordx2 s[28:29], s[0:1], 16
    s_load_dwordx2 s[6:7], s[0:1], 56
    s_load_dwordx2 s[8:9], s[0:1], 64
    s_and_b32 s40, s2, 7
    s_lshl_b32 s40, s40, 2
    s_bfe_u32 s3, s2, 0x20003
    s_add_u32 s40, s40, s3
    s_lshr_b32 s41, s2, 5
    v_lshrrev_b32 v1, 6, v0
    s_nop 0
    v_readfirstlane_b32 s42, v1
    v_and_b32 v2, 63, v0
    s_lshr_b32 s48, s42, 2
    s_and_b32 s49, s42, 3
    s_sub_u32 s46, 15, s41
    s_cmp_eq_u32 s48, 0
    s_cselect_b32 s46, s46, s41
    s_lshl_b32 s46, s46, 7
    s_lshl_b32 s47, s49, 5
    s_add_u32 s43, s46, s47
    s_lshl_b32 s47, s42, 5
    s_waitcnt lgkmcnt(0)
    s_mov_b32 s26, 0x200000
    s_mov_b32 s27, 0x00020000
    s_mov_b32 s30, 0x180000
    s_movk_i32 s44, 3072
    s_cmp_eq_u32 s48, 0
    s_cselect_b32 s28, s28, s6
    s_cselect_b32 s29, s29, s7
    s_cselect_b32 s30, 0x400000, s30
    s_cselect_b32 s44, 8192, s44
    s_mov_b32 s31, 0x00020000
    s_mov_b32 s32, s4
    s_mov_b32 s33, s5
    s_mov_b32 s34, 0x10000000
    s_mov_b32 s35, 0x00020000
    s_lshl_b32 s52, s44, 5

    v_lshrrev_b32 v3, 3, v2
    v_add_u32 v3, s43, v3
    v_lshrrev_b32 v4, 4, v2
    v_and_b32 v5, 7, v2
    v_xor_b32 v5, v5, v4
    v_xor_b32 v6, 4, v5
    v_lshlrev_b32 v5, 4, v5
    v_lshlrev_b32 v6, 4, v6

    v_add_u32 v7, 0, v3
    v_lshl_add_u32 v8, v7, 10, v5
    v_add_u32 v7, 8, v3
    v_lshl_add_u32 v9, v7, 10, v6
    v_add_u32 v7, 16, v3
    v_lshl_add_u32 v10, v7, 10, v5
    v_add_u32 v7, 24, v3
    v_lshl_add_u32 v11, v7, 10, v6
    v_and_b32 v3, 31, v2
    v_lshrrev_b32 v4, 5, v2
    v_add_u32 v5, s47, v3
    v_bfe_u32 v6, v3, 1, 3
    v_xor_b32 v6, v6, v4
    v_lshlrev_b32 v6, 4, v6
    v_lshl_add_u32 v16, v5, 7, v6

    v_xor_b32 v17, 32, v16
    v_xor_b32 v18, 64, v16
    v_xor_b32 v19, 96, v16
    v_add_u32 v20, 65536, v16
    v_add_u32 v21, 65536, v17
    v_add_u32 v22, 65536, v18
    v_add_u32 v23, 65536, v19
    v_bfe_u32 v3, v2, 2, 2
    v_lshl_add_u32 v4, v4, 3, v3
    v_lshlrev_b32 v4, 8, v4
    v_and_b32 v5, 3, v2
    v_lshlrev_b32 v5, 3, v5
    v_bfe_u32 v6, v2, 4, 1
    v_lshl_add_u32 v5, v6, 5, v5
    v_add_u32 v4, v4, v5
    v_add_u32 v4, 98304, v4
    s_bfe_u32 s50, s2, 0x20003
    s_lshl_b32 s50, s50, 1
    s_lshr_b32 s51, s2, 5
    s_add_u32 s50, s50, s51
    s_and_b32 s50, s50, 7
    s_lshl_b32 s51, s52, 1
    s_mul_i32 s51, s51, s50
    s_lshl_b32 s50, s50, 7
    s_lshl_b32 s55, s52, 4
    s_lshl_b32 s53, s42, 12
    s_lshl_b32 s54, s42, 11

    v_xor_b32 v5, 0, v3
    v_lshl_add_u32 v24, v5, 6, v4
    v_xor_b32 v5, 1, v3
    v_lshl_add_u32 v25, v5, 6, v4
    v_xor_b32 v5, 2, v3
    v_lshl_add_u32 v26, v5, 6, v4
    v_xor_b32 v5, 3, v3
    v_lshl_add_u32 v27, v5, 6, v4
    v_lshrrev_b32 v5, 5, v2
    v_lshl_add_u32 v5, v5, 3, v3
    v_lshlrev_b32 v5, 7, v5
    v_and_b32 v6, 3, v2
    v_lshl_add_u32 v5, v6, 3, v5
    v_bfe_u32 v6, v2, 4, 1
    v_lshl_add_u32 v5, v6, 5, v5
    v_add_u32 v5, 106496, v5
    v_lshrrev_b32 v6, 1, v3
    v_lshl_add_u32 v28, v6, 6, v5
    v_xor_b32 v29, 64, v28
    s_cmp_eq_u32 s48, 0
    s_cbranch_scc1 L_k2_wqk
    v_lshrrev_b32 v4, 3, v2
    v_bfe_u32 v6, v2, 4, 1
    v_lshlrev_b32 v6, 2, v6
    v_and_b32 v5, 7, v2
    v_xor_b32 v5, v5, v6
    v_lshrrev_b32 v6, 1, v5
    v_min_u32 v6, 2, v6
    v_lshlrev_b32 v6, 10, v6
    v_and_b32 v7, 1, v5
    v_lshl_add_u32 v6, v7, 4, v6
    s_lshl_b32 s46, s40, 5
    v_add_u32 v5, s46, v6
    s_lshl_b32 s46, s49, 3
    v_add_u32 v4, s46, v4
    v_mul_lo_u32 v6, v4, s44
    v_add_u32 v12, v6, v5
    v_mov_b32 v13, v12
    s_lshl_b32 s54, s49, 10
    s_add_u32 s54, s54, 8192
    s_branch L_k2_wdonek
L_k2_wqk:
    v_lshrrev_b32 v4, 4, v2
    v_and_b32 v5, 15, v2
    v_lshlrev_b32 v6, 2, v4
    v_xor_b32 v5, v5, v6
    v_lshlrev_b32 v5, 4, v5
    s_lshl_b32 s46, s40, 8
    v_add_u32 v5, s46, v5
    s_lshl_b32 s46, s49, 3
    v_add_u32 v4, s46, v4

    v_add_u32 v6, 0, v4
    v_mul_lo_u32 v6, v6, s44
    v_add_u32 v12, v6, v5
    v_add_u32 v6, 4, v4
    v_mul_lo_u32 v6, v6, s44
    v_add_u32 v13, v6, v5
L_k2_wdonek:
    s_mov_b32 s8, s8
    s_mov_b32 s9, s9
    s_mov_b32 s10, 0x4000
    s_mov_b32 s11, 0x00020000
    v_and_b32 v5, 15, v2
    v_lshlrev_b32 v5, 1, v5
    v_lshrrev_b32 v4, 5, v2
    v_lshl_add_u32 v5, v4, 7, v5
    s_lshl_b32 s3, s40, 9
    v_add_u32 v5, s3, v5

    buffer_load_ushort v40, v5, s[8:11], 0 offen offset:0
    buffer_load_ushort v41, v5, s[8:11], 0 offen offset:32
    buffer_load_ushort v42, v5, s[8:11], 0 offen offset:64
    buffer_load_ushort v43, v5, s[8:11], 0 offen offset:96
    buffer_load_ushort v44, v5, s[8:11], 0 offen offset:256
    buffer_load_ushort v45, v5, s[8:11], 0 offen offset:288
    buffer_load_ushort v46, v5, s[8:11], 0 offen offset:320
    buffer_load_ushort v47, v5, s[8:11], 0 offen offset:352
    s_waitcnt lgkmcnt(5)
    v_mfma_f32_32x32x16_bf16 v[96:111], v[224:227], v[196:199], v[96:111]
    ds_read_b64_tr_b16 v[236:237], v57 offset:20480
    ds_read_b64_tr_b16 v[238:239], v57 offset:21504
    s_waitcnt lgkmcnt(7)
    v_mfma_f32_32x32x16_bf16 v[112:127], v[228:231], v[196:199], v[112:127]
    ds_read_b128 v[212:215], v51 offset:4096
    s_add_u32 m0, s53, 65536
    s_nop 0
    buffer_load_dwordx4 v8, s[24:27], s50 offen lds
    s_waitcnt lgkmcnt(7)
    v_mfma_f32_32x32x16_bf16 v[128:143], v[224:227], v[200:203], v[128:143]
    ds_read_b128 v[216:219], v51 offset:8192
    s_add_u32 m0, s53, 66560
    s_nop 0
    buffer_load_dwordx4 v9, s[24:27], s50 offen lds
    s_waitcnt lgkmcnt(8)
    v_mfma_f32_32x32x16_bf16 v[144:159], v[228:231], v[200:203], v[144:159]
    ds_read_b128 v[220:223], v51 offset:12288
    s_add_u32 m0, s53, 67584
    s_nop 0
    buffer_load_dwordx4 v10, s[24:27], s50 offen lds
    s_waitcnt lgkmcnt(8)
    v_mfma_f32_32x32x16_bf16 v[160:175], v[224:227], v[204:207], v[160:175]
    s_add_u32 m0, s53, 68608
    s_nop 0
    buffer_load_dwordx4 v11, s[24:27], s50 offen lds
    s_add_u32 s50, s50, 128
    s_and_b32 s50, s50, 1023
    v_mfma_f32_32x32x16_bf16 v[176:191], v[228:231], v[204:207], v[176:191]
    s_waitcnt lgkmcnt(5)
    v_mfma_f32_32x32x16_bf16 v[64:79], v[232:235], v[208:211], v[64:79]
    s_waitcnt vmcnt(14)
    s_barrier
    ds_read_b64_tr_b16 v[224:225], v56 offset:32768
    ds_read_b64_tr_b16 v[226:227], v56 offset:33792
    s_waitcnt lgkmcnt(5)
    v_mfma_f32_32x32x16_bf16 v[80:95], v[236:239], v[208:211], v[80:95]
    ds_read_b128 v[192:195], v48 offset:32768
    s_waitcnt lgkmcnt(5)
    v_mfma_f32_32x32x16_bf16 v[96:111], v[232:235], v[212:215], v[96:111]
    ds_read_b64_tr_b16 v[228:229], v57 offset:32768
    ds_read_b64_tr_b16 v[230:231], v57 offset:33792
    s_add_u32 m0, s54, 98304
    s_nop 0
    buffer_load_dwordx4 v12, s[28:31], s51 offen lds
    s_waitcnt lgkmcnt(7)
    v_mfma_f32_32x32x16_bf16 v[112:127], v[236:239], v[212:215], v[112:127]
    ds_read_b128 v[196:199], v48 offset:36864
    s_waitcnt lgkmcnt(7)
    v_mfma_f32_32x32x16_bf16 v[128:143], v[232:235], v[216:219], v[128:143]
    ds_read_b128 v[200:203], v48 offset:40960
    s_cbranch_vccnz L_pw_102
    s_add_u32 m0, s54, 99328
    s_nop 0
    buffer_load_dwordx4 v13, s[28:31], s51 offen lds
L_pw_102:
    s_add_u32 s51, s51, s52
    s_cmp_eq_u32 s51, s55
    s_cselect_b32 s51, 0, s51
    s_waitcnt lgkmcnt(8)
    v_mfma_f32_32x32x16_bf16 v[144:159], v[236:239], v[216:219], v[144:159]
    ds_read_b128 v[204:207], v48 offset:45056
    s_waitcnt lgkmcnt(8)
    v_mfma_f32_32x32x16_bf16 v[160:175], v[232:235], v[220:223], v[160:175]
    v_mfma_f32_32x32x16_bf16 v[176:191], v[236:239], v[220:223], v[176:191]
    s_waitcnt lgkmcnt(5)
    v_mfma_f32_32x32x16_bf16 v[64:79], v[224:227], v[192:195], v[64:79]
    ds_read_b64_tr_b16 v[232:233], v56 offset:36864
    ds_read_b64_tr_b16 v[234:235], v56 offset:37888
    s_waitcnt lgkmcnt(5)
    v_mfma_f32_32x32x16_bf16 v[80:95], v[228:231], v[192:195], v[80:95]
    ds_read_b128 v[208:211], v49 offset:32768
    s_waitcnt lgkmcnt(5)
    v_mfma_f32_32x32x16_bf16 v[96:111], v[224:227], v[196:199], v[96:111]
    ds_read_b64_tr_b16 v[236:237], v57 offset:36864
    ds_read_b64_tr_b16 v[238:239], v57 offset:37888
    s_waitcnt lgkmcnt(7)
    v_mfma_f32_32x32x16_bf16 v[112:127], v[228:231], v[196:199], v[112:127]
    ds_read_b128 v[212:215], v49 offset:36864
    s_waitcnt lgkmcnt(7)
    v_mfma_f32_32x32x16_bf16 v[128:143], v[224:227], v[200:203], v[128:143]
    ds_read_b128 v[216:219], v49 offset:40960
    s_waitcnt lgkmcnt(8)
    v_mfma_f32_32x32x16_bf16 v[144:159], v[228:231], v[200:203], v[144:159]
    ds_read_b128 v[220:223], v49 offset:45056
    s_waitcnt lgkmcnt(8)
    v_mfma_f32_32x32x16_bf16 v[160:175], v[224:227], v[204:207], v[160:175]
    v_mfma_f32_32x32x16_bf16 v[176:191], v[228:231], v[204:207], v[176:191]
    s_waitcnt lgkmcnt(5)
    v_mfma_f32_32x32x16_bf16 v[64:79], v[232:235], v[208:211], v[64:79]
    s_cbranch_vccnz L_vw_103
    s_waitcnt vmcnt(14)
    s_branch L_vw_104
L_vw_103:
    s_waitcnt vmcnt(13)
L_vw_104:
    s_barrier
    ds_read_b64_tr_b16 v[224:225], v56 offset:49152
    ds_read_b64_tr_b16 v[226:227], v56 offset:50176
    s_waitcnt lgkmcnt(5)
    v_mfma_f32_32x32x16_bf16 v[80:95], v[236:239], v[208:211], v[80:95]
    ds_read_b128 v[192:195], v50 offset:32768
    s_waitcnt lgkmcnt(5)
    v_mfma_f32_32x32x16_bf16 v[96:111], v[232:235], v[212:215], v[96:111]
    ds_read_b64_tr_b16 v[228:229], v57 offset:49152
    ds_read_b64_tr_b16 v[230:231], v57 offset:50176
    s_add_u32 m0, s54, 114688
    s_nop 0
    buffer_load_dwordx4 v12, s[28:31], s51 offen lds
    s_waitcnt lgkmcnt(7)
    v_mfma_f32_32x32x16_bf16 v[112:127], v[236:239], v[212:215], v[112:127]
    ds_read_b128 v[196:199], v50 offset:36864
    s_waitcnt lgkmcnt(7)
    v_mfma_f32_32x32x16_bf16 v[128:143], v[232:235], v[216:219], v[128:143]
    ds_read_b128 v[200:203], v50 offset:40960
    s_cbranch_vccnz L_pw_105
    s_add_u32 m0, s54, 115712
    s_nop 0
    buffer_load_dwordx4 v13, s[28:31], s51 offen lds
L_pw_105:
    s_add_u32 s51, s51, s52
    s_cmp_eq_u32 s51, s55
    s_cselect_b32 s51, 0, s51
    s_waitcnt lgkmcnt(8)
    v_mfma_f32_32x32x16_bf16 v[144:159], v[236:239], v[216:219], v[144:159]
    ds_read_b128 v[204:207], v50 offset:45056
    s_waitcnt lgkmcnt(8)
    v_mfma_f32_32x32x16_bf16 v[160:175], v[232:235], v[220:223], v[160:175]
    v_mfma_f32_32x32x16_bf16 v[176:191], v[236:239], v[220:223], v[176:191]
    s_waitcnt lgkmcnt(5)
    v_mfma_f32_32x32x16_bf16 v[64:79], v[224:227], v[192:195], v[64:79]
    ds_read_b64_tr_b16 v[232:233], v56 offset:53248
    ds_read_b64_tr_b16 v[234:235], v56 offset:54272
    s_waitcnt lgkmcnt(5)
    v_mfma_f32_32x32x16_bf16 v[80:95], v[228:231], v[192:195], v[80:95]
    ds_read_b128 v[208:211], v51 offset:32768
    s_add_u32 m0, s53, 0
    s_nop 0
    buffer_load_dwordx4 v8, s[24:27], s50 offen lds
    s_waitcnt lgkmcnt(5)
    v_mfma_f32_32x32x16_bf16 v[96:111], v[224:227], v[196:199], v[96:111]
    ds_read_b64_tr_b16 v[236:237], v57 offset:53248
    ds_read_b64_tr_b16 v[238:239], v57 offset:54272
    s_add_u32 m0, s53, 1024
    s_nop 0
    buffer_load_dwordx4 v9, s[24:27], s50 offen lds
    s_waitcnt lgkmcnt(7)
    v_mfma_f32_32x32x16_bf16 v[112:127], v[228:231], v[196:199], v[112:127]
    ds_read_b128 v[212:215], v51 offset:36864
    s_add_u32 m0, s53, 2048
    s_nop 0
    buffer_load_dwordx4 v10, s[24:27], s50 offen lds
    s_waitcnt lgkmcnt(7)
    v_mfma_f32_32x32x16_bf16 v[128:143], v[224:227], v[200:203], v[128:143]
    ds_read_b128 v[216:219], v51 offset:40960
    s_add_u32 m0, s53, 3072
    s_nop 0
    buffer_load_dwordx4 v11, s[24:27], s50 offen lds
    s_add_u32 s50, s50, 128
    s_and_b32 s50, s50, 1023
    s_waitcnt lgkmcnt(8)
    v_mfma_f32_32x32x16_bf16 v[144:159], v[228:231], v[200:203], v[144:159]
    ds_read_b128 v[220:223], v51 offset:45056
    s_waitcnt lgkmcnt(8)
    v_mfma_f32_32x32x16_bf16 v[160:175], v[224:227], v[204:207], v[160:175]
    v_mfma_f32_32x32x16_bf16 v[176:191], v[228:231], v[204:207], v[176:191]
    s_waitcnt lgkmcnt(5)
    v_mfma_f32_32x32x16_bf16 v[64:79], v[232:235], v[208:211], v[64:79]
    s_waitcnt lgkmcnt(3)
    v_mfma_f32_32x32x16_bf16 v[80:95], v[236:239], v[208:211], v[80:95]
    s_waitcnt lgkmcnt(2)
    v_mfma_f32_32x32x16_bf16 v[96:111], v[232:235], v[212:215], v[96:111]
    v_mfma_f32_32x32x16_bf16 v[112:127], v[236:239], v[212:215], v[112:127]
    s_waitcnt lgkmcnt(1)
    v_mfma_f32_32x32x16_bf16 v[128:143], v[232:235], v[216:219], v[128:143]
    v_mfma_f32_32x32x16_bf16 v[144:159], v[236:239], v[216:219], v[144:159]
    s_waitcnt lgkmcnt(0)
    v_mfma_f32_32x32x16_bf16 v[160:175], v[232:235], v[220:223], v[160:175]
    v_mfma_f32_32x32x16_bf16 v[176:191], v[236:239], v[220:223], v[176:191]
    s_nop 15
    v_cvt_pk_bf16_f32 v216, v64, v65
    v_cvt_pk_bf16_f32 v217, v66, v67
    v_cvt_pk_bf16_f32 v218, v68, v69
    v_cvt_pk_bf16_f32 v219, v70, v71
    v_cvt_pk_bf16_f32 v220, v72, v73
    v_cvt_pk_bf16_f32 v221, v74, v75
    v_cvt_pk_bf16_f32 v222, v76, v77
    v_cvt_pk_bf16_f32 v223, v78, v79
    v_cvt_pk_bf16_f32 v224, v80, v81
    v_cvt_pk_bf16_f32 v225, v82, v83
    v_cvt_pk_bf16_f32 v226, v84, v85
    v_cvt_pk_bf16_f32 v227, v86, v87
    v_cvt_pk_bf16_f32 v228, v88, v89
    v_cvt_pk_bf16_f32 v229, v90, v91
    v_cvt_pk_bf16_f32 v230, v92, v93
    v_cvt_pk_bf16_f32 v231, v94, v95
    v_cvt_pk_bf16_f32 v232, v96, v97
    v_cvt_pk_bf16_f32 v233, v98, v99
    v_cvt_pk_bf16_f32 v234, v100, v101
    v_cvt_pk_bf16_f32 v235, v102, v103
    v_cvt_pk_bf16_f32 v236, v104, v105
    v_cvt_pk_bf16_f32 v237, v106, v107
    v_cvt_pk_bf16_f32 v238, v108, v109
    v_cvt_pk_bf16_f32 v239, v110, v111
    v_cvt_pk_bf16_f32 v240, v112, v113
    v_cvt_pk_bf16_f32 v241, v114, v115
    v_cvt_pk_bf16_f32 v242, v116, v117
    v_cvt_pk_bf16_f32 v243, v118, v119
    v_cvt_pk_bf16_f32 v244, v120, v121
    v_cvt_pk_bf16_f32 v245, v122, v123
    v_cvt_pk_bf16_f32 v246, v124, v125
    v_cvt_pk_bf16_f32 v247, v126, v127
    v_cvt_pk_bf16_f32 v248, v128, v129
    v_cvt_pk_bf16_f32 v249, v130, v131
    v_cvt_pk_bf16_f32 v250, v132, v133
    v_cvt_pk_bf16_f32 v251, v134, v135
    v_cvt_pk_bf16_f32 v252, v136, v137
    v_cvt_pk_bf16_f32 v253, v138, v139
    v_cvt_pk_bf16_f32 v254, v140, v141
    v_cvt_pk_bf16_f32 v255, v142, v143
    v_cvt_pk_bf16_f32 v48, v144, v145
    v_cvt_pk_bf16_f32 v49, v146, v147
    v_cvt_pk_bf16_f32 v50, v148, v149
    v_cvt_pk_bf16_f32 v51, v150, v151
    v_cvt_pk_bf16_f32 v52, v152, v153
    v_cvt_pk_bf16_f32 v53, v154, v155
    v_cvt_pk_bf16_f32 v54, v156, v157
    v_cvt_pk_bf16_f32 v55, v158, v159
    v_cvt_pk_bf16_f32 v56, v160, v161
    v_cvt_pk_bf16_f32 v57, v162, v163
    v_cvt_pk_bf16_f32 v58, v164, v165
    v_cvt_pk_bf16_f32 v59, v166, v167
    v_cvt_pk_bf16_f32 v60, v168, v169
    v_cvt_pk_bf16_f32 v61, v170, v171
    v_cvt_pk_bf16_f32 v62, v172, v173
    v_cvt_pk_bf16_f32 v63, v174, v175
    v_cvt_pk_bf16_f32 v32, v176, v177
    v_cvt_pk_bf16_f32 v33, v178, v179
    v_cvt_pk_bf16_f32 v34, v180, v181
    v_cvt_pk_bf16_f32 v35, v182, v183
    v_cvt_pk_bf16_f32 v36, v184, v185
    v_cvt_pk_bf16_f32 v37, v186, v187
    v_cvt_pk_bf16_f32 v38, v188, v189
    v_cvt_pk_bf16_f32 v39, v190, v191
    s_branch L_k1_q
L_k1_vtype:
    s_lshl_b32 s46, s57, 19
    s_add_u32 s46, s46, 0x2000000
    s_lshl_b32 s47, s41, 16
    s_add_u32 s46, s46, s47
    s_lshl_b32 s47, s48, 15
    s_add_u32 s46, s46, s47
    s_lshl_b32 s47, s49, 11
    s_add_u32 s46, s46, s47
    v_lshlrev_b32 v5, 4, v2

    s_mov_b32 s90, s46
    v_mov_b32 v14, v5
    v_add_u32 v15, 4096, v5
    s_waitcnt vmcnt(8)
    s_barrier
    ds_read_b64_tr_b16 v[224:225], v56 offset:0
    ds_read_b64_tr_b16 v[226:227], v56 offset:1024
    ds_read_b128 v[192:195], v48 offset:0
    ds_read_b64_tr_b16 v[228:229], v57 offset:0
    ds_read_b64_tr_b16 v[230:231], v57 offset:1024
    ds_read_b128 v[196:199], v48 offset:4096
    ds_read_b128 v[200:203], v48 offset:8192
    ds_read_b128 v[204:207], v48 offset:12288
    s_waitcnt lgkmcnt(5)
    v_mfma_f32_32x32x16_bf16 v[64:79], v[192:195], v[224:227], 0
    ds_read_b64_tr_b16 v[232:233], v56 offset:4096
    ds_read_b64_tr_b16 v[234:235], v56 offset:5120
    s_waitcnt lgkmcnt(5)
    v_mfma_f32_32x32x16_bf16 v[80:95], v[192:195], v[228:231], 0
    ds_read_b128 v[208:211], v49 offset:0
    s_waitcnt lgkmcnt(5)
    v_mfma_f32_32x32x16_bf16 v[96:111], v[196:199], v[224:227], 0
    ds_read_b64_tr_b16 v[236:237], v57 offset:4096
    ds_read_b64_tr_b16 v[238:239], v57 offset:5120
    s_waitcnt lgkmcnt(7)
    v_mfma_f32_32x32x16_bf16 v[112:127], v[196:199], v[228:231], 0
    ds_read_b128 v[212:215], v49 offset:4096
    s_waitcnt lgkmcnt(7)
    v_mfma_f32_32x32x16_bf16 v[128:143], v[200:203], v[224:227], 0
    ds_read_b128 v[216:219], v49 offset:8192
    s_waitcnt lgkmcnt(8)
    v_mfma_f32_32x32x16_bf16 v[144:159], v[200:203], v[228:231], 0
    ds_read_b128 v[220:223], v49 offset:12288
    s_waitcnt lgkmcnt(8)
    v_mfma_f32_32x32x16_bf16 v[160:175], v[204:207], v[224:227], 0
    v_mfma_f32_32x32x16_bf16 v[176:191], v[204:207], v[228:231], 0
    s_waitcnt lgkmcnt(5)
    v_mfma_f32_32x32x16_bf16 v[64:79], v[208:211], v[232:235], v[64:79]
    s_waitcnt vmcnt(4)
    s_barrier
    ds_read_b64_tr_b16 v[224:225], v56 offset:16384
    ds_read_b64_tr_b16 v[226:227], v56 offset:17408
    s_cbranch_vccnz L_sk_106
    s_add_u32 m0, s54, 147456
    s_nop 0
    buffer_load_dwordx4 v12, s[28:31], s51 offen lds
L_sk_106:
    s_waitcnt lgkmcnt(5)
    v_mfma_f32_32x32x16_bf16 v[80:95], v[208:211], v[236:239], v[80:95]
    ds_read_b128 v[192:195], v50 offset:0
    s_waitcnt lgkmcnt(5)
    v_mfma_f32_32x32x16_bf16 v[96:111], v[212:215], v[232:235], v[96:111]
    ds_read_b64_tr_b16 v[228:229], v57 offset:16384
    ds_read_b64_tr_b16 v[230:231], v57 offset:17408
    s_cbranch_vccz L_sk_107
    s_add_u32 m0, s54, 147456
    s_nop 0
    buffer_load_dwordx4 v12, s[28:31], s51 offen lds
L_sk_107:
    s_waitcnt lgkmcnt(7)
    v_mfma_f32_32x32x16_bf16 v[112:127], v[212:215], v[236:239], v[112:127]
    ds_read_b128 v[196:199], v50 offset:4096
    s_waitcnt lgkmcnt(7)
    v_mfma_f32_32x32x16_bf16 v[128:143], v[216:219], v[232:235], v[128:143]
    ds_read_b128 v[200:203], v50 offset:8192
    s_cbranch_vccnz L_sk_108
    s_add_u32 m0, s54, 148480
    s_nop 0
    buffer_load_dwordx4 v13, s[28:31], s51 offen lds
    s_add_u32 s51, s51, s52
    s_cmp_eq_u32 s51, s55
    s_cselect_b32 s51, 0, s51
L_sk_108:
    s_waitcnt lgkmcnt(8)
    v_mfma_f32_32x32x16_bf16 v[144:159], v[216:219], v[236:239], v[144:159]
    ds_read_b128 v[204:207], v50 offset:12288
    s_waitcnt lgkmcnt(8)
    v_mfma_f32_32x32x16_bf16 v[160:175], v[220:223], v[232:235], v[160:175]
    s_cbranch_vccz L_sk_109
    s_add_u32 m0, s54, 148480
    s_nop 0
    buffer_load_dwordx4 v13, s[28:31], s51 offen lds
    s_add_u32 s51, s51, s52
    s_cmp_eq_u32 s51, s55
    s_cselect_b32 s51, 0, s51
L_sk_109:
    v_mfma_f32_32x32x16_bf16 v[176:191], v[220:223], v[236:239], v[176:191]
    s_waitcnt lgkmcnt(5)
    v_mfma_f32_32x32x16_bf16 v[64:79], v[192:195], v[224:227], v[64:79]
    ds_read_b64_tr_b16 v[232:233], v56 offset:20480
    ds_read_b64_tr_b16 v[234:235], v56 offset:21504
    s_cbranch_vccnz L_sk_110
    s_add_u32 m0, s53, 65536
    s_nop 0
    buffer_load_dwordx4 v8, s[24:27], s50 offen lds
L_sk_110:
    s_waitcnt lgkmcnt(5)
    v_mfma_f32_32x32x16_bf16 v[80:95], v[192:195], v[228:231], v[80:95]
    ds_read_b128 v[208:211], v51 offset:0
    s_waitcnt lgkmcnt(5)
    v_mfma_f32_32x32x16_bf16 v[96:111], v[196:199], v[224:227], v[96:111]
    ds_read_b64_tr_b16 v[236:237], v57 offset:20480
    ds_read_b64_tr_b16 v[238:239], v57 offset:21504
    s_cbranch_vccz L_sk_111
    s_add_u32 m0, s53, 65536
    s_nop 0
    buffer_load_dwordx4 v8, s[24:27], s50 offen lds
L_sk_111:
    s_waitcnt lgkmcnt(7)
    v_mfma_f32_32x32x16_bf16 v[112:127], v[196:199], v[228:231], v[112:127]
    ds_read_b128 v[212:215], v51 offset:4096
    s_waitcnt lgkmcnt(7)
    v_mfma_f32_32x32x16_bf16 v[128:143], v[200:203], v[224:227], v[128:143]
    ds_read_b128 v[216:219], v51 offset:8192
    s_cbranch_vccnz L_sk_112
    s_add_u32 m0, s53, 66560
    s_nop 0
    buffer_load_dwordx4 v9, s[24:27], s50 offen lds
L_sk_112:
    s_waitcnt lgkmcnt(8)
    v_mfma_f32_32x32x16_bf16 v[144:159], v[200:203], v[228:231], v[144:159]
    ds_read_b128 v[220:223], v51 offset:12288
    s_waitcnt lgkmcnt(8)
    v_mfma_f32_32x32x16_bf16 v[160:175], v[204:207], v[224:227], v[160:175]
    s_cbranch_vccz L_sk_113
    s_add_u32 m0, s53, 66560
    s_nop 0
    buffer_load_dwordx4 v9, s[24:27], s50 offen lds
L_sk_113:
    v_mfma_f32_32x32x16_bf16 v[176:191], v[204:207], v[228:231], v[176:191]
    s_waitcnt lgkmcnt(5)
    v_mfma_f32_32x32x16_bf16 v[64:79], v[208:211], v[232:235], v[64:79]
    s_waitcnt vmcnt(4)
    s_barrier
    ds_read_b64_tr_b16 v[224:225], v56 offset:32768
    ds_read_b64_tr_b16 v[226:227], v56 offset:33792
    s_cbranch_vccnz L_sk_114
    s_add_u32 m0, s54, 98304
    s_nop 0
    buffer_load_dwordx4 v12, s[28:31], s51 offen lds
L_sk_114:
    s_waitcnt lgkmcnt(5)
    v_mfma_f32_32x32x16_bf16 v[80:95], v[208:211], v[236:239], v[80:95]
    ds_read_b128 v[192:195], v48 offset:32768
    s_waitcnt lgkmcnt(5)
    v_mfma_f32_32x32x16_bf16 v[96:111], v[212:215], v[232:235], v[96:111]
    ds_read_b64_tr_b16 v[228:229], v57 offset:32768
    ds_read_b64_tr_b16 v[230:231], v57 offset:33792
    s_cbranch_vccz L_sk_115
    s_add_u32 m0, s54, 98304
    s_nop 0
    buffer_load_dwordx4 v12, s[28:31], s51 offen lds
L_sk_115:
    s_waitcnt lgkmcnt(7)
    v_mfma_f32_32x32x16_bf16 v[112:127], v[212:215], v[236:239], v[112:127]
    ds_read_b128 v[196:199], v48 offset:36864
    s_waitcnt lgkmcnt(7)
    v_mfma_f32_32x32x16_bf16 v[128:143], v[216:219], v[232:235], v[128:143]
    ds_read_b128 v[200:203], v48 offset:40960
    s_cbranch_vccnz L_sk_116
    s_add_u32 m0, s54, 99328
    s_nop 0
    buffer_load_dwordx4 v13, s[28:31], s51 offen lds
    s_add_u32 s51, s51, s52
    s_cmp_eq_u32 s51, s55
    s_cselect_b32 s51, 0, s51
L_sk_116:
    s_waitcnt lgkmcnt(8)
    v_mfma_f32_32x32x16_bf16 v[144:159], v[216:219], v[236:239], v[144:159]
    ds_read_b128 v[204:207], v48 offset:45056
    s_waitcnt lgkmcnt(8)
    v_mfma_f32_32x32x16_bf16 v[160:175], v[220:223], v[232:235], v[160:175]
    s_cbranch_vccz L_sk_117
    s_add_u32 m0, s54, 99328
    s_nop 0
    buffer_load_dwordx4 v13, s[28:31], s51 offen lds
    s_add_u32 s51, s51, s52
    s_cmp_eq_u32 s51, s55
    s_cselect_b32 s51, 0, s51
L_sk_117:
    v_mfma_f32_32x32x16_bf16 v[176:191], v[220:223], v[236:239], v[176:191]
    s_waitcnt lgkmcnt(5)
    v_mfma_f32_32x32x16_bf16 v[64:79], v[192:195], v[224:227], v[64:79]
    ds_read_b64_tr_b16 v[232:233], v56 offset:36864
    ds_read_b64_tr_b16 v[234:235], v56 offset:37888
    s_cbranch_vccnz L_sk_118
    s_add_u32 m0, s53, 67584
    s_nop 0
    buffer_load_dwordx4 v10, s[24:27], s50 offen lds
L_sk_118:
    s_waitcnt lgkmcnt(5)
    v_mfma_f32_32x32x16_bf16 v[80:95], v[192:195], v[228:231], v[80:95]
    ds_read_b128 v[208:211], v49 offset:32768
    s_waitcnt lgkmcnt(5)
    v_mfma_f32_32x32x16_bf16 v[96:111], v[196:199], v[224:227], v[96:111]
    ds_read_b64_tr_b16 v[236:237], v57 offset:36864
    ds_read_b64_tr_b16 v[238:239], v57 offset:37888
    s_cbranch_vccz L_sk_119
    s_add_u32 m0, s53, 67584
    s_nop 0
    buffer_load_dwordx4 v10, s[24:27], s50 offen lds
L_sk_119:
    s_waitcnt lgkmcnt(7)
    v_mfma_f32_32x32x16_bf16 v[112:127], v[196:199], v[228:231], v[112:127]
    ds_read_b128 v[212:215], v49 offset:36864
    s_waitcnt lgkmcnt(7)
    v_mfma_f32_32x32x16_bf16 v[128:143], v[200:203], v[224:227], v[128:143]
    ds_read_b128 v[216:219], v49 offset:40960
    s_cbranch_vccnz L_sk_120
    s_add_u32 m0, s53, 68608
    s_nop 0
    buffer_load_dwordx4 v11, s[24:27], s50 offen lds
    s_add_u32 s50, s50, 128
    s_and_b32 s50, s50, 1023
L_sk_120:
    s_waitcnt lgkmcnt(8)
    v_mfma_f32_32x32x16_bf16 v[144:159], v[200:203], v[228:231], v[144:159]
    ds_read_b128 v[220:223], v49 offset:45056
    s_waitcnt lgkmcnt(8)
    v_mfma_f32_32x32x16_bf16 v[160:175], v[204:207], v[224:227], v[160:175]
    s_cbranch_vccz L_sk_121
    s_add_u32 m0, s53, 68608
    s_nop 0
    buffer_load_dwordx4 v11, s[24:27], s50 offen lds
    s_add_u32 s50, s50, 128
    s_and_b32 s50, s50, 1023
L_sk_121:
    v_mfma_f32_32x32x16_bf16 v[176:191], v[204:207], v[228:231], v[176:191]
    s_waitcnt lgkmcnt(5)
    v_mfma_f32_32x32x16_bf16 v[64:79], v[208:211], v[232:235], v[64:79]
    s_waitcnt vmcnt(4)
    s_barrier
    ds_read_b64_tr_b16 v[224:225], v56 offset:49152
    ds_read_b64_tr_b16 v[226:227], v56 offset:50176
    s_cbranch_vccnz L_sk_122
    s_add_u32 m0, s54, 114688
    s_nop 0
    buffer_load_dwordx4 v12, s[28:31], s51 offen lds
L_sk_122:
    s_waitcnt lgkmcnt(5)
    v_mfma_f32_32x32x16_bf16 v[80:95], v[208:211], v[236:239], v[80:95]
    ds_read_b128 v[192:195], v50 offset:32768
    s_waitcnt lgkmcnt(5)
    v_mfma_f32_32x32x16_bf16 v[96:111], v[212:215], v[232:235], v[96:111]
    ds_read_b64_tr_b16 v[228:229], v57 offset:49152
    ds_read_b64_tr_b16 v[230:231], v57 offset:50176
    s_cbranch_vccz L_sk_123
    s_add_u32 m0, s54, 114688
    s_nop 0
    buffer_load_dwordx4 v12, s[28:31], s51 offen lds
L_sk_123:
    s_waitcnt lgkmcnt(7)
    v_mfma_f32_32x32x16_bf16 v[112:127], v[212:215], v[236:239], v[112:127]
    ds_read_b128 v[196:199], v50 offset:36864
    s_waitcnt lgkmcnt(7)
    v_mfma_f32_32x32x16_bf16 v[128:143], v[216:219], v[232:235], v[128:143]
    ds_read_b128 v[200:203], v50 offset:40960
    s_cbranch_vccnz L_sk_124
    s_add_u32 m0, s54, 115712
    s_nop 0
    buffer_load_dwordx4 v13, s[28:31], s51 offen lds
    s_add_u32 s51, s51, s52
    s_cmp_eq_u32 s51, s55
    s_cselect_b32 s51, 0, s51
L_sk_124:
    s_waitcnt lgkmcnt(8)
    v_mfma_f32_32x32x16_bf16 v[144:159], v[216:219], v[236:239], v[144:159]
    ds_read_b128 v[204:207], v50 offset:45056
    s_waitcnt lgkmcnt(8)
    v_mfma_f32_32x32x16_bf16 v[160:175], v[220:223], v[232:235], v[160:175]
    s_cbranch_vccz L_sk_125
    s_add_u32 m0, s54, 115712
    s_nop 0
    buffer_load_dwordx4 v13, s[28:31], s51 offen lds
    s_add_u32 s51, s51, s52
    s_cmp_eq_u32 s51, s55
    s_cselect_b32 s51, 0, s51
L_sk_125:
    v_mfma_f32_32x32x16_bf16 v[176:191], v[220:223], v[236:239], v[176:191]
    s_waitcnt lgkmcnt(5)
    v_mfma_f32_32x32x16_bf16 v[64:79], v[192:195], v[224:227], v[64:79]
    ds_read_b64_tr_b16 v[232:233], v56 offset:53248
    ds_read_b64_tr_b16 v[234:235], v56 offset:54272
    s_cbranch_vccnz L_sk_126
    s_add_u32 m0, s53, 0
    s_nop 0
    buffer_load_dwordx4 v8, s[24:27], s50 offen lds
L_sk_126:
    s_waitcnt lgkmcnt(5)
    v_mfma_f32_32x32x16_bf16 v[80:95], v[192:195], v[228:231], v[80:95]
    ds_read_b128 v[208:211], v51 offset:32768
    s_waitcnt lgkmcnt(5)
    v_mfma_f32_32x32x16_bf16 v[96:111], v[196:199], v[224:227], v[96:111]
    ds_read_b64_tr_b16 v[236:237], v57 offset:53248
    ds_read_b64_tr_b16 v[238:239], v57 offset:54272
    s_cbranch_vccz L_sk_127
    s_add_u32 m0, s53, 0
    s_nop 0
    buffer_load_dwordx4 v8, s[24:27], s50 offen lds
L_sk_127:
    s_waitcnt lgkmcnt(7)
    v_mfma_f32_32x32x16_bf16 v[112:127], v[196:199], v[228:231], v[112:127]
    ds_read_b128 v[212:215], v51 offset:36864
    s_waitcnt lgkmcnt(7)
    v_mfma_f32_32x32x16_bf16 v[128:143], v[200:203], v[224:227], v[128:143]
    ds_read_b128 v[216:219], v51 offset:40960
    s_cbranch_vccnz L_sk_128
    s_add_u32 m0, s53, 1024
    s_nop 0
    buffer_load_dwordx4 v9, s[24:27], s50 offen lds
L_sk_128:
    s_waitcnt lgkmcnt(8)
    v_mfma_f32_32x32x16_bf16 v[144:159], v[200:203], v[228:231], v[144:159]
    ds_read_b128 v[220:223], v51 offset:45056
    s_waitcnt lgkmcnt(8)
    v_mfma_f32_32x32x16_bf16 v[160:175], v[204:207], v[224:227], v[160:175]
    s_cbranch_vccz L_sk_129
    s_add_u32 m0, s53, 1024
    s_nop 0
    buffer_load_dwordx4 v9, s[24:27], s50 offen lds
L_sk_129:
    v_mfma_f32_32x32x16_bf16 v[176:191], v[204:207], v[228:231], v[176:191]
    s_waitcnt lgkmcnt(5)
    v_mfma_f32_32x32x16_bf16 v[64:79], v[208:211], v[232:235], v[64:79]
    s_waitcnt vmcnt(4)
    s_barrier
    ds_read_b64_tr_b16 v[224:225], v56 offset:0
    ds_read_b64_tr_b16 v[226:227], v56 offset:1024
    s_cbranch_vccnz L_sk_130
    s_add_u32 m0, s54, 131072
    s_nop 0
    buffer_load_dwordx4 v12, s[28:31], s51 offen lds
L_sk_130:
    s_waitcnt lgkmcnt(5)
    v_mfma_f32_32x32x16_bf16 v[80:95], v[208:211], v[236:239], v[80:95]
    ds_read_b128 v[192:195], v52 offset:0
    s_waitcnt lgkmcnt(5)
    v_mfma_f32_32x32x16_bf16 v[96:111], v[212:215], v[232:235], v[96:111]
    ds_read_b64_tr_b16 v[228:229], v57 offset:0
    ds_read_b64_tr_b16 v[230:231], v57 offset:1024
    s_cbranch_vccz L_sk_131
    s_add_u32 m0, s54, 131072
    s_nop 0
    buffer_load_dwordx4 v12, s[28:31], s51 offen lds
L_sk_131:
    s_waitcnt lgkmcnt(7)
    v_mfma_f32_32x32x16_bf16 v[112:127], v[212:215], v[236:239], v[112:127]
    ds_read_b128 v[196:199], v52 offset:4096
    s_waitcnt lgkmcnt(7)
    v_mfma_f32_32x32x16_bf16 v[128:143], v[216:219], v[232:235], v[128:143]
    ds_read_b128 v[200:203], v52 offset:8192
    s_cbranch_vccnz L_sk_132
    s_add_u32 m0, s54, 132096
    s_nop 0
    buffer_load_dwordx4 v13, s[28:31], s51 offen lds
    s_add_u32 s51, s51, s52
    s_cmp_eq_u32 s51, s55
    s_cselect_b32 s51, 0, s51
L_sk_132:
    s_waitcnt lgkmcnt(8)
    v_mfma_f32_32x32x16_bf16 v[144:159], v[216:219], v[236:239], v[144:159]
    ds_read_b128 v[204:207], v52 offset:12288
    s_waitcnt lgkmcnt(8)
    v_mfma_f32_32x32x16_bf16 v[160:175], v[220:223], v[232:235], v[160:175]
    s_cbranch_vccz L_sk_133
    s_add_u32 m0, s54, 132096
    s_nop 0
    buffer_load_dwordx4 v13, s[28:31], s51 offen lds
    s_add_u32 s51, s51, s52
    s_cmp_eq_u32 s51, s55
    s_cselect_b32 s51, 0, s51
L_sk_133:
    v_mfma_f32_32x32x16_bf16 v[176:191], v[220:223], v[236:239], v[176:191]
    s_waitcnt lgkmcnt(5)
    v_mfma_f32_32x32x16_bf16 v[64:79], v[192:195], v[224:227], v[64:79]
    ds_read_b64_tr_b16 v[232:233], v56 offset:4096
    ds_read_b64_tr_b16 v[234:235], v56 offset:5120
    s_cbranch_vccnz L_sk_134
    s_add_u32 m0, s53, 2048
    s_nop 0
    buffer_load_dwordx4 v10, s[24:27], s50 offen lds
L_sk_134:
    s_waitcnt lgkmcnt(5)
    v_mfma_f32_32x32x16_bf16 v[80:95], v[192:195], v[228:231], v[80:95]
    ds_read_b128 v[208:211], v53 offset:0
    s_waitcnt lgkmcnt(5)
    v_mfma_f32_32x32x16_bf16 v[96:111], v[196:199], v[224:227], v[96:111]
    ds_read_b64_tr_b16 v[236:237], v57 offset:4096
    ds_read_b64_tr_b16 v[238:239], v57 offset:5120
    s_cbranch_vccz L_sk_135
    s_add_u32 m0, s53, 2048
    s_nop 0
    buffer_load_dwordx4 v10, s[24:27], s50 offen lds
L_sk_135:
    s_waitcnt lgkmcnt(7)
    v_mfma_f32_32x32x16_bf16 v[112:127], v[196:199], v[228:231], v[112:127]
    ds_read_b128 v[212:215], v53 offset:4096
    s_waitcnt lgkmcnt(7)
    v_mfma_f32_32x32x16_bf16 v[128:143], v[200:203], v[224:227], v[128:143]
    ds_read_b128 v[216:219], v53 offset:8192
    s_cbranch_vccnz L_sk_136
    s_add_u32 m0, s53, 3072
    s_nop 0
    buffer_load_dwordx4 v11, s[24:27], s50 offen lds
    s_add_u32 s50, s50, 128
    s_and_b32 s50, s50, 1023
L_sk_136:
    s_waitcnt lgkmcnt(8)
    v_mfma_f32_32x32x16_bf16 v[144:159], v[200:203], v[228:231], v[144:159]
    ds_read_b128 v[220:223], v53 offset:12288
    s_waitcnt lgkmcnt(8)
    v_mfma_f32_32x32x16_bf16 v[160:175], v[204:207], v[224:227], v[160:175]
    s_cbranch_vccz L_sk_137
    s_add_u32 m0, s53, 3072
    s_nop 0
    buffer_load_dwordx4 v11, s[24:27], s50 offen lds
    s_add_u32 s50, s50, 128
    s_and_b32 s50, s50, 1023
L_sk_137:
    v_mfma_f32_32x32x16_bf16 v[176:191], v[204:207], v[228:231], v[176:191]
    s_waitcnt lgkmcnt(5)
    v_mfma_f32_32x32x16_bf16 v[64:79], v[208:211], v[232:235], v[64:79]
    s_waitcnt vmcnt(4)
    s_barrier
    ds_read_b64_tr_b16 v[224:225], v56 offset:16384
    ds_read_b64_tr_b16 v[226:227], v56 offset:17408
    s_cbranch_vccnz L_sk_138
    s_add_u32 m0, s54, 147456
    s_nop 0
    buffer_load_dwordx4 v12, s[28:31], s51 offen lds
L_sk_138:
    s_waitcnt lgkmcnt(5)
    v_mfma_f32_32x32x16_bf16 v[80:95], v[208:211], v[236:239], v[80:95]
    ds_read_b128 v[192:195], v54 offset:0
    s_waitcnt lgkmcnt(5)
    v_mfma_f32_32x32x16_bf16 v[96:111], v[212:215], v[232:235], v[96:111]
    ds_read_b64_tr_b16 v[228:229], v57 offset:16384
    ds_read_b64_tr_b16 v[230:231], v57 offset:17408
    s_cbranch_vccz L_sk_139
    s_add_u32 m0, s54, 147456
    s_nop 0
    buffer_load_dwordx4 v12, s[28:31], s51 offen lds
L_sk_139:
    s_waitcnt lgkmcnt(7)
    v_mfma_f32_32x32x16_bf16 v[112:127], v[212:215], v[236:239], v[112:127]
    ds_read_b128 v[196:199], v54 offset:4096
    s_waitcnt lgkmcnt(7)
    v_mfma_f32_32x32x16_bf16 v[128:143], v[216:219], v[232:235], v[128:143]
    ds_read_b128 v[200:203], v54 offset:8192
    s_cbranch_vccnz L_sk_140
    s_add_u32 m0, s54, 148480
    s_nop 0
    buffer_load_dwordx4 v13, s[28:31], s51 offen lds
    s_add_u32 s51, s51, s52
    s_cmp_eq_u32 s51, s55
    s_cselect_b32 s51, 0, s51
L_sk_140:
    s_waitcnt lgkmcnt(8)
    v_mfma_f32_32x32x16_bf16 v[144:159], v[216:219], v[236:239], v[144:159]
    ds_read_b128 v[204:207], v54 offset:12288
    s_waitcnt lgkmcnt(8)
    v_mfma_f32_32x32x16_bf16 v[160:175], v[220:223], v[232:235], v[160:175]
    s_cbranch_vccz L_sk_141
    s_add_u32 m0, s54, 148480
    s_nop 0
    buffer_load_dwordx4 v13, s[28:31], s51 offen lds
    s_add_u32 s51, s51, s52
    s_cmp_eq_u32 s51, s55
    s_cselect_b32 s51, 0, s51
L_sk_141:
    v_mfma_f32_32x32x16_bf16 v[176:191], v[220:223], v[236:239], v[176:191]
    s_waitcnt lgkmcnt(5)
    v_mfma_f32_32x32x16_bf16 v[64:79], v[192:195], v[224:227], v[64:79]
    ds_read_b64_tr_b16 v[232:233], v56 offset:20480
    ds_read_b64_tr_b16 v[234:235], v56 offset:21504
    s_cbranch_vccnz L_sk_142
    s_add_u32 m0, s53, 32768
    s_nop 0
    buffer_load_dwordx4 v8, s[24:27], s50 offen lds
L_sk_142:
    s_waitcnt lgkmcnt(5)
    v_mfma_f32_32x32x16_bf16 v[80:95], v[192:195], v[228:231], v[80:95]
    ds_read_b128 v[208:211], v55 offset:0
    s_waitcnt lgkmcnt(5)
    v_mfma_f32_32x32x16_bf16 v[96:111], v[196:199], v[224:227], v[96:111]
    ds_read_b64_tr_b16 v[236:237], v57 offset:20480
    ds_read_b64_tr_b16 v[238:239], v57 offset:21504
    s_cbranch_vccz L_sk_143
    s_add_u32 m0, s53, 32768
    s_nop 0
    buffer_load_dwordx4 v8, s[24:27], s50 offen lds
L_sk_143:
    s_waitcnt lgkmcnt(7)
    v_mfma_f32_32x32x16_bf16 v[112:127], v[196:199], v[228:231], v[112:127]
    ds_read_b128 v[212:215], v55 offset:4096
    s_waitcnt lgkmcnt(7)
    v_mfma_f32_32x32x16_bf16 v[128:143], v[200:203], v[224:227], v[128:143]
    ds_read_b128 v[216:219], v55 offset:8192
    s_cbranch_vccnz L_sk_144
    s_add_u32 m0, s53, 33792
    s_nop 0
    buffer_load_dwordx4 v9, s[24:27], s50 offen lds
L_sk_144:
    s_waitcnt lgkmcnt(8)
    v_mfma_f32_32x32x16_bf16 v[144:159], v[200:203], v[228:231], v[144:159]
    ds_read_b128 v[220:223], v55 offset:12288
    s_waitcnt lgkmcnt(8)
    v_mfma_f32_32x32x16_bf16 v[160:175], v[204:207], v[224:227], v[160:175]
    s_cbranch_vccz L_sk_145
    s_add_u32 m0, s53, 33792
    s_nop 0
    buffer_load_dwordx4 v9, s[24:27], s50 offen lds
L_sk_145:
    v_mfma_f32_32x32x16_bf16 v[176:191], v[204:207], v[228:231], v[176:191]
    s_waitcnt lgkmcnt(5)
    v_mfma_f32_32x32x16_bf16 v[64:79], v[208:211], v[232:235], v[64:79]
    s_waitcnt vmcnt(4)
    s_barrier
    ds_read_b64_tr_b16 v[224:225], v56 offset:32768
    ds_read_b64_tr_b16 v[226:227], v56 offset:33792
    s_cbranch_vccnz L_sk_146
    s_add_u32 m0, s54, 98304
    s_nop 0
    buffer_load_dwordx4 v12, s[28:31], s51 offen lds
L_sk_146:
    s_waitcnt lgkmcnt(5)
    v_mfma_f32_32x32x16_bf16 v[80:95], v[208:211], v[236:239], v[80:95]
    ds_read_b128 v[192:195], v48 offset:0
    s_waitcnt lgkmcnt(5)
    v_mfma_f32_32x32x16_bf16 v[96:111], v[212:215], v[232:235], v[96:111]
    ds_read_b64_tr_b16 v[228:229], v57 offset:32768
    ds_read_b64_tr_b16 v[230:231], v57 offset:33792
    s_cbranch_vccz L_sk_147
    s_add_u32 m0, s54, 98304
    s_nop 0
    buffer_load_dwordx4 v12, s[28:31], s51 offen lds
L_sk_147:
    s_waitcnt lgkmcnt(7)
    v_mfma_f32_32x32x16_bf16 v[112:127], v[212:215], v[236:239], v[112:127]
    ds_read_b128 v[196:199], v48 offset:4096
    s_waitcnt lgkmcnt(7)
    v_mfma_f32_32x32x16_bf16 v[128:143], v[216:219], v[232:235], v[128:143]
    ds_read_b128 v[200:203], v48 offset:8192
    s_cbranch_vccnz L_sk_148
    s_add_u32 m0, s54, 99328
    s_nop 0
    buffer_load_dwordx4 v13, s[28:31], s51 offen lds
    s_add_u32 s51, s51, s52
    s_cmp_eq_u32 s51, s55
    s_cselect_b32 s51, 0, s51
L_sk_148:
    s_waitcnt lgkmcnt(8)
    v_mfma_f32_32x32x16_bf16 v[144:159], v[216:219], v[236:239], v[144:159]
    ds_read_b128 v[204:207], v48 offset:12288
    s_waitcnt lgkmcnt(8)
    v_mfma_f32_32x32x16_bf16 v[160:175], v[220:223], v[232:235], v[160:175]
    s_cbranch_vccz L_sk_149
    s_add_u32 m0, s54, 99328
    s_nop 0
    buffer_load_dwordx4 v13, s[28:31], s51 offen lds
    s_add_u32 s51, s51, s52
    s_cmp_eq_u32 s51, s55
    s_cselect_b32 s51, 0, s51
L_sk_149:
    v_mfma_f32_32x32x16_bf16 v[176:191], v[220:223], v[236:239], v[176:191]
    s_waitcnt lgkmcnt(5)
    v_mfma_f32_32x32x16_bf16 v[64:79], v[192:195], v[224:227], v[64:79]
    ds_read_b64_tr_b16 v[232:233], v56 offset:36864
    ds_read_b64_tr_b16 v[234:235], v56 offset:37888
    s_cbranch_vccnz L_sk_150
    s_add_u32 m0, s53, 34816
    s_nop 0
    buffer_load_dwordx4 v10, s[24:27], s50 offen lds
L_sk_150:
    s_waitcnt lgkmcnt(5)
    v_mfma_f32_32x32x16_bf16 v[80:95], v[192:195], v[228:231], v[80:95]
    ds_read_b128 v[208:211], v49 offset:0
    s_waitcnt lgkmcnt(5)
    v_mfma_f32_32x32x16_bf16 v[96:111], v[196:199], v[224:227], v[96:111]
    ds_read_b64_tr_b16 v[236:237], v57 offset:36864
    ds_read_b64_tr_b16 v[238:239], v57 offset:37888
    s_cbranch_vccz L_sk_151
    s_add_u32 m0, s53, 34816
    s_nop 0
    buffer_load_dwordx4 v10, s[24:27], s50 offen lds
L_sk_151:
    s_waitcnt lgkmcnt(7)
    v_mfma_f32_32x32x16_bf16 v[112:127], v[196:199], v[228:231], v[112:127]
    ds_read_b128 v[212:215], v49 offset:4096
    s_waitcnt lgkmcnt(7)
    v_mfma_f32_32x32x16_bf16 v[128:143], v[200:203], v[224:227], v[128:143]
    ds_read_b128 v[216:219], v49 offset:8192
    s_cbranch_vccnz L_sk_152
    s_add_u32 m0, s53, 35840
    s_nop 0
    buffer_load_dwordx4 v11, s[24:27], s50 offen lds
    s_add_u32 s50, s50, 128
    s_and_b32 s50, s50, 1023
L_sk_152:
    s_waitcnt lgkmcnt(8)
    v_mfma_f32_32x32x16_bf16 v[144:159], v[200:203], v[228:231], v[144:159]
    ds_read_b128 v[220:223], v49 offset:12288
    s_waitcnt lgkmcnt(8)
    v_mfma_f32_32x32x16_bf16 v[160:175], v[204:207], v[224:227], v[160:175]
    s_cbranch_vccz L_sk_153
    s_add_u32 m0, s53, 35840
    s_nop 0
    buffer_load_dwordx4 v11, s[24:27], s50 offen lds
    s_add_u32 s50, s50, 128
    s_and_b32 s50, s50, 1023
L_sk_153:
    v_mfma_f32_32x32x16_bf16 v[176:191], v[204:207], v[228:231], v[176:191]
    s_waitcnt lgkmcnt(5)
    v_mfma_f32_32x32x16_bf16 v[64:79], v[208:211], v[232:235], v[64:79]
    s_waitcnt vmcnt(4)
    s_barrier
    ds_read_b64_tr_b16 v[224:225], v56 offset:49152
    ds_read_b64_tr_b16 v[226:227], v56 offset:50176
    s_cbranch_vccnz L_sk_154
    s_add_u32 m0, s54, 114688
    s_nop 0
    buffer_load_dwordx4 v12, s[28:31], s51 offen lds
L_sk_154:
    s_waitcnt lgkmcnt(5)
    v_mfma_f32_32x32x16_bf16 v[80:95], v[208:211], v[236:239], v[80:95]
    ds_read_b128 v[192:195], v50 offset:0
    s_waitcnt lgkmcnt(5)
    v_mfma_f32_32x32x16_bf16 v[96:111], v[212:215], v[232:235], v[96:111]
    ds_read_b64_tr_b16 v[228:229], v57 offset:49152
    ds_read_b64_tr_b16 v[230:231], v57 offset:50176
    s_cbranch_vccz L_sk_155
    s_add_u32 m0, s54, 114688
    s_nop 0
    buffer_load_dwordx4 v12, s[28:31], s51 offen lds
L_sk_155:
    s_waitcnt lgkmcnt(7)
    v_mfma_f32_32x32x16_bf16 v[112:127], v[212:215], v[236:239], v[112:127]
    ds_read_b128 v[196:199], v50 offset:4096
    s_waitcnt lgkmcnt(7)
    v_mfma_f32_32x32x16_bf16 v[128:143], v[216:219], v[232:235], v[128:143]
    ds_read_b128 v[200:203], v50 offset:8192
    s_cbranch_vccnz L_sk_156
    s_add_u32 m0, s54, 115712
    s_nop 0
    buffer_load_dwordx4 v13, s[28:31], s51 offen lds
    s_add_u32 s51, s51, s52
    s_cmp_eq_u32 s51, s55
    s_cselect_b32 s51, 0, s51
L_sk_156:
    s_waitcnt lgkmcnt(8)
    v_mfma_f32_32x32x16_bf16 v[144:159], v[216:219], v[236:239], v[144:159]
    ds_read_b128 v[204:207], v50 offset:12288
    s_waitcnt lgkmcnt(8)
    v_mfma_f32_32x32x16_bf16 v[160:175], v[220:223], v[232:235], v[160:175]
    s_cbranch_vccz L_sk_157
    s_add_u32 m0, s54, 115712
    s_nop 0
    buffer_load_dwordx4 v13, s[28:31], s51 offen lds
    s_add_u32 s51, s51, s52
    s_cmp_eq_u32 s51, s55
    s_cselect_b32 s51, 0, s51
L_sk_157:
    v_mfma_f32_32x32x16_bf16 v[176:191], v[220:223], v[236:239], v[176:191]
    s_waitcnt lgkmcnt(5)
    v_mfma_f32_32x32x16_bf16 v[64:79], v[192:195], v[224:227], v[64:79]
    ds_read_b64_tr_b16 v[232:233], v56 offset:53248
    ds_read_b64_tr_b16 v[234:235], v56 offset:54272
    s_cbranch_vccnz L_sk_158
    s_add_u32 m0, s53, 65536
    s_nop 0
    buffer_load_dwordx4 v8, s[24:27], s50 offen lds
L_sk_158:
    s_waitcnt lgkmcnt(5)
    v_mfma_f32_32x32x16_bf16 v[80:95], v[192:195], v[228:231], v[80:95]
    ds_read_b128 v[208:211], v51 offset:0
    s_waitcnt lgkmcnt(5)
    v_mfma_f32_32x32x16_bf16 v[96:111], v[196:199], v[224:227], v[96:111]
    ds_read_b64_tr_b16 v[236:237], v57 offset:53248
    ds_read_b64_tr_b16 v[238:239], v57 offset:54272
    s_cbranch_vccz L_sk_159
    s_add_u32 m0, s53, 65536
    s_nop 0
    buffer_load_dwordx4 v8, s[24:27], s50 offen lds
L_sk_159:
    s_waitcnt lgkmcnt(7)
    v_mfma_f32_32x32x16_bf16 v[112:127], v[196:199], v[228:231], v[112:127]
    ds_read_b128 v[212:215], v51 offset:4096
    s_waitcnt lgkmcnt(7)
    v_mfma_f32_32x32x16_bf16 v[128:143], v[200:203], v[224:227], v[128:143]
    ds_read_b128 v[216:219], v51 offset:8192
    s_cbranch_vccnz L_sk_160
    s_add_u32 m0, s53, 66560
    s_nop 0
    buffer_load_dwordx4 v9, s[24:27], s50 offen lds
L_sk_160:
    s_waitcnt lgkmcnt(8)
    v_mfma_f32_32x32x16_bf16 v[144:159], v[200:203], v[228:231], v[144:159]
    ds_read_b128 v[220:223], v51 offset:12288
    s_waitcnt lgkmcnt(8)
    v_mfma_f32_32x32x16_bf16 v[160:175], v[204:207], v[224:227], v[160:175]
    s_cbranch_vccz L_sk_161
    s_add_u32 m0, s53, 66560
    s_nop 0
    buffer_load_dwordx4 v9, s[24:27], s50 offen lds
L_sk_161:
    v_mfma_f32_32x32x16_bf16 v[176:191], v[204:207], v[228:231], v[176:191]
    s_waitcnt lgkmcnt(5)
    v_mfma_f32_32x32x16_bf16 v[64:79], v[208:211], v[232:235], v[64:79]
    s_waitcnt vmcnt(4)
    s_barrier
    ds_read_b64_tr_b16 v[224:225], v56 offset:0
    ds_read_b64_tr_b16 v[226:227], v56 offset:1024
    s_cbranch_vccnz L_sk_162
    s_add_u32 m0, s54, 131072
    s_nop 0
    buffer_load_dwordx4 v12, s[28:31], s51 offen lds
L_sk_162:
    s_waitcnt lgkmcnt(5)
    v_mfma_f32_32x32x16_bf16 v[80:95], v[208:211], v[236:239], v[80:95]
    ds_read_b128 v[192:195], v48 offset:32768
    s_waitcnt lgkmcnt(5)
    v_mfma_f32_32x32x16_bf16 v[96:111], v[212:215], v[232:235], v[96:111]
    ds_read_b64_tr_b16 v[228:229], v57 offset:0
    ds_read_b64_tr_b16 v[230:231], v57 offset:1024
    s_cbranch_vccz L_sk_163
    s_add_u32 m0, s54, 131072
    s_nop 0
    buffer_load_dwordx4 v12, s[28:31], s51 offen lds
L_sk_163:
    s_waitcnt lgkmcnt(7)
    v_mfma_f32_32x32x16_bf16 v[112:127], v[212:215], v[236:239], v[112:127]
    ds_read_b128 v[196:199], v48 offset:36864
    s_waitcnt lgkmcnt(7)
    v_mfma_f32_32x32x16_bf16 v[128:143], v[216:219], v[232:235], v[128:143]
    ds_read_b128 v[200:203], v48 offset:40960
    s_cbranch_vccnz L_sk_164
    s_add_u32 m0, s54, 132096
    s_nop 0
    buffer_load_dwordx4 v13, s[28:31], s51 offen lds
    s_add_u32 s51, s51, s52
    s_cmp_eq_u32 s51, s55
    s_cselect_b32 s51, 0, s51
L_sk_164:
    s_waitcnt lgkmcnt(8)
    v_mfma_f32_32x32x16_bf16 v[144:159], v[216:219], v[236:239], v[144:159]
    ds_read_b128 v[204:207], v48 offset:45056
    s_waitcnt lgkmcnt(8)
    v_mfma_f32_32x32x16_bf16 v[160:175], v[220:223], v[232:235], v[160:175]
    s_cbranch_vccz L_sk_165
    s_add_u32 m0, s54, 132096
    s_nop 0
    buffer_load_dwordx4 v13, s[28:31], s51 offen lds
    s_add_u32 s51, s51, s52
    s_cmp_eq_u32 s51, s55
    s_cselect_b32 s51, 0, s51
L_sk_165:
    v_mfma_f32_32x32x16_bf16 v[176:191], v[220:223], v[236:239], v[176:191]
    s_waitcnt lgkmcnt(5)
    v_mfma_f32_32x32x16_bf16 v[64:79], v[192:195], v[224:227], v[64:79]
    ds_read_b64_tr_b16 v[232:233], v56 offset:4096
    ds_read_b64_tr_b16 v[234:235], v56 offset:5120
    s_cbranch_vccnz L_sk_166
    s_add_u32 m0, s53, 67584
    s_nop 0
    buffer_load_dwordx4 v10, s[24:27], s50 offen lds
L_sk_166:
    s_waitcnt lgkmcnt(5)
    v_mfma_f32_32x32x16_bf16 v[80:95], v[192:195], v[228:231], v[80:95]
    ds_read_b128 v[208:211], v49 offset:32768
    s_waitcnt lgkmcnt(5)
    v_mfma_f32_32x32x16_bf16 v[96:111], v[196:199], v[224:227], v[96:111]
    ds_read_b64_tr_b16 v[236:237], v57 offset:4096
    ds_read_b64_tr_b16 v[238:239], v57 offset:5120
    s_cbranch_vccz L_sk_167
    s_add_u32 m0, s53, 67584
    s_nop 0
    buffer_load_dwordx4 v10, s[24:27], s50 offen lds
L_sk_167:
    s_waitcnt lgkmcnt(7)
    v_mfma_f32_32x32x16_bf16 v[112:127], v[196:199], v[228:231], v[112:127]
    ds_read_b128 v[212:215], v49 offset:36864
    s_waitcnt lgkmcnt(7)
    v_mfma_f32_32x32x16_bf16 v[128:143], v[200:203], v[224:227], v[128:143]
    ds_read_b128 v[216:219], v49 offset:40960
    s_cbranch_vccnz L_sk_168
    s_add_u32 m0, s53, 68608
    s_nop 0
    buffer_load_dwordx4 v11, s[24:27], s50 offen lds
    s_add_u32 s50, s50, 128
    s_and_b32 s50, s50, 1023
L_sk_168:
    s_waitcnt lgkmcnt(8)
    v_mfma_f32_32x32x16_bf16 v[144:159], v[200:203], v[228:231], v[144:159]
    ds_read_b128 v[220:223], v49 offset:45056
    s_waitcnt lgkmcnt(8)
    v_mfma_f32_32x32x16_bf16 v[160:175], v[204:207], v[224:227], v[160:175]
    s_cbranch_vccz L_sk_169
    s_add_u32 m0, s53, 68608
    s_nop 0
    buffer_load_dwordx4 v11, s[24:27], s50 offen lds
    s_add_u32 s50, s50, 128
    s_and_b32 s50, s50, 1023
L_sk_169:
    v_mfma_f32_32x32x16_bf16 v[176:191], v[204:207], v[228:231], v[176:191]
    s_waitcnt lgkmcnt(5)
    v_mfma_f32_32x32x16_bf16 v[64:79], v[208:211], v[232:235], v[64:79]
    s_waitcnt vmcnt(4)
    s_barrier
    ds_read_b64_tr_b16 v[224:225], v56 offset:16384
    ds_read_b64_tr_b16 v[226:227], v56 offset:17408
    s_cbranch_vccnz L_sk_170
    s_add_u32 m0, s54, 147456
    s_nop 0
    buffer_load_dwordx4 v12, s[28:31], s51 offen lds
L_sk_170:
    s_waitcnt lgkmcnt(5)
    v_mfma_f32_32x32x16_bf16 v[80:95], v[208:211], v[236:239], v[80:95]
    ds_read_b128 v[192:195], v50 offset:32768
    s_waitcnt lgkmcnt(5)
    v_mfma_f32_32x32x16_bf16 v[96:111], v[212:215], v[232:235], v[96:111]
    ds_read_b64_tr_b16 v[228:229], v57 offset:16384
    ds_read_b64_tr_b16 v[230:231], v57 offset:17408
    s_cbranch_vccz L_sk_171
    s_add_u32 m0, s54, 147456
    s_nop 0
    buffer_load_dwordx4 v12, s[28:31], s51 offen lds
L_sk_171:
    s_waitcnt lgkmcnt(7)
    v_mfma_f32_32x32x16_bf16 v[112:127], v[212:215], v[236:239], v[112:127]
    ds_read_b128 v[196:199], v50 offset:36864
    s_waitcnt lgkmcnt(7)
    v_mfma_f32_32x32x16_bf16 v[128:143], v[216:219], v[232:235], v[128:143]
    ds_read_b128 v[200:203], v50 offset:40960
    s_cbranch_vccnz L_sk_172
    s_add_u32 m0, s54, 148480
    s_nop 0
    buffer_load_dwordx4 v13, s[28:31], s51 offen lds
    s_add_u32 s51, s51, s52
    s_cmp_eq_u32 s51, s55
    s_cselect_b32 s51, 0, s51
L_sk_172:
    s_waitcnt lgkmcnt(8)
    v_mfma_f32_32x32x16_bf16 v[144:159], v[216:219], v[236:239], v[144:159]
    ds_read_b128 v[204:207], v50 offset:45056
    s_waitcnt lgkmcnt(8)
    v_mfma_f32_32x32x16_bf16 v[160:175], v[220:223], v[232:235], v[160:175]
    s_cbranch_vccz L_sk_173
    s_add_u32 m0, s54, 148480
    s_nop 0
    buffer_load_dwordx4 v13, s[28:31], s51 offen lds
    s_add_u32 s51, s51, s52
    s_cmp_eq_u32 s51, s55
    s_cselect_b32 s51, 0, s51
L_sk_173:
    v_mfma_f32_32x32x16_bf16 v[176:191], v[220:223], v[236:239], v[176:191]
    s_waitcnt lgkmcnt(5)
    v_mfma_f32_32x32x16_bf16 v[64:79], v[192:195], v[224:227], v[64:79]
    ds_read_b64_tr_b16 v[232:233], v56 offset:20480
    ds_read_b64_tr_b16 v[234:235], v56 offset:21504
    s_cbranch_vccnz L_sk_174
    s_add_u32 m0, s53, 0
    s_nop 0
    buffer_load_dwordx4 v8, s[24:27], s50 offen lds
L_sk_174:
    s_waitcnt lgkmcnt(5)
    v_mfma_f32_32x32x16_bf16 v[80:95], v[192:195], v[228:231], v[80:95]
    ds_read_b128 v[208:211], v51 offset:32768
    s_waitcnt lgkmcnt(5)
    v_mfma_f32_32x32x16_bf16 v[96:111], v[196:199], v[224:227], v[96:111]
    ds_read_b64_tr_b16 v[236:237], v57 offset:20480
    ds_read_b64_tr_b16 v[238:239], v57 offset:21504
    s_cbranch_vccz L_sk_175
    s_add_u32 m0, s53, 0
    s_nop 0
    buffer_load_dwordx4 v8, s[24:27], s50 offen lds
L_sk_175:
    s_waitcnt lgkmcnt(7)
    v_mfma_f32_32x32x16_bf16 v[112:127], v[196:199], v[228:231], v[112:127]
    ds_read_b128 v[212:215], v51 offset:36864
    s_waitcnt lgkmcnt(7)
    v_mfma_f32_32x32x16_bf16 v[128:143], v[200:203], v[224:227], v[128:143]
    ds_read_b128 v[216:219], v51 offset:40960
    s_cbranch_vccnz L_sk_176
    s_add_u32 m0, s53, 1024
    s_nop 0
    buffer_load_dwordx4 v9, s[24:27], s50 offen lds
L_sk_176:
    s_waitcnt lgkmcnt(8)
    v_mfma_f32_32x32x16_bf16 v[144:159], v[200:203], v[228:231], v[144:159]
    ds_read_b128 v[220:223], v51 offset:45056
    s_waitcnt lgkmcnt(8)
    v_mfma_f32_32x32x16_bf16 v[160:175], v[204:207], v[224:227], v[160:175]
    s_cbranch_vccz L_sk_177
    s_add_u32 m0, s53, 1024
    s_nop 0
    buffer_load_dwordx4 v9, s[24:27], s50 offen lds
L_sk_177:
    v_mfma_f32_32x32x16_bf16 v[176:191], v[204:207], v[228:231], v[176:191]
    s_waitcnt lgkmcnt(5)
    v_mfma_f32_32x32x16_bf16 v[64:79], v[208:211], v[232:235], v[64:79]
    s_waitcnt vmcnt(4)
    s_barrier
    ds_read_b64_tr_b16 v[224:225], v56 offset:32768
    ds_read_b64_tr_b16 v[226:227], v56 offset:33792
    s_cbranch_vccnz L_sk_178
    s_add_u32 m0, s54, 98304
    s_nop 0
    buffer_load_dwordx4 v12, s[28:31], s51 offen lds
L_sk_178:
    s_waitcnt lgkmcnt(5)
    v_mfma_f32_32x32x16_bf16 v[80:95], v[208:211], v[236:239], v[80:95]
    ds_read_b128 v[192:195], v52 offset:0
    s_waitcnt lgkmcnt(5)
    v_mfma_f32_32x32x16_bf16 v[96:111], v[212:215], v[232:235], v[96:111]
    ds_read_b64_tr_b16 v[228:229], v57 offset:32768
    ds_read_b64_tr_b16 v[230:231], v57 offset:33792
    s_cbranch_vccz L_sk_179
    s_add_u32 m0, s54, 98304
    s_nop 0
    buffer_load_dwordx4 v12, s[28:31], s51 offen lds
L_sk_179:
    s_waitcnt lgkmcnt(7)
    v_mfma_f32_32x32x16_bf16 v[112:127], v[212:215], v[236:239], v[112:127]
    ds_read_b128 v[196:199], v52 offset:4096
    s_waitcnt lgkmcnt(7)
    v_mfma_f32_32x32x16_bf16 v[128:143], v[216:219], v[232:235], v[128:143]
    ds_read_b128 v[200:203], v52 offset:8192
    s_cbranch_vccnz L_sk_180
    s_add_u32 m0, s54, 99328
    s_nop 0
    buffer_load_dwordx4 v13, s[28:31], s51 offen lds
    s_add_u32 s51, s51, s52
    s_cmp_eq_u32 s51, s55
    s_cselect_b32 s51, 0, s51
L_sk_180:
    s_waitcnt lgkmcnt(8)
    v_mfma_f32_32x32x16_bf16 v[144:159], v[216:219], v[236:239], v[144:159]
    ds_read_b128 v[204:207], v52 offset:12288
    s_waitcnt lgkmcnt(8)
    v_mfma_f32_32x32x16_bf16 v[160:175], v[220:223], v[232:235], v[160:175]
    s_cbranch_vccz L_sk_181
    s_add_u32 m0, s54, 99328
    s_nop 0
    buffer_load_dwordx4 v13, s[28:31], s51 offen lds
    s_add_u32 s51, s51, s52
    s_cmp_eq_u32 s51, s55
    s_cselect_b32 s51, 0, s51
L_sk_181:
    v_mfma_f32_32x32x16_bf16 v[176:191], v[220:223], v[236:239], v[176:191]
    s_waitcnt lgkmcnt(5)
    v_mfma_f32_32x32x16_bf16 v[64:79], v[192:195], v[224:227], v[64:79]
    ds_read_b64_tr_b16 v[232:233], v56 offset:36864
    ds_read_b64_tr_b16 v[234:235], v56 offset:37888
    s_cbranch_vccnz L_sk_182
    s_add_u32 m0, s53, 2048
    s_nop 0
    buffer_load_dwordx4 v10, s[24:27], s50 offen lds
L_sk_182:
    s_waitcnt lgkmcnt(5)
    v_mfma_f32_32x32x16_bf16 v[80:95], v[192:195], v[228:231], v[80:95]
    ds_read_b128 v[208:211], v53 offset:0
    s_waitcnt lgkmcnt(5)
    v_mfma_f32_32x32x16_bf16 v[96:111], v[196:199], v[224:227], v[96:111]
    ds_read_b64_tr_b16 v[236:237], v57 offset:36864
    ds_read_b64_tr_b16 v[238:239], v57 offset:37888
    s_cbranch_vccz L_sk_183
    s_add_u32 m0, s53, 2048
    s_nop 0
    buffer_load_dwordx4 v10, s[24:27], s50 offen lds
L_sk_183:
    s_waitcnt lgkmcnt(7)
    v_mfma_f32_32x32x16_bf16 v[112:127], v[196:199], v[228:231], v[112:127]
    ds_read_b128 v[212:215], v53 offset:4096
    s_waitcnt lgkmcnt(7)
    v_mfma_f32_32x32x16_bf16 v[128:143], v[200:203], v[224:227], v[128:143]
    ds_read_b128 v[216:219], v53 offset:8192
    s_cbranch_vccnz L_sk_184
    s_add_u32 m0, s53, 3072
    s_nop 0
    buffer_load_dwordx4 v11, s[24:27], s50 offen lds
    s_add_u32 s50, s50, 128
    s_and_b32 s50, s50, 1023
L_sk_184:
    s_waitcnt lgkmcnt(8)
    v_mfma_f32_32x32x16_bf16 v[144:159], v[200:203], v[228:231], v[144:159]
    ds_read_b128 v[220:223], v53 offset:12288
    s_waitcnt lgkmcnt(8)
    v_mfma_f32_32x32x16_bf16 v[160:175], v[204:207], v[224:227], v[160:175]
    s_cbranch_vccz L_sk_185
    s_add_u32 m0, s53, 3072
    s_nop 0
    buffer_load_dwordx4 v11, s[24:27], s50 offen lds
    s_add_u32 s50, s50, 128
    s_and_b32 s50, s50, 1023
L_sk_185:
    v_mfma_f32_32x32x16_bf16 v[176:191], v[204:207], v[228:231], v[176:191]
    s_waitcnt lgkmcnt(5)
    v_mfma_f32_32x32x16_bf16 v[64:79], v[208:211], v[232:235], v[64:79]
    s_waitcnt vmcnt(4)
    s_barrier
    ds_read_b64_tr_b16 v[224:225], v56 offset:49152
    ds_read_b64_tr_b16 v[226:227], v56 offset:50176
    s_cbranch_vccnz L_sk_186
    s_add_u32 m0, s54, 114688
    s_nop 0
    buffer_load_dwordx4 v12, s[28:31], s51 offen lds
L_sk_186:
    s_waitcnt lgkmcnt(5)
    v_mfma_f32_32x32x16_bf16 v[80:95], v[208:211], v[236:239], v[80:95]
    ds_read_b128 v[192:195], v54 offset:0
    s_waitcnt lgkmcnt(5)
    v_mfma_f32_32x32x16_bf16 v[96:111], v[212:215], v[232:235], v[96:111]
    ds_read_b64_tr_b16 v[228:229], v57 offset:49152
    ds_read_b64_tr_b16 v[230:231], v57 offset:50176
    s_cbranch_vccz L_sk_187
    s_add_u32 m0, s54, 114688
    s_nop 0
    buffer_load_dwordx4 v12, s[28:31], s51 offen lds
L_sk_187:
    s_waitcnt lgkmcnt(7)
    v_mfma_f32_32x32x16_bf16 v[112:127], v[212:215], v[236:239], v[112:127]
    ds_read_b128 v[196:199], v54 offset:4096
    s_waitcnt lgkmcnt(7)
    v_mfma_f32_32x32x16_bf16 v[128:143], v[216:219], v[232:235], v[128:143]
    ds_read_b128 v[200:203], v54 offset:8192
    s_cbranch_vccnz L_sk_188
    s_add_u32 m0, s54, 115712
    s_nop 0
    buffer_load_dwordx4 v13, s[28:31], s51 offen lds
    s_add_u32 s51, s51, s52
    s_cmp_eq_u32 s51, s55
    s_cselect_b32 s51, 0, s51
L_sk_188:
    s_waitcnt lgkmcnt(8)
    v_mfma_f32_32x32x16_bf16 v[144:159], v[216:219], v[236:239], v[144:159]
    ds_read_b128 v[204:207], v54 offset:12288
    s_waitcnt lgkmcnt(8)
    v_mfma_f32_32x32x16_bf16 v[160:175], v[220:223], v[232:235], v[160:175]
    s_cbranch_vccz L_sk_189
    s_add_u32 m0, s54, 115712
    s_nop 0
    buffer_load_dwordx4 v13, s[28:31], s51 offen lds
    s_add_u32 s51, s51, s52
    s_cmp_eq_u32 s51, s55
    s_cselect_b32 s51, 0, s51
L_sk_189:
    v_mfma_f32_32x32x16_bf16 v[176:191], v[220:223], v[236:239], v[176:191]
    s_waitcnt lgkmcnt(5)
    v_mfma_f32_32x32x16_bf16 v[64:79], v[192:195], v[224:227], v[64:79]
    ds_read_b64_tr_b16 v[232:233], v56 offset:53248
    ds_read_b64_tr_b16 v[234:235], v56 offset:54272
    s_cbranch_vccnz L_sk_190
    s_add_u32 m0, s53, 32768
    s_nop 0
    buffer_load_dwordx4 v8, s[24:27], s50 offen lds
L_sk_190:
    s_waitcnt lgkmcnt(5)
    v_mfma_f32_32x32x16_bf16 v[80:95], v[192:195], v[228:231], v[80:95]
    ds_read_b128 v[208:211], v55 offset:0
    s_waitcnt lgkmcnt(5)
    v_mfma_f32_32x32x16_bf16 v[96:111], v[196:199], v[224:227], v[96:111]
    ds_read_b64_tr_b16 v[236:237], v57 offset:53248
    ds_read_b64_tr_b16 v[238:239], v57 offset:54272
    s_cbranch_vccz L_sk_191
    s_add_u32 m0, s53, 32768
    s_nop 0
    buffer_load_dwordx4 v8, s[24:27], s50 offen lds
L_sk_191:
    s_waitcnt lgkmcnt(7)
    v_mfma_f32_32x32x16_bf16 v[112:127], v[196:199], v[228:231], v[112:127]
    ds_read_b128 v[212:215], v55 offset:4096
    s_waitcnt lgkmcnt(7)
    v_mfma_f32_32x32x16_bf16 v[128:143], v[200:203], v[224:227], v[128:143]
    ds_read_b128 v[216:219], v55 offset:8192
    s_cbranch_vccnz L_sk_192
    s_add_u32 m0, s53, 33792
    s_nop 0
    buffer_load_dwordx4 v9, s[24:27], s50 offen lds
L_sk_192:
    s_waitcnt lgkmcnt(8)
    v_mfma_f32_32x32x16_bf16 v[144:159], v[200:203], v[228:231], v[144:159]
    ds_read_b128 v[220:223], v55 offset:12288
    s_waitcnt lgkmcnt(8)
    v_mfma_f32_32x32x16_bf16 v[160:175], v[204:207], v[224:227], v[160:175]
    s_cbranch_vccz L_sk_193
    s_add_u32 m0, s53, 33792
    s_nop 0
    buffer_load_dwordx4 v9, s[24:27], s50 offen lds
L_sk_193:
    v_mfma_f32_32x32x16_bf16 v[176:191], v[204:207], v[228:231], v[176:191]
    s_waitcnt lgkmcnt(5)
    v_mfma_f32_32x32x16_bf16 v[64:79], v[208:211], v[232:235], v[64:79]
    s_waitcnt vmcnt(4)
    s_barrier
    ds_read_b64_tr_b16 v[224:225], v56 offset:0
    ds_read_b64_tr_b16 v[226:227], v56 offset:1024
    s_cbranch_vccnz L_sk_194
    s_add_u32 m0, s54, 131072
    s_nop 0
    buffer_load_dwordx4 v12, s[28:31], s51 offen lds
L_sk_194:
    s_waitcnt lgkmcnt(5)
    v_mfma_f32_32x32x16_bf16 v[80:95], v[208:211], v[236:239], v[80:95]
    ds_read_b128 v[192:195], v48 offset:0
    s_waitcnt lgkmcnt(5)
    v_mfma_f32_32x32x16_bf16 v[96:111], v[212:215], v[232:235], v[96:111]
    ds_read_b64_tr_b16 v[228:229], v57 offset:0
    ds_read_b64_tr_b16 v[230:231], v57 offset:1024
    s_cbranch_vccz L_sk_195
    s_add_u32 m0, s54, 131072
    s_nop 0
    buffer_load_dwordx4 v12, s[28:31], s51 offen lds
L_sk_195:
    s_waitcnt lgkmcnt(7)
    v_mfma_f32_32x32x16_bf16 v[112:127], v[212:215], v[236:239], v[112:127]
    ds_read_b128 v[196:199], v48 offset:4096
    s_waitcnt lgkmcnt(7)
    v_mfma_f32_32x32x16_bf16 v[128:143], v[216:219], v[232:235], v[128:143]
    ds_read_b128 v[200:203], v48 offset:8192
    s_cbranch_vccnz L_sk_196
    s_add_u32 m0, s54, 132096
    s_nop 0
    buffer_load_dwordx4 v13, s[28:31], s51 offen lds
    s_add_u32 s51, s51, s52
    s_cmp_eq_u32 s51, s55
    s_cselect_b32 s51, 0, s51
L_sk_196:
    s_waitcnt lgkmcnt(8)
    v_mfma_f32_32x32x16_bf16 v[144:159], v[216:219], v[236:239], v[144:159]
    ds_read_b128 v[204:207], v48 offset:12288
    s_waitcnt lgkmcnt(8)
    v_mfma_f32_32x32x16_bf16 v[160:175], v[220:223], v[232:235], v[160:175]
    s_cbranch_vccz L_sk_197
    s_add_u32 m0, s54, 132096
    s_nop 0
    buffer_load_dwordx4 v13, s[28:31], s51 offen lds
    s_add_u32 s51, s51, s52
    s_cmp_eq_u32 s51, s55
    s_cselect_b32 s51, 0, s51
L_sk_197:
    v_mfma_f32_32x32x16_bf16 v[176:191], v[220:223], v[236:239], v[176:191]
    s_waitcnt lgkmcnt(5)
    v_mfma_f32_32x32x16_bf16 v[64:79], v[192:195], v[224:227], v[64:79]
    ds_read_b64_tr_b16 v[232:233], v56 offset:4096
    ds_read_b64_tr_b16 v[234:235], v56 offset:5120
    s_cbranch_vccnz L_sk_198
    s_add_u32 m0, s53, 34816
    s_nop 0
    buffer_load_dwordx4 v10, s[24:27], s50 offen lds
L_sk_198:
    s_waitcnt lgkmcnt(5)
    v_mfma_f32_32x32x16_bf16 v[80:95], v[192:195], v[228:231], v[80:95]
    ds_read_b128 v[208:211], v49 offset:0
    s_waitcnt lgkmcnt(5)
    v_mfma_f32_32x32x16_bf16 v[96:111], v[196:199], v[224:227], v[96:111]
    ds_read_b64_tr_b16 v[236:237], v57 offset:4096
    ds_read_b64_tr_b16 v[238:239], v57 offset:5120
    s_cbranch_vccz L_sk_199
    s_add_u32 m0, s53, 34816
    s_nop 0
    buffer_load_dwordx4 v10, s[24:27], s50 offen lds
L_sk_199:
    s_waitcnt lgkmcnt(7)
    v_mfma_f32_32x32x16_bf16 v[112:127], v[196:199], v[228:231], v[112:127]
    ds_read_b128 v[212:215], v49 offset:4096
    s_waitcnt lgkmcnt(7)
    v_mfma_f32_32x32x16_bf16 v[128:143], v[200:203], v[224:227], v[128:143]
    ds_read_b128 v[216:219], v49 offset:8192
    s_cbranch_vccnz L_sk_200
    s_add_u32 m0, s53, 35840
    s_nop 0
    buffer_load_dwordx4 v11, s[24:27], s50 offen lds
    s_add_u32 s50, s50, 128
    s_and_b32 s50, s50, 1023
L_sk_200:
    s_waitcnt lgkmcnt(8)
    v_mfma_f32_32x32x16_bf16 v[144:159], v[200:203], v[228:231], v[144:159]
    ds_read_b128 v[220:223], v49 offset:12288
    s_waitcnt lgkmcnt(8)
    v_mfma_f32_32x32x16_bf16 v[160:175], v[204:207], v[224:227], v[160:175]
    s_cbranch_vccz L_sk_201
    s_add_u32 m0, s53, 35840
    s_nop 0
    buffer_load_dwordx4 v11, s[24:27], s50 offen lds
    s_add_u32 s50, s50, 128
    s_and_b32 s50, s50, 1023
L_sk_201:
    v_mfma_f32_32x32x16_bf16 v[176:191], v[204:207], v[228:231], v[176:191]
    s_waitcnt lgkmcnt(5)
    v_mfma_f32_32x32x16_bf16 v[64:79], v[208:211], v[232:235], v[64:79]
    s_waitcnt vmcnt(4)
    s_barrier
    ds_read_b64_tr_b16 v[224:225], v56 offset:16384
    ds_read_b64_tr_b16 v[226:227], v56 offset:17408
    s_cbranch_vccnz L_sk_202
    s_add_u32 m0, s54, 147456
    s_nop 0
    buffer_load_dwordx4 v12, s[28:31], s51 offen lds
L_sk_202:
    s_waitcnt lgkmcnt(5)
    v_mfma_f32_32x32x16_bf16 v[80:95], v[208:211], v[236:239], v[80:95]
    ds_read_b128 v[192:195], v50 offset:0
    s_waitcnt lgkmcnt(5)
    v_mfma_f32_32x32x16_bf16 v[96:111], v[212:215], v[232:235], v[96:111]
    ds_read_b64_tr_b16 v[228:229], v57 offset:16384
    ds_read_b64_tr_b16 v[230:231], v57 offset:17408
    s_cbranch_vccz L_sk_203
    s_add_u32 m0, s54, 147456
    s_nop 0
    buffer_load_dwordx4 v12, s[28:31], s51 offen lds
L_sk_203:
    s_waitcnt lgkmcnt(7)
    v_mfma_f32_32x32x16_bf16 v[112:127], v[212:215], v[236:239], v[112:127]
    ds_read_b128 v[196:199], v50 offset:4096
    s_waitcnt lgkmcnt(7)
    v_mfma_f32_32x32x16_bf16 v[128:143], v[216:219], v[232:235], v[128:143]
    ds_read_b128 v[200:203], v50 offset:8192
    s_cbranch_vccnz L_sk_204
    s_add_u32 m0, s54, 148480
    s_nop 0
    buffer_load_dwordx4 v13, s[28:31], s51 offen lds
    s_add_u32 s51, s51, s52
    s_cmp_eq_u32 s51, s55
    s_cselect_b32 s51, 0, s51
L_sk_204:
    s_waitcnt lgkmcnt(8)
    v_mfma_f32_32x32x16_bf16 v[144:159], v[216:219], v[236:239], v[144:159]
    ds_read_b128 v[204:207], v50 offset:12288
    s_waitcnt lgkmcnt(8)
    v_mfma_f32_32x32x16_bf16 v[160:175], v[220:223], v[232:235], v[160:175]
    s_cbranch_vccz L_sk_205
    s_add_u32 m0, s54, 148480
    s_nop 0
    buffer_load_dwordx4 v13, s[28:31], s51 offen lds
    s_add_u32 s51, s51, s52
    s_cmp_eq_u32 s51, s55
    s_cselect_b32 s51, 0, s51
L_sk_205:
    v_mfma_f32_32x32x16_bf16 v[176:191], v[220:223], v[236:239], v[176:191]
    s_waitcnt lgkmcnt(5)
    v_mfma_f32_32x32x16_bf16 v[64:79], v[192:195], v[224:227], v[64:79]
    ds_read_b64_tr_b16 v[232:233], v56 offset:20480
    ds_read_b64_tr_b16 v[234:235], v56 offset:21504
    s_waitcnt lgkmcnt(5)
    v_mfma_f32_32x32x16_bf16 v[80:95], v[192:195], v[228:231], v[80:95]
    ds_read_b128 v[208:211], v51 offset:0
    s_load_dwordx2 s[4:5], s[0:1], 104
    s_load_dwordx2 s[24:25], s[0:1], 0
    s_load_dwordx2 s[28:29], s[0:1], 16
    s_load_dwordx2 s[6:7], s[0:1], 56
    s_load_dwordx2 s[8:9], s[0:1], 64
    s_and_b32 s40, s2, 7
    s_lshl_b32 s40, s40, 2
    s_bfe_u32 s3, s2, 0x20003
    s_add_u32 s40, s40, s3
    s_lshr_b32 s41, s2, 5
    v_lshrrev_b32 v1, 6, v0
    s_nop 0
    v_readfirstlane_b32 s42, v1
    v_and_b32 v2, 63, v0
    s_lshr_b32 s48, s42, 2
    s_and_b32 s49, s42, 3
    s_sub_u32 s46, 15, s41
    s_cmp_eq_u32 s48, 0
    s_cselect_b32 s46, s46, s41
    s_lshl_b32 s46, s46, 7
    s_lshl_b32 s47, s49, 5
    s_add_u32 s43, s46, s47
    s_lshl_b32 s47, s42, 5
    s_waitcnt lgkmcnt(0)
    s_mov_b32 s26, 0x200000
    s_mov_b32 s27, 0x00020000
    s_mov_b32 s30, 0x180000
    s_movk_i32 s44, 3072
    s_cmp_eq_u32 s48, 0
    s_cselect_b32 s28, s28, s6
    s_cselect_b32 s29, s29, s7
    s_cselect_b32 s30, 0x400000, s30
    s_cselect_b32 s44, 8192, s44
    s_mov_b32 s31, 0x00020000
    s_mov_b32 s32, s4
    s_mov_b32 s33, s5
    s_mov_b32 s34, 0x10000000
    s_mov_b32 s35, 0x00020000
    s_lshl_b32 s52, s44, 5

    v_lshrrev_b32 v3, 3, v2
    v_add_u32 v3, s43, v3
    v_lshrrev_b32 v4, 4, v2
    v_and_b32 v5, 7, v2
    v_xor_b32 v5, v5, v4
    v_xor_b32 v6, 4, v5
    v_lshlrev_b32 v5, 4, v5
    v_lshlrev_b32 v6, 4, v6

    v_add_u32 v7, 0, v3
    v_lshl_add_u32 v8, v7, 10, v5
    v_add_u32 v7, 8, v3
    v_lshl_add_u32 v9, v7, 10, v6
    v_add_u32 v7, 16, v3
    v_lshl_add_u32 v10, v7, 10, v5
    v_add_u32 v7, 24, v3
    v_lshl_add_u32 v11, v7, 10, v6
    v_and_b32 v3, 31, v2
    v_lshrrev_b32 v4, 5, v2
    v_add_u32 v5, s47, v3
    v_bfe_u32 v6, v3, 1, 3
    v_xor_b32 v6, v6, v4
    v_lshlrev_b32 v6, 4, v6
    v_lshl_add_u32 v16, v5, 7, v6

    v_xor_b32 v17, 32, v16
    v_xor_b32 v18, 64, v16
    v_xor_b32 v19, 96, v16
    v_add_u32 v20, 65536, v16
    v_add_u32 v21, 65536, v17
    v_add_u32 v22, 65536, v18
    v_add_u32 v23, 65536, v19
    v_bfe_u32 v3, v2, 2, 2
    v_lshl_add_u32 v4, v4, 3, v3
    v_lshlrev_b32 v4, 8, v4
    v_and_b32 v5, 3, v2
    v_lshlrev_b32 v5, 3, v5
    v_bfe_u32 v6, v2, 4, 1
    v_lshl_add_u32 v5, v6, 5, v5
    v_add_u32 v4, v4, v5
    v_add_u32 v4, 98304, v4
    s_bfe_u32 s50, s2, 0x20003
    s_lshl_b32 s50, s50, 1
    s_lshr_b32 s51, s2, 5
    s_add_u32 s50, s50, s51
    s_and_b32 s50, s50, 7
    s_lshl_b32 s51, s52, 1
    s_mul_i32 s51, s51, s50
    s_lshl_b32 s50, s50, 7
    s_lshl_b32 s55, s52, 4
    s_lshl_b32 s53, s42, 12
    s_lshl_b32 s54, s42, 11

    v_xor_b32 v5, 0, v3
    v_lshl_add_u32 v24, v5, 6, v4
    v_xor_b32 v5, 1, v3
    v_lshl_add_u32 v25, v5, 6, v4
    v_xor_b32 v5, 2, v3
    v_lshl_add_u32 v26, v5, 6, v4
    v_xor_b32 v5, 3, v3
    v_lshl_add_u32 v27, v5, 6, v4
    v_lshrrev_b32 v5, 5, v2
    v_lshl_add_u32 v5, v5, 3, v3
    v_lshlrev_b32 v5, 7, v5
    v_and_b32 v6, 3, v2
    v_lshl_add_u32 v5, v6, 3, v5
    v_bfe_u32 v6, v2, 4, 1
    v_lshl_add_u32 v5, v6, 5, v5
    v_add_u32 v5, 106496, v5
    v_lshrrev_b32 v6, 1, v3
    v_lshl_add_u32 v28, v6, 6, v5
    v_xor_b32 v29, 64, v28
    s_cmp_eq_u32 s48, 0
    s_cbranch_scc1 L_k2_wqv
    v_lshrrev_b32 v4, 3, v2
    v_bfe_u32 v6, v2, 4, 1
    v_lshlrev_b32 v6, 2, v6
    v_and_b32 v5, 7, v2
    v_xor_b32 v5, v5, v6
    v_lshrrev_b32 v6, 1, v5
    v_min_u32 v6, 2, v6
    v_lshlrev_b32 v6, 10, v6
    v_and_b32 v7, 1, v5
    v_lshl_add_u32 v6, v7, 4, v6
    s_lshl_b32 s46, s40, 5
    v_add_u32 v5, s46, v6
    s_lshl_b32 s46, s49, 3
    v_add_u32 v4, s46, v4
    v_mul_lo_u32 v6, v4, s44
    v_add_u32 v12, v6, v5
    v_mov_b32 v13, v12
    s_lshl_b32 s54, s49, 10
    s_add_u32 s54, s54, 8192
    s_branch L_k2_wdonev
L_k2_wqv:
    v_lshrrev_b32 v4, 4, v2
    v_and_b32 v5, 15, v2
    v_lshlrev_b32 v6, 2, v4
    v_xor_b32 v5, v5, v6
    v_lshlrev_b32 v5, 4, v5
    s_lshl_b32 s46, s40, 8
    v_add_u32 v5, s46, v5
    s_lshl_b32 s46, s49, 3
    v_add_u32 v4, s46, v4

    v_add_u32 v6, 0, v4
    v_mul_lo_u32 v6, v6, s44
    v_add_u32 v12, v6, v5
    v_add_u32 v6, 4, v4
    v_mul_lo_u32 v6, v6, s44
    v_add_u32 v13, v6, v5
L_k2_wdonev:
    s_mov_b32 s8, s8
    s_mov_b32 s9, s9
    s_mov_b32 s10, 0x4000
    s_mov_b32 s11, 0x00020000
    v_and_b32 v5, 15, v2
    v_lshlrev_b32 v5, 1, v5
    v_lshrrev_b32 v4, 5, v2
    v_lshl_add_u32 v5, v4, 7, v5
    s_lshl_b32 s3, s40, 9
    v_add_u32 v5, s3, v5

    buffer_load_ushort v40, v5, s[8:11], 0 offen offset:0
    buffer_load_ushort v41, v5, s[8:11], 0 offen offset:32
    buffer_load_ushort v42, v5, s[8:11], 0 offen offset:64
    buffer_load_ushort v43, v5, s[8:11], 0 offen offset:96
    buffer_load_ushort v44, v5, s[8:11], 0 offen offset:256
    buffer_load_ushort v45, v5, s[8:11], 0 offen offset:288
    buffer_load_ushort v46, v5, s[8:11], 0 offen offset:320
    buffer_load_ushort v47, v5, s[8:11], 0 offen offset:352
    s_waitcnt lgkmcnt(5)
    v_mfma_f32_32x32x16_bf16 v[96:111], v[196:199], v[224:227], v[96:111]
    ds_read_b64_tr_b16 v[236:237], v57 offset:20480
    ds_read_b64_tr_b16 v[238:239], v57 offset:21504
    s_waitcnt lgkmcnt(7)
    v_mfma_f32_32x32x16_bf16 v[112:127], v[196:199], v[228:231], v[112:127]
    ds_read_b128 v[212:215], v51 offset:4096
    s_add_u32 m0, s53, 65536
    s_nop 0
    buffer_load_dwordx4 v8, s[24:27], s50 offen lds
    s_waitcnt lgkmcnt(7)
    v_mfma_f32_32x32x16_bf16 v[128:143], v[200:203], v[224:227], v[128:143]
    ds_read_b128 v[216:219], v51 offset:8192
    s_add_u32 m0, s53, 66560
    s_nop 0
    buffer_load_dwordx4 v9, s[24:27], s50 offen lds
    s_waitcnt lgkmcnt(8)
    v_mfma_f32_32x32x16_bf16 v[144:159], v[200:203], v[228:231], v[144:159]
    ds_read_b128 v[220:223], v51 offset:12288
    s_add_u32 m0, s53, 67584
    s_nop 0
    buffer_load_dwordx4 v10, s[24:27], s50 offen lds
    s_waitcnt lgkmcnt(8)
    v_mfma_f32_32x32x16_bf16 v[160:175], v[204:207], v[224:227], v[160:175]
    s_add_u32 m0, s53, 68608
    s_nop 0
    buffer_load_dwordx4 v11, s[24:27], s50 offen lds
    s_add_u32 s50, s50, 128
    s_and_b32 s50, s50, 1023
    v_mfma_f32_32x32x16_bf16 v[176:191], v[204:207], v[228:231], v[176:191]
    s_waitcnt lgkmcnt(5)
    v_mfma_f32_32x32x16_bf16 v[64:79], v[208:211], v[232:235], v[64:79]
    s_waitcnt vmcnt(14)
    s_barrier
    ds_read_b64_tr_b16 v[224:225], v56 offset:32768
    ds_read_b64_tr_b16 v[226:227], v56 offset:33792
    s_waitcnt lgkmcnt(5)
    v_mfma_f32_32x32x16_bf16 v[80:95], v[208:211], v[236:239], v[80:95]
    ds_read_b128 v[192:195], v48 offset:32768
    s_waitcnt lgkmcnt(5)
    v_mfma_f32_32x32x16_bf16 v[96:111], v[212:215], v[232:235], v[96:111]
    ds_read_b64_tr_b16 v[228:229], v57 offset:32768
    ds_read_b64_tr_b16 v[230:231], v57 offset:33792
    s_add_u32 m0, s54, 98304
    s_nop 0
    buffer_load_dwordx4 v12, s[28:31], s51 offen lds
    s_waitcnt lgkmcnt(7)
    v_mfma_f32_32x32x16_bf16 v[112:127], v[212:215], v[236:239], v[112:127]
    ds_read_b128 v[196:199], v48 offset:36864
    s_waitcnt lgkmcnt(7)
    v_mfma_f32_32x32x16_bf16 v[128:143], v[216:219], v[232:235], v[128:143]
    ds_read_b128 v[200:203], v48 offset:40960
    s_cbranch_vccnz L_pw_206
    s_add_u32 m0, s54, 99328
    s_nop 0
    buffer_load_dwordx4 v13, s[28:31], s51 offen lds
L_pw_206:
    s_add_u32 s51, s51, s52
    s_cmp_eq_u32 s51, s55
    s_cselect_b32 s51, 0, s51
    s_waitcnt lgkmcnt(8)
    v_mfma_f32_32x32x16_bf16 v[144:159], v[216:219], v[236:239], v[144:159]
    ds_read_b128 v[204:207], v48 offset:45056
    s_waitcnt lgkmcnt(8)
    v_mfma_f32_32x32x16_bf16 v[160:175], v[220:223], v[232:235], v[160:175]
    v_mfma_f32_32x32x16_bf16 v[176:191], v[220:223], v[236:239], v[176:191]
    s_waitcnt lgkmcnt(5)
    v_mfma_f32_32x32x16_bf16 v[64:79], v[192:195], v[224:227], v[64:79]
    ds_read_b64_tr_b16 v[232:233], v56 offset:36864
    ds_read_b64_tr_b16 v[234:235], v56 offset:37888
    s_waitcnt lgkmcnt(5)
    v_mfma_f32_32x32x16_bf16 v[80:95], v[192:195], v[228:231], v[80:95]
    ds_read_b128 v[208:211], v49 offset:32768
    s_waitcnt lgkmcnt(5)
    v_mfma_f32_32x32x16_bf16 v[96:111], v[196:199], v[224:227], v[96:111]
    ds_read_b64_tr_b16 v[236:237], v57 offset:36864
    ds_read_b64_tr_b16 v[238:239], v57 offset:37888
    s_waitcnt lgkmcnt(7)
    v_mfma_f32_32x32x16_bf16 v[112:127], v[196:199], v[228:231], v[112:127]
    ds_read_b128 v[212:215], v49 offset:36864
    s_waitcnt lgkmcnt(7)
    v_mfma_f32_32x32x16_bf16 v[128:143], v[200:203], v[224:227], v[128:143]
    ds_read_b128 v[216:219], v49 offset:40960
    s_waitcnt lgkmcnt(8)
    v_mfma_f32_32x32x16_bf16 v[144:159], v[200:203], v[228:231], v[144:159]
    ds_read_b128 v[220:223], v49 offset:45056
    s_waitcnt lgkmcnt(8)
    v_mfma_f32_32x32x16_bf16 v[160:175], v[204:207], v[224:227], v[160:175]
    v_mfma_f32_32x32x16_bf16 v[176:191], v[204:207], v[228:231], v[176:191]
    s_waitcnt lgkmcnt(5)
    v_mfma_f32_32x32x16_bf16 v[64:79], v[208:211], v[232:235], v[64:79]
    s_cbranch_vccnz L_vw_207
    s_waitcnt vmcnt(14)
    s_branch L_vw_208
L_vw_207:
    s_waitcnt vmcnt(13)
L_vw_208:
    s_barrier
    ds_read_b64_tr_b16 v[224:225], v56 offset:49152
    ds_read_b64_tr_b16 v[226:227], v56 offset:50176
    s_waitcnt lgkmcnt(5)
    v_mfma_f32_32x32x16_bf16 v[80:95], v[208:211], v[236:239], v[80:95]
    ds_read_b128 v[192:195], v50 offset:32768
    s_waitcnt lgkmcnt(5)
    v_mfma_f32_32x32x16_bf16 v[96:111], v[212:215], v[232:235], v[96:111]
    ds_read_b64_tr_b16 v[228:229], v57 offset:49152
    ds_read_b64_tr_b16 v[230:231], v57 offset:50176
    s_add_u32 m0, s54, 114688
    s_nop 0
    buffer_load_dwordx4 v12, s[28:31], s51 offen lds
    s_waitcnt lgkmcnt(7)
    v_mfma_f32_32x32x16_bf16 v[112:127], v[212:215], v[236:239], v[112:127]
    ds_read_b128 v[196:199], v50 offset:36864
    s_waitcnt lgkmcnt(7)
    v_mfma_f32_32x32x16_bf16 v[128:143], v[216:219], v[232:235], v[128:143]
    ds_read_b128 v[200:203], v50 offset:40960
    s_cbranch_vccnz L_pw_209
    s_add_u32 m0, s54, 115712
    s_nop 0
    buffer_load_dwordx4 v13, s[28:31], s51 offen lds
L_pw_209:
    s_add_u32 s51, s51, s52
    s_cmp_eq_u32 s51, s55
    s_cselect_b32 s51, 0, s51
    s_waitcnt lgkmcnt(8)
    v_mfma_f32_32x32x16_bf16 v[144:159], v[216:219], v[236:239], v[144:159]
    ds_read_b128 v[204:207], v50 offset:45056
    s_waitcnt lgkmcnt(8)
    v_mfma_f32_32x32x16_bf16 v[160:175], v[220:223], v[232:235], v[160:175]
    v_mfma_f32_32x32x16_bf16 v[176:191], v[220:223], v[236:239], v[176:191]
    s_waitcnt lgkmcnt(5)
    v_mfma_f32_32x32x16_bf16 v[64:79], v[192:195], v[224:227], v[64:79]
    ds_read_b64_tr_b16 v[232:233], v56 offset:53248
    ds_read_b64_tr_b16 v[234:235], v56 offset:54272
    s_waitcnt lgkmcnt(5)
    v_mfma_f32_32x32x16_bf16 v[80:95], v[192:195], v[228:231], v[80:95]
    ds_read_b128 v[208:211], v51 offset:32768
    s_add_u32 m0, s53, 0
    s_nop 0
    buffer_load_dwordx4 v8, s[24:27], s50 offen lds
    s_waitcnt lgkmcnt(5)
    v_mfma_f32_32x32x16_bf16 v[96:111], v[196:199], v[224:227], v[96:111]
    ds_read_b64_tr_b16 v[236:237], v57 offset:53248
    ds_read_b64_tr_b16 v[238:239], v57 offset:54272
    s_add_u32 m0, s53, 1024
    s_nop 0
    buffer_load_dwordx4 v9, s[24:27], s50 offen lds
    s_waitcnt lgkmcnt(7)
    v_mfma_f32_32x32x16_bf16 v[112:127], v[196:199], v[228:231], v[112:127]
    ds_read_b128 v[212:215], v51 offset:36864
    s_add_u32 m0, s53, 2048
    s_nop 0
    buffer_load_dwordx4 v10, s[24:27], s50 offen lds
    s_waitcnt lgkmcnt(7)
    v_mfma_f32_32x32x16_bf16 v[128:143], v[200:203], v[224:227], v[128:143]
    ds_read_b128 v[216:219], v51 offset:40960
    s_add_u32 m0, s53, 3072
    s_nop 0
    buffer_load_dwordx4 v11, s[24:27], s50 offen lds
    s_add_u32 s50, s50, 128
    s_and_b32 s50, s50, 1023
    s_waitcnt lgkmcnt(8)
    v_mfma_f32_32x32x16_bf16 v[144:159], v[200:203], v[228:231], v[144:159]
    ds_read_b128 v[220:223], v51 offset:45056
    s_waitcnt lgkmcnt(8)
    v_mfma_f32_32x32x16_bf16 v[160:175], v[204:207], v[224:227], v[160:175]
    v_mfma_f32_32x32x16_bf16 v[176:191], v[204:207], v[228:231], v[176:191]
    s_waitcnt lgkmcnt(5)
    v_mfma_f32_32x32x16_bf16 v[64:79], v[208:211], v[232:235], v[64:79]
    s_waitcnt lgkmcnt(3)
    v_mfma_f32_32x32x16_bf16 v[80:95], v[208:211], v[236:239], v[80:95]
    s_waitcnt lgkmcnt(2)
    v_mfma_f32_32x32x16_bf16 v[96:111], v[212:215], v[232:235], v[96:111]
    v_mfma_f32_32x32x16_bf16 v[112:127], v[212:215], v[236:239], v[112:127]
    s_waitcnt lgkmcnt(1)
    v_mfma_f32_32x32x16_bf16 v[128:143], v[216:219], v[232:235], v[128:143]
    v_mfma_f32_32x32x16_bf16 v[144:159], v[216:219], v[236:239], v[144:159]
    s_waitcnt lgkmcnt(0)
    v_mfma_f32_32x32x16_bf16 v[160:175], v[220:223], v[232:235], v[160:175]
    v_mfma_f32_32x32x16_bf16 v[176:191], v[220:223], v[236:239], v[176:191]
    s_nop 15
    v_cvt_pk_bf16_f32 v216, v64, v65
    v_cvt_pk_bf16_f32 v217, v66, v67
    v_cvt_pk_bf16_f32 v218, v68, v69
    v_cvt_pk_bf16_f32 v219, v70, v71
    v_cvt_pk_bf16_f32 v220, v80, v81
    v_cvt_pk_bf16_f32 v221, v82, v83
    v_cvt_pk_bf16_f32 v222, v84, v85
    v_cvt_pk_bf16_f32 v223, v86, v87
    v_cvt_pk_bf16_f32 v224, v72, v73
    v_cvt_pk_bf16_f32 v225, v74, v75
    v_cvt_pk_bf16_f32 v226, v76, v77
    v_cvt_pk_bf16_f32 v227, v78, v79
    v_cvt_pk_bf16_f32 v228, v88, v89
    v_cvt_pk_bf16_f32 v229, v90, v91
    v_cvt_pk_bf16_f32 v230, v92, v93
    v_cvt_pk_bf16_f32 v231, v94, v95
    v_cvt_pk_bf16_f32 v232, v96, v97
    v_cvt_pk_bf16_f32 v233, v98, v99
    v_cvt_pk_bf16_f32 v234, v100, v101
    v_cvt_pk_bf16_f32 v235, v102, v103
    v_cvt_pk_bf16_f32 v236, v112, v113
    v_cvt_pk_bf16_f32 v237, v114, v115
    v_cvt_pk_bf16_f32 v238, v116, v117
    v_cvt_pk_bf16_f32 v239, v118, v119
    v_cvt_pk_bf16_f32 v240, v104, v105
    v_cvt_pk_bf16_f32 v241, v106, v107
    v_cvt_pk_bf16_f32 v242, v108, v109
    v_cvt_pk_bf16_f32 v243, v110, v111
    v_cvt_pk_bf16_f32 v244, v120, v121
    v_cvt_pk_bf16_f32 v245, v122, v123
    v_cvt_pk_bf16_f32 v246, v124, v125
    v_cvt_pk_bf16_f32 v247, v126, v127
    v_cvt_pk_bf16_f32 v248, v128, v129
    v_cvt_pk_bf16_f32 v249, v130, v131
    v_cvt_pk_bf16_f32 v250, v132, v133
    v_cvt_pk_bf16_f32 v251, v134, v135
    v_cvt_pk_bf16_f32 v252, v144, v145
    v_cvt_pk_bf16_f32 v253, v146, v147
    v_cvt_pk_bf16_f32 v254, v148, v149
    v_cvt_pk_bf16_f32 v255, v150, v151
    v_cvt_pk_bf16_f32 v48, v136, v137
    v_cvt_pk_bf16_f32 v49, v138, v139
    v_cvt_pk_bf16_f32 v50, v140, v141
    v_cvt_pk_bf16_f32 v51, v142, v143
    v_cvt_pk_bf16_f32 v52, v152, v153
    v_cvt_pk_bf16_f32 v53, v154, v155
    v_cvt_pk_bf16_f32 v54, v156, v157
    v_cvt_pk_bf16_f32 v55, v158, v159
    v_cvt_pk_bf16_f32 v56, v160, v161
    v_cvt_pk_bf16_f32 v57, v162, v163
    v_cvt_pk_bf16_f32 v58, v164, v165
    v_cvt_pk_bf16_f32 v59, v166, v167
    v_cvt_pk_bf16_f32 v60, v176, v177
    v_cvt_pk_bf16_f32 v61, v178, v179
    v_cvt_pk_bf16_f32 v62, v180, v181
    v_cvt_pk_bf16_f32 v63, v182, v183
    v_cvt_pk_bf16_f32 v32, v168, v169
    v_cvt_pk_bf16_f32 v33, v170, v171
    v_cvt_pk_bf16_f32 v34, v172, v173
    v_cvt_pk_bf16_f32 v35, v174, v175
    v_cvt_pk_bf16_f32 v36, v184, v185
    v_cvt_pk_bf16_f32 v37, v186, v187
    v_cvt_pk_bf16_f32 v38, v188, v189
    v_cvt_pk_bf16_f32 v39, v190, v191
L_k1_q:
    s_barrier
    s_add_u32 m0, s54, 131072
    s_nop 0
    buffer_load_dwordx4 v12, s[28:31], s51 offen lds
    s_cbranch_vccnz L_pw_210
    s_add_u32 m0, s54, 132096
    s_nop 0
    buffer_load_dwordx4 v13, s[28:31], s51 offen lds
L_pw_210:
    s_add_u32 s51, s51, s52
    s_cmp_eq_u32 s51, s55
    s_cselect_b32 s51, 0, s51
    s_cbranch_vccnz L_vw_211
    s_waitcnt vmcnt(8)
    s_branch L_vw_212
L_vw_211:
    s_waitcnt vmcnt(6)
L_vw_212:
    s_barrier
    ds_read_b128 v[160:163], v20 offset:0
    ds_read_b64_tr_b16 v[168:169], v24 offset:0
    ds_read_b64_tr_b16 v[170:171], v24 offset:1024
    ds_read_b64_tr_b16 v[172:173], v25 offset:0
    ds_read_b64_tr_b16 v[174:175], v25 offset:1024
    ds_read_b64_tr_b16 v[176:177], v26 offset:0
    ds_read_b64_tr_b16 v[178:179], v26 offset:1024
    ds_read_b64_tr_b16 v[180:181], v27 offset:0
    ds_read_b64_tr_b16 v[182:183], v27 offset:1024
    ds_read_b64_tr_b16 v[184:185], v28 offset:0
    ds_read_b64_tr_b16 v[186:187], v28 offset:512
    ds_read_b64_tr_b16 v[188:189], v29 offset:0
    ds_read_b64_tr_b16 v[190:191], v29 offset:512
    s_waitcnt lgkmcnt(10)
    v_mfma_f32_32x32x16_bf16 v[64:79], v[168:171], v[160:163], 0
    ds_read_b128 v[164:167], v21 offset:0
    ds_read_b64_tr_b16 v[192:193], v24 offset:4096
    ds_read_b64_tr_b16 v[194:195], v24 offset:5120
    s_waitcnt lgkmcnt(11)
    v_mfma_f32_32x32x16_bf16 v[80:95], v[172:175], v[160:163], 0
    ds_read_b64_tr_b16 v[196:197], v25 offset:4096
    ds_read_b64_tr_b16 v[198:199], v25 offset:5120
    s_waitcnt lgkmcnt(11)
    v_mfma_f32_32x32x16_bf16 v[96:111], v[176:179], v[160:163], 0
    ds_read_b64_tr_b16 v[200:201], v26 offset:4096
    ds_read_b64_tr_b16 v[202:203], v26 offset:5120
    s_waitcnt lgkmcnt(11)
    v_mfma_f32_32x32x16_bf16 v[112:127], v[180:183], v[160:163], 0
    ds_read_b64_tr_b16 v[204:205], v27 offset:4096
    ds_read_b64_tr_b16 v[206:207], v27 offset:5120
    s_waitcnt lgkmcnt(11)
    v_mfma_f32_32x32x16_bf16 v[128:143], v[184:187], v[160:163], 0
    ds_read_b64_tr_b16 v[208:209], v28 offset:2048
    ds_read_b64_tr_b16 v[210:211], v28 offset:2560
    s_waitcnt lgkmcnt(11)
    v_mfma_f32_32x32x16_bf16 v[144:159], v[188:191], v[160:163], 0
    ds_read_b64_tr_b16 v[212:213], v29 offset:2048
    ds_read_b64_tr_b16 v[214:215], v29 offset:2560
    buffer_store_dwordx4 v[216:219], v14, s[32:35], s90 offen offset:0
    s_waitcnt lgkmcnt(10)
    v_mfma_f32_32x32x16_bf16 v[64:79], v[192:195], v[164:167], v[64:79]
    s_cbranch_vccnz L_vw_213
    s_waitcnt vmcnt(5)
    s_branch L_vw_214
L_vw_213:
    s_waitcnt vmcnt(4)
L_vw_214:
    s_barrier
    ds_read_b128 v[160:163], v22 offset:0
    ds_read_b64_tr_b16 v[168:169], v24 offset:16384
    ds_read_b64_tr_b16 v[170:171], v24 offset:17408
    s_cbranch_vccnz L_sk_215
    s_add_u32 m0, s54, 147456
    s_nop 0
    buffer_load_dwordx4 v12, s[28:31], s51 offen lds
L_sk_215:
    s_waitcnt lgkmcnt(11)
    v_mfma_f32_32x32x16_bf16 v[80:95], v[196:199], v[164:167], v[80:95]
    ds_read_b64_tr_b16 v[172:173], v25 offset:16384
    ds_read_b64_tr_b16 v[174:175], v25 offset:17408
    s_cbranch_vccz L_sk_216
    s_add_u32 m0, s54, 147456
    s_nop 0
    buffer_load_dwordx4 v12, s[28:31], s51 offen lds
    s_add_u32 s51, s51, s52
    s_cmp_eq_u32 s51, s55
    s_cselect_b32 s51, 0, s51
L_sk_216:
    s_waitcnt lgkmcnt(11)
    v_mfma_f32_32x32x16_bf16 v[96:111], v[200:203], v[164:167], v[96:111]
    ds_read_b64_tr_b16 v[176:177], v26 offset:16384
    ds_read_b64_tr_b16 v[178:179], v26 offset:17408
    s_waitcnt lgkmcnt(11)
    v_mfma_f32_32x32x16_bf16 v[112:127], v[204:207], v[164:167], v[112:127]
    ds_read_b64_tr_b16 v[180:181], v27 offset:16384
    ds_read_b64_tr_b16 v[182:183], v27 offset:17408
    s_cbranch_vccnz L_sk_217
    s_add_u32 m0, s54, 148480
    s_nop 0
    buffer_load_dwordx4 v13, s[28:31], s51 offen lds
    s_add_u32 s51, s51, s52
    s_cmp_eq_u32 s51, s55
    s_cselect_b32 s51, 0, s51
L_sk_217:
    s_waitcnt lgkmcnt(11)
    v_mfma_f32_32x32x16_bf16 v[128:143], v[208:211], v[164:167], v[128:143]
    ds_read_b64_tr_b16 v[184:185], v28 offset:16384
    ds_read_b64_tr_b16 v[186:187], v28 offset:16896
    s_waitcnt lgkmcnt(11)
    v_mfma_f32_32x32x16_bf16 v[144:159], v[212:215], v[164:167], v[144:159]
    ds_read_b64_tr_b16 v[188:189], v29 offset:16384
    ds_read_b64_tr_b16 v[190:191], v29 offset:16896
    s_waitcnt lgkmcnt(10)
    v_mfma_f32_32x32x16_bf16 v[64:79], v[168:171], v[160:163], v[64:79]
    ds_read_b128 v[164:167], v23 offset:0
    ds_read_b64_tr_b16 v[192:193], v24 offset:20480
    ds_read_b64_tr_b16 v[194:195], v24 offset:21504
    s_cbranch_vccnz L_sk_218
    s_add_u32 m0, s53, 32768
    s_nop 0
    buffer_load_dwordx4 v8, s[24:27], s50 offen lds
L_sk_218:
    s_waitcnt lgkmcnt(11)
    v_mfma_f32_32x32x16_bf16 v[80:95], v[172:175], v[160:163], v[80:95]
    ds_read_b64_tr_b16 v[196:197], v25 offset:20480
    ds_read_b64_tr_b16 v[198:199], v25 offset:21504
    s_cbranch_vccz L_sk_219
    s_add_u32 m0, s53, 32768
    s_nop 0
    buffer_load_dwordx4 v8, s[24:27], s50 offen lds
L_sk_219:
    s_waitcnt lgkmcnt(11)
    v_mfma_f32_32x32x16_bf16 v[96:111], v[176:179], v[160:163], v[96:111]
    ds_read_b64_tr_b16 v[200:201], v26 offset:20480
    ds_read_b64_tr_b16 v[202:203], v26 offset:21504
    s_waitcnt lgkmcnt(11)
    v_mfma_f32_32x32x16_bf16 v[112:127], v[180:183], v[160:163], v[112:127]
    ds_read_b64_tr_b16 v[204:205], v27 offset:20480
    ds_read_b64_tr_b16 v[206:207], v27 offset:21504
    s_cbranch_vccnz L_sk_220
    s_add_u32 m0, s53, 33792
    s_nop 0
    buffer_load_dwordx4 v9, s[24:27], s50 offen lds
L_sk_220:
    s_waitcnt lgkmcnt(11)
    v_mfma_f32_32x32x16_bf16 v[128:143], v[184:187], v[160:163], v[128:143]
    ds_read_b64_tr_b16 v[208:209], v28 offset:18432
    ds_read_b64_tr_b16 v[210:211], v28 offset:18944
    s_cbranch_vccz L_sk_221
    s_add_u32 m0, s53, 33792
    s_nop 0
    buffer_load_dwordx4 v9, s[24:27], s50 offen lds
L_sk_221:
    s_waitcnt lgkmcnt(11)
    v_mfma_f32_32x32x16_bf16 v[144:159], v[188:191], v[160:163], v[144:159]
    ds_read_b64_tr_b16 v[212:213], v29 offset:18432
    ds_read_b64_tr_b16 v[214:215], v29 offset:18944
    buffer_store_dwordx4 v[220:223], v14, s[32:35], s90 offen offset:1024
    s_waitcnt lgkmcnt(10)
    v_mfma_f32_32x32x16_bf16 v[64:79], v[192:195], v[164:167], v[64:79]
    s_cbranch_vccnz L_vw_222
    s_waitcnt vmcnt(5)
    s_branch L_vw_223
L_vw_222:
    s_waitcnt vmcnt(4)
L_vw_223:
    s_barrier
    ds_read_b128 v[160:163], v16 offset:0
    ds_read_b64_tr_b16 v[168:169], v24 offset:32768
    ds_read_b64_tr_b16 v[170:171], v24 offset:33792
    s_cbranch_vccnz L_sk_224
    s_add_u32 m0, s54, 98304
    s_nop 0
    buffer_load_dwordx4 v12, s[28:31], s51 offen lds
L_sk_224:
    s_waitcnt lgkmcnt(11)
    v_mfma_f32_32x32x16_bf16 v[80:95], v[196:199], v[164:167], v[80:95]
    ds_read_b64_tr_b16 v[172:173], v25 offset:32768
    ds_read_b64_tr_b16 v[174:175], v25 offset:33792
    s_cbranch_vccz L_sk_225
    s_add_u32 m0, s54, 98304
    s_nop 0
    buffer_load_dwordx4 v12, s[28:31], s51 offen lds
    s_add_u32 s51, s51, s52
    s_cmp_eq_u32 s51, s55
    s_cselect_b32 s51, 0, s51
L_sk_225:
    s_waitcnt lgkmcnt(11)
    v_mfma_f32_32x32x16_bf16 v[96:111], v[200:203], v[164:167], v[96:111]
    ds_read_b64_tr_b16 v[176:177], v26 offset:32768
    ds_read_b64_tr_b16 v[178:179], v26 offset:33792
    s_waitcnt lgkmcnt(11)
    v_mfma_f32_32x32x16_bf16 v[112:127], v[204:207], v[164:167], v[112:127]
    ds_read_b64_tr_b16 v[180:181], v27 offset:32768
    ds_read_b64_tr_b16 v[182:183], v27 offset:33792
    s_cbranch_vccnz L_sk_226
    s_add_u32 m0, s54, 99328
    s_nop 0
    buffer_load_dwordx4 v13, s[28:31], s51 offen lds
    s_add_u32 s51, s51, s52
    s_cmp_eq_u32 s51, s55
    s_cselect_b32 s51, 0, s51
L_sk_226:
    s_waitcnt lgkmcnt(11)
    v_mfma_f32_32x32x16_bf16 v[128:143], v[208:211], v[164:167], v[128:143]
    ds_read_b64_tr_b16 v[184:185], v28 offset:32768
    ds_read_b64_tr_b16 v[186:187], v28 offset:33280
    s_waitcnt lgkmcnt(11)
    v_mfma_f32_32x32x16_bf16 v[144:159], v[212:215], v[164:167], v[144:159]
    ds_read_b64_tr_b16 v[188:189], v29 offset:32768
    ds_read_b64_tr_b16 v[190:191], v29 offset:33280
    s_waitcnt lgkmcnt(10)
    v_mfma_f32_32x32x16_bf16 v[64:79], v[168:171], v[160:163], v[64:79]
    ds_read_b128 v[164:167], v17 offset:0
    ds_read_b64_tr_b16 v[192:193], v24 offset:36864
    ds_read_b64_tr_b16 v[194:195], v24 offset:37888
    s_cbranch_vccnz L_sk_227
    s_add_u32 m0, s53, 34816
    s_nop 0
    buffer_load_dwordx4 v10, s[24:27], s50 offen lds
L_sk_227:
    s_waitcnt lgkmcnt(11)
    v_mfma_f32_32x32x16_bf16 v[80:95], v[172:175], v[160:163], v[80:95]
    ds_read_b64_tr_b16 v[196:197], v25 offset:36864
    ds_read_b64_tr_b16 v[198:199], v25 offset:37888
    s_cbranch_vccz L_sk_228
    s_add_u32 m0, s53, 34816
    s_nop 0
    buffer_load_dwordx4 v10, s[24:27], s50 offen lds
L_sk_228:
    s_waitcnt lgkmcnt(11)
    v_mfma_f32_32x32x16_bf16 v[96:111], v[176:179], v[160:163], v[96:111]
    ds_read_b64_tr_b16 v[200:201], v26 offset:36864
    ds_read_b64_tr_b16 v[202:203], v26 offset:37888
    s_waitcnt lgkmcnt(11)
    v_mfma_f32_32x32x16_bf16 v[112:127], v[180:183], v[160:163], v[112:127]
    ds_read_b64_tr_b16 v[204:205], v27 offset:36864
    ds_read_b64_tr_b16 v[206:207], v27 offset:37888
    s_cbranch_vccnz L_sk_229
    s_add_u32 m0, s53, 35840
    s_nop 0
    buffer_load_dwordx4 v11, s[24:27], s50 offen lds
    s_add_u32 s50, s50, 128
    s_and_b32 s50, s50, 1023
L_sk_229:
    s_waitcnt lgkmcnt(11)
    v_mfma_f32_32x32x16_bf16 v[128:143], v[184:187], v[160:163], v[128:143]
    ds_read_b64_tr_b16 v[208:209], v28 offset:34816
    ds_read_b64_tr_b16 v[210:211], v28 offset:35328
    s_cbranch_vccz L_sk_230
    s_add_u32 m0, s53, 35840
    s_nop 0
    buffer_load_dwordx4 v11, s[24:27], s50 offen lds
    s_add_u32 s50, s50, 128
    s_and_b32 s50, s50, 1023
L_sk_230:
    s_waitcnt lgkmcnt(11)
    v_mfma_f32_32x32x16_bf16 v[144:159], v[188:191], v[160:163], v[144:159]
    ds_read_b64_tr_b16 v[212:213], v29 offset:34816
    ds_read_b64_tr_b16 v[214:215], v29 offset:35328
    buffer_store_dwordx4 v[224:227], v15, s[32:35], s90 offen offset:0
    s_waitcnt lgkmcnt(10)
    v_mfma_f32_32x32x16_bf16 v[64:79], v[192:195], v[164:167], v[64:79]
    s_cbranch_vccnz L_vw_231
    s_waitcnt vmcnt(5)
    s_branch L_vw_232
L_vw_231:
    s_waitcnt vmcnt(4)
L_vw_232:
    s_barrier
    ds_read_b128 v[160:163], v18 offset:0
    ds_read_b64_tr_b16 v[168:169], v24 offset:49152
    ds_read_b64_tr_b16 v[170:171], v24 offset:50176
    s_cbranch_vccnz L_sk_233
    s_add_u32 m0, s54, 114688
    s_nop 0
    buffer_load_dwordx4 v12, s[28:31], s51 offen lds
L_sk_233:
    s_waitcnt lgkmcnt(11)
    v_mfma_f32_32x32x16_bf16 v[80:95], v[196:199], v[164:167], v[80:95]
    ds_read_b64_tr_b16 v[172:173], v25 offset:49152
    ds_read_b64_tr_b16 v[174:175], v25 offset:50176
    s_cbranch_vccz L_sk_234
    s_add_u32 m0, s54, 114688
    s_nop 0
    buffer_load_dwordx4 v12, s[28:31], s51 offen lds
    s_add_u32 s51, s51, s52
    s_cmp_eq_u32 s51, s55
    s_cselect_b32 s51, 0, s51
L_sk_234:
    s_waitcnt lgkmcnt(11)
    v_mfma_f32_32x32x16_bf16 v[96:111], v[200:203], v[164:167], v[96:111]
    ds_read_b64_tr_b16 v[176:177], v26 offset:49152
    ds_read_b64_tr_b16 v[178:179], v26 offset:50176
    s_waitcnt lgkmcnt(11)
    v_mfma_f32_32x32x16_bf16 v[112:127], v[204:207], v[164:167], v[112:127]
    ds_read_b64_tr_b16 v[180:181], v27 offset:49152
    ds_read_b64_tr_b16 v[182:183], v27 offset:50176
    s_cbranch_vccnz L_sk_235
    s_add_u32 m0, s54, 115712
    s_nop 0
    buffer_load_dwordx4 v13, s[28:31], s51 offen lds
    s_add_u32 s51, s51, s52
    s_cmp_eq_u32 s51, s55
    s_cselect_b32 s51, 0, s51
L_sk_235:
    s_waitcnt lgkmcnt(11)
    v_mfma_f32_32x32x16_bf16 v[128:143], v[208:211], v[164:167], v[128:143]
    ds_read_b64_tr_b16 v[184:185], v28 offset:49152
    ds_read_b64_tr_b16 v[186:187], v28 offset:49664
    s_waitcnt lgkmcnt(11)
    v_mfma_f32_32x32x16_bf16 v[144:159], v[212:215], v[164:167], v[144:159]
    ds_read_b64_tr_b16 v[188:189], v29 offset:49152
    ds_read_b64_tr_b16 v[190:191], v29 offset:49664
    s_waitcnt lgkmcnt(10)
    v_mfma_f32_32x32x16_bf16 v[64:79], v[168:171], v[160:163], v[64:79]
    ds_read_b128 v[164:167], v19 offset:0
    ds_read_b64_tr_b16 v[192:193], v24 offset:53248
    ds_read_b64_tr_b16 v[194:195], v24 offset:54272
    s_cbranch_vccnz L_sk_236
    s_add_u32 m0, s53, 65536
    s_nop 0
    buffer_load_dwordx4 v8, s[24:27], s50 offen lds
L_sk_236:
    s_waitcnt lgkmcnt(11)
    v_mfma_f32_32x32x16_bf16 v[80:95], v[172:175], v[160:163], v[80:95]
    ds_read_b64_tr_b16 v[196:197], v25 offset:53248
    ds_read_b64_tr_b16 v[198:199], v25 offset:54272
    s_cbranch_vccz L_sk_237
    s_add_u32 m0, s53, 65536
    s_nop 0
    buffer_load_dwordx4 v8, s[24:27], s50 offen lds
L_sk_237:
    s_waitcnt lgkmcnt(11)
    v_mfma_f32_32x32x16_bf16 v[96:111], v[176:179], v[160:163], v[96:111]
    ds_read_b64_tr_b16 v[200:201], v26 offset:53248
    ds_read_b64_tr_b16 v[202:203], v26 offset:54272
    s_waitcnt lgkmcnt(11)
    v_mfma_f32_32x32x16_bf16 v[112:127], v[180:183], v[160:163], v[112:127]
    ds_read_b64_tr_b16 v[204:205], v27 offset:53248
    ds_read_b64_tr_b16 v[206:207], v27 offset:54272
    s_cbranch_vccnz L_sk_238
    s_add_u32 m0, s53, 66560
    s_nop 0
    buffer_load_dwordx4 v9, s[24:27], s50 offen lds
L_sk_238:
    s_waitcnt lgkmcnt(11)
    v_mfma_f32_32x32x16_bf16 v[128:143], v[184:187], v[160:163], v[128:143]
    ds_read_b64_tr_b16 v[208:209], v28 offset:51200
    ds_read_b64_tr_b16 v[210:211], v28 offset:51712
    s_cbranch_vccz L_sk_239
    s_add_u32 m0, s53, 66560
    s_nop 0
    buffer_load_dwordx4 v9, s[24:27], s50 offen lds
L_sk_239:
    s_waitcnt lgkmcnt(11)
    v_mfma_f32_32x32x16_bf16 v[144:159], v[188:191], v[160:163], v[144:159]
    ds_read_b64_tr_b16 v[212:213], v29 offset:51200
    ds_read_b64_tr_b16 v[214:215], v29 offset:51712
    buffer_store_dwordx4 v[228:231], v15, s[32:35], s90 offen offset:1024
    s_add_u32 s90, s90, 8192
    s_waitcnt lgkmcnt(10)
    v_mfma_f32_32x32x16_bf16 v[64:79], v[192:195], v[164:167], v[64:79]
    s_cbranch_vccnz L_vw_240
    s_waitcnt vmcnt(5)
    s_branch L_vw_241
L_vw_240:
    s_waitcnt vmcnt(4)
L_vw_241:
    s_barrier
    ds_read_b128 v[160:163], v16 offset:32768
    ds_read_b64_tr_b16 v[168:169], v24 offset:0
    ds_read_b64_tr_b16 v[170:171], v24 offset:1024
    s_cbranch_vccnz L_sk_242
    s_add_u32 m0, s54, 131072
    s_nop 0
    buffer_load_dwordx4 v12, s[28:31], s51 offen lds
L_sk_242:
    s_waitcnt lgkmcnt(11)
    v_mfma_f32_32x32x16_bf16 v[80:95], v[196:199], v[164:167], v[80:95]
    ds_read_b64_tr_b16 v[172:173], v25 offset:0
    ds_read_b64_tr_b16 v[174:175], v25 offset:1024
    s_cbranch_vccz L_sk_243
    s_add_u32 m0, s54, 131072
    s_nop 0
    buffer_load_dwordx4 v12, s[28:31], s51 offen lds
    s_add_u32 s51, s51, s52
    s_cmp_eq_u32 s51, s55
    s_cselect_b32 s51, 0, s51
L_sk_243:
    s_waitcnt lgkmcnt(11)
    v_mfma_f32_32x32x16_bf16 v[96:111], v[200:203], v[164:167], v[96:111]
    ds_read_b64_tr_b16 v[176:177], v26 offset:0
    ds_read_b64_tr_b16 v[178:179], v26 offset:1024
    s_waitcnt lgkmcnt(11)
    v_mfma_f32_32x32x16_bf16 v[112:127], v[204:207], v[164:167], v[112:127]
    ds_read_b64_tr_b16 v[180:181], v27 offset:0
    ds_read_b64_tr_b16 v[182:183], v27 offset:1024
    s_cbranch_vccnz L_sk_244
    s_add_u32 m0, s54, 132096
    s_nop 0
    buffer_load_dwordx4 v13, s[28:31], s51 offen lds
    s_add_u32 s51, s51, s52
    s_cmp_eq_u32 s51, s55
    s_cselect_b32 s51, 0, s51
L_sk_244:
    s_waitcnt lgkmcnt(11)
    v_mfma_f32_32x32x16_bf16 v[128:143], v[208:211], v[164:167], v[128:143]
    ds_read_b64_tr_b16 v[184:185], v28 offset:0
    ds_read_b64_tr_b16 v[186:187], v28 offset:512
    s_waitcnt lgkmcnt(11)
    v_mfma_f32_32x32x16_bf16 v[144:159], v[212:215], v[164:167], v[144:159]
    ds_read_b64_tr_b16 v[188:189], v29 offset:0
    ds_read_b64_tr_b16 v[190:191], v29 offset:512
    s_waitcnt lgkmcnt(10)
    v_mfma_f32_32x32x16_bf16 v[64:79], v[168:171], v[160:163], v[64:79]
    ds_read_b128 v[164:167], v17 offset:32768
    ds_read_b64_tr_b16 v[192:193], v24 offset:4096
    ds_read_b64_tr_b16 v[194:195], v24 offset:5120
    s_cbranch_vccnz L_sk_245
    s_add_u32 m0, s53, 67584
    s_nop 0
    buffer_load_dwordx4 v10, s[24:27], s50 offen lds
L_sk_245:
    s_waitcnt lgkmcnt(11)
    v_mfma_f32_32x32x16_bf16 v[80:95], v[172:175], v[160:163], v[80:95]
    ds_read_b64_tr_b16 v[196:197], v25 offset:4096
    ds_read_b64_tr_b16 v[198:199], v25 offset:5120
    s_cbranch_vccz L_sk_246
    s_add_u32 m0, s53, 67584
    s_nop 0
    buffer_load_dwordx4 v10, s[24:27], s50 offen lds
L_sk_246:
    s_waitcnt lgkmcnt(11)
    v_mfma_f32_32x32x16_bf16 v[96:111], v[176:179], v[160:163], v[96:111]
    ds_read_b64_tr_b16 v[200:201], v26 offset:4096
    ds_read_b64_tr_b16 v[202:203], v26 offset:5120
    s_waitcnt lgkmcnt(11)
    v_mfma_f32_32x32x16_bf16 v[112:127], v[180:183], v[160:163], v[112:127]
    ds_read_b64_tr_b16 v[204:205], v27 offset:4096
    ds_read_b64_tr_b16 v[206:207], v27 offset:5120
    s_cbranch_vccnz L_sk_247
    s_add_u32 m0, s53, 68608
    s_nop 0
    buffer_load_dwordx4 v11, s[24:27], s50 offen lds
    s_add_u32 s50, s50, 128
    s_and_b32 s50, s50, 1023
L_sk_247:
    s_waitcnt lgkmcnt(11)
    v_mfma_f32_32x32x16_bf16 v[128:143], v[184:187], v[160:163], v[128:143]
    ds_read_b64_tr_b16 v[208:209], v28 offset:2048
    ds_read_b64_tr_b16 v[210:211], v28 offset:2560
    s_cbranch_vccz L_sk_248
    s_add_u32 m0, s53, 68608
    s_nop 0
    buffer_load_dwordx4 v11, s[24:27], s50 offen lds
    s_add_u32 s50, s50, 128
    s_and_b32 s50, s50, 1023
L_sk_248:
    s_waitcnt lgkmcnt(11)
    v_mfma_f32_32x32x16_bf16 v[144:159], v[188:191], v[160:163], v[144:159]
    ds_read_b64_tr_b16 v[212:213], v29 offset:2048
    ds_read_b64_tr_b16 v[214:215], v29 offset:2560
    buffer_store_dwordx4 v[232:235], v14, s[32:35], s90 offen offset:0
    s_waitcnt lgkmcnt(10)
    v_mfma_f32_32x32x16_bf16 v[64:79], v[192:195], v[164:167], v[64:79]
    s_cbranch_vccnz L_vw_249
    s_waitcnt vmcnt(5)
    s_branch L_vw_250
L_vw_249:
    s_waitcnt vmcnt(4)
L_vw_250:
    s_barrier
    ds_read_b128 v[160:163], v18 offset:32768
    ds_read_b64_tr_b16 v[168:169], v24 offset:16384
    ds_read_b64_tr_b16 v[170:171], v24 offset:17408
    s_cbranch_vccnz L_sk_251
    s_add_u32 m0, s54, 147456
    s_nop 0
    buffer_load_dwordx4 v12, s[28:31], s51 offen lds
L_sk_251:
    s_waitcnt lgkmcnt(11)
    v_mfma_f32_32x32x16_bf16 v[80:95], v[196:199], v[164:167], v[80:95]
    ds_read_b64_tr_b16 v[172:173], v25 offset:16384
    ds_read_b64_tr_b16 v[174:175], v25 offset:17408
    s_cbranch_vccz L_sk_252
    s_add_u32 m0, s54, 147456
    s_nop 0
    buffer_load_dwordx4 v12, s[28:31], s51 offen lds
    s_add_u32 s51, s51, s52
    s_cmp_eq_u32 s51, s55
    s_cselect_b32 s51, 0, s51
L_sk_252:
    s_waitcnt lgkmcnt(11)
    v_mfma_f32_32x32x16_bf16 v[96:111], v[200:203], v[164:167], v[96:111]
    ds_read_b64_tr_b16 v[176:177], v26 offset:16384
    ds_read_b64_tr_b16 v[178:179], v26 offset:17408
    s_waitcnt lgkmcnt(11)
    v_mfma_f32_32x32x16_bf16 v[112:127], v[204:207], v[164:167], v[112:127]
    ds_read_b64_tr_b16 v[180:181], v27 offset:16384
    ds_read_b64_tr_b16 v[182:183], v27 offset:17408
    s_cbranch_vccnz L_sk_253
    s_add_u32 m0, s54, 148480
    s_nop 0
    buffer_load_dwordx4 v13, s[28:31], s51 offen lds
    s_add_u32 s51, s51, s52
    s_cmp_eq_u32 s51, s55
    s_cselect_b32 s51, 0, s51
L_sk_253:
    s_waitcnt lgkmcnt(11)
    v_mfma_f32_32x32x16_bf16 v[128:143], v[208:211], v[164:167], v[128:143]
    ds_read_b64_tr_b16 v[184:185], v28 offset:16384
    ds_read_b64_tr_b16 v[186:187], v28 offset:16896
    s_waitcnt lgkmcnt(11)
    v_mfma_f32_32x32x16_bf16 v[144:159], v[212:215], v[164:167], v[144:159]
    ds_read_b64_tr_b16 v[188:189], v29 offset:16384
    ds_read_b64_tr_b16 v[190:191], v29 offset:16896
    s_waitcnt lgkmcnt(10)
    v_mfma_f32_32x32x16_bf16 v[64:79], v[168:171], v[160:163], v[64:79]
    ds_read_b128 v[164:167], v19 offset:32768
    ds_read_b64_tr_b16 v[192:193], v24 offset:20480
    ds_read_b64_tr_b16 v[194:195], v24 offset:21504
    s_cbranch_vccnz L_sk_254
    s_add_u32 m0, s53, 0
    s_nop 0
    buffer_load_dwordx4 v8, s[24:27], s50 offen lds
L_sk_254:
    s_waitcnt lgkmcnt(11)
    v_mfma_f32_32x32x16_bf16 v[80:95], v[172:175], v[160:163], v[80:95]
    ds_read_b64_tr_b16 v[196:197], v25 offset:20480
    ds_read_b64_tr_b16 v[198:199], v25 offset:21504
    s_cbranch_vccz L_sk_255
    s_add_u32 m0, s53, 0
    s_nop 0
    buffer_load_dwordx4 v8, s[24:27], s50 offen lds
L_sk_255:
    s_waitcnt lgkmcnt(11)
    v_mfma_f32_32x32x16_bf16 v[96:111], v[176:179], v[160:163], v[96:111]
    ds_read_b64_tr_b16 v[200:201], v26 offset:20480
    ds_read_b64_tr_b16 v[202:203], v26 offset:21504
    s_waitcnt lgkmcnt(11)
    v_mfma_f32_32x32x16_bf16 v[112:127], v[180:183], v[160:163], v[112:127]
    ds_read_b64_tr_b16 v[204:205], v27 offset:20480
    ds_read_b64_tr_b16 v[206:207], v27 offset:21504
    s_cbranch_vccnz L_sk_256
    s_add_u32 m0, s53, 1024
    s_nop 0
    buffer_load_dwordx4 v9, s[24:27], s50 offen lds
L_sk_256:
    s_waitcnt lgkmcnt(11)
    v_mfma_f32_32x32x16_bf16 v[128:143], v[184:187], v[160:163], v[128:143]
    ds_read_b64_tr_b16 v[208:209], v28 offset:18432
    ds_read_b64_tr_b16 v[210:211], v28 offset:18944
    s_cbranch_vccz L_sk_257
    s_add_u32 m0, s53, 1024
    s_nop 0
    buffer_load_dwordx4 v9, s[24:27], s50 offen lds
L_sk_257:
    s_waitcnt lgkmcnt(11)
    v_mfma_f32_32x32x16_bf16 v[144:159], v[188:191], v[160:163], v[144:159]
    ds_read_b64_tr_b16 v[212:213], v29 offset:18432
    ds_read_b64_tr_b16 v[214:215], v29 offset:18944
    buffer_store_dwordx4 v[236:239], v14, s[32:35], s90 offen offset:1024
    s_waitcnt lgkmcnt(10)
    v_mfma_f32_32x32x16_bf16 v[64:79], v[192:195], v[164:167], v[64:79]
    s_cbranch_vccnz L_vw_258
    s_waitcnt vmcnt(5)
    s_branch L_vw_259
L_vw_258:
    s_waitcnt vmcnt(4)
L_vw_259:
    s_barrier
    ds_read_b128 v[160:163], v20 offset:0
    ds_read_b64_tr_b16 v[168:169], v24 offset:32768
    ds_read_b64_tr_b16 v[170:171], v24 offset:33792
    s_cbranch_vccnz L_sk_260
    s_add_u32 m0, s54, 98304
    s_nop 0
    buffer_load_dwordx4 v12, s[28:31], s51 offen lds
L_sk_260:
    s_waitcnt lgkmcnt(11)
    v_mfma_f32_32x32x16_bf16 v[80:95], v[196:199], v[164:167], v[80:95]
    ds_read_b64_tr_b16 v[172:173], v25 offset:32768
    ds_read_b64_tr_b16 v[174:175], v25 offset:33792
    s_cbranch_vccz L_sk_261
    s_add_u32 m0, s54, 98304
    s_nop 0
    buffer_load_dwordx4 v12, s[28:31], s51 offen lds
    s_add_u32 s51, s51, s52
    s_cmp_eq_u32 s51, s55
    s_cselect_b32 s51, 0, s51
L_sk_261:
    s_waitcnt lgkmcnt(11)
    v_mfma_f32_32x32x16_bf16 v[96:111], v[200:203], v[164:167], v[96:111]
    ds_read_b64_tr_b16 v[176:177], v26 offset:32768
    ds_read_b64_tr_b16 v[178:179], v26 offset:33792
    s_waitcnt lgkmcnt(11)
    v_mfma_f32_32x32x16_bf16 v[112:127], v[204:207], v[164:167], v[112:127]
    ds_read_b64_tr_b16 v[180:181], v27 offset:32768
    ds_read_b64_tr_b16 v[182:183], v27 offset:33792
    s_cbranch_vccnz L_sk_262
    s_add_u32 m0, s54, 99328
    s_nop 0
    buffer_load_dwordx4 v13, s[28:31], s51 offen lds
    s_add_u32 s51, s51, s52
    s_cmp_eq_u32 s51, s55
    s_cselect_b32 s51, 0, s51
L_sk_262:
    s_waitcnt lgkmcnt(11)
    v_mfma_f32_32x32x16_bf16 v[128:143], v[208:211], v[164:167], v[128:143]
    ds_read_b64_tr_b16 v[184:185], v28 offset:32768
    ds_read_b64_tr_b16 v[186:187], v28 offset:33280
    s_waitcnt lgkmcnt(11)
    v_mfma_f32_32x32x16_bf16 v[144:159], v[212:215], v[164:167], v[144:159]
    ds_read_b64_tr_b16 v[188:189], v29 offset:32768
    ds_read_b64_tr_b16 v[190:191], v29 offset:33280
    s_waitcnt lgkmcnt(10)
    v_mfma_f32_32x32x16_bf16 v[64:79], v[168:171], v[160:163], v[64:79]
    ds_read_b128 v[164:167], v21 offset:0
    ds_read_b64_tr_b16 v[192:193], v24 offset:36864
    ds_read_b64_tr_b16 v[194:195], v24 offset:37888
    s_cbranch_vccnz L_sk_263
    s_add_u32 m0, s53, 2048
    s_nop 0
    buffer_load_dwordx4 v10, s[24:27], s50 offen lds
L_sk_263:
    s_waitcnt lgkmcnt(11)
    v_mfma_f32_32x32x16_bf16 v[80:95], v[172:175], v[160:163], v[80:95]
    ds_read_b64_tr_b16 v[196:197], v25 offset:36864
    ds_read_b64_tr_b16 v[198:199], v25 offset:37888
    s_cbranch_vccz L_sk_264
    s_add_u32 m0, s53, 2048
    s_nop 0
    buffer_load_dwordx4 v10, s[24:27], s50 offen lds
L_sk_264:
    s_waitcnt lgkmcnt(11)
    v_mfma_f32_32x32x16_bf16 v[96:111], v[176:179], v[160:163], v[96:111]
    ds_read_b64_tr_b16 v[200:201], v26 offset:36864
    ds_read_b64_tr_b16 v[202:203], v26 offset:37888
    s_waitcnt lgkmcnt(11)
    v_mfma_f32_32x32x16_bf16 v[112:127], v[180:183], v[160:163], v[112:127]
    ds_read_b64_tr_b16 v[204:205], v27 offset:36864
    ds_read_b64_tr_b16 v[206:207], v27 offset:37888
    s_cbranch_vccnz L_sk_265
    s_add_u32 m0, s53, 3072
    s_nop 0
    buffer_load_dwordx4 v11, s[24:27], s50 offen lds
    s_add_u32 s50, s50, 128
    s_and_b32 s50, s50, 1023
L_sk_265:
    s_waitcnt lgkmcnt(11)
    v_mfma_f32_32x32x16_bf16 v[128:143], v[184:187], v[160:163], v[128:143]
    ds_read_b64_tr_b16 v[208:209], v28 offset:34816
    ds_read_b64_tr_b16 v[210:211], v28 offset:35328
    s_cbranch_vccz L_sk_266
    s_add_u32 m0, s53, 3072
    s_nop 0
    buffer_load_dwordx4 v11, s[24:27], s50 offen lds
    s_add_u32 s50, s50, 128
    s_and_b32 s50, s50, 1023
L_sk_266:
    s_waitcnt lgkmcnt(11)
    v_mfma_f32_32x32x16_bf16 v[144:159], v[188:191], v[160:163], v[144:159]
    ds_read_b64_tr_b16 v[212:213], v29 offset:34816
    ds_read_b64_tr_b16 v[214:215], v29 offset:35328
    buffer_store_dwordx4 v[240:243], v15, s[32:35], s90 offen offset:0
    s_waitcnt lgkmcnt(10)
    v_mfma_f32_32x32x16_bf16 v[64:79], v[192:195], v[164:167], v[64:79]
    s_cbranch_vccnz L_vw_267
    s_waitcnt vmcnt(5)
    s_branch L_vw_268
L_vw_267:
    s_waitcnt vmcnt(4)
L_vw_268:
    s_barrier
    ds_read_b128 v[160:163], v22 offset:0
    ds_read_b64_tr_b16 v[168:169], v24 offset:49152
    ds_read_b64_tr_b16 v[170:171], v24 offset:50176
    s_cbranch_vccnz L_sk_269
    s_add_u32 m0, s54, 114688
    s_nop 0
    buffer_load_dwordx4 v12, s[28:31], s51 offen lds
L_sk_269:
    s_waitcnt lgkmcnt(11)
    v_mfma_f32_32x32x16_bf16 v[80:95], v[196:199], v[164:167], v[80:95]
    ds_read_b64_tr_b16 v[172:173], v25 offset:49152
    ds_read_b64_tr_b16 v[174:175], v25 offset:50176
    s_cbranch_vccz L_sk_270
    s_add_u32 m0, s54, 114688
    s_nop 0
    buffer_load_dwordx4 v12, s[28:31], s51 offen lds
    s_add_u32 s51, s51, s52
    s_cmp_eq_u32 s51, s55
    s_cselect_b32 s51, 0, s51
L_sk_270:
    s_waitcnt lgkmcnt(11)
    v_mfma_f32_32x32x16_bf16 v[96:111], v[200:203], v[164:167], v[96:111]
    ds_read_b64_tr_b16 v[176:177], v26 offset:49152
    ds_read_b64_tr_b16 v[178:179], v26 offset:50176
    s_waitcnt lgkmcnt(11)
    v_mfma_f32_32x32x16_bf16 v[112:127], v[204:207], v[164:167], v[112:127]
    ds_read_b64_tr_b16 v[180:181], v27 offset:49152
    ds_read_b64_tr_b16 v[182:183], v27 offset:50176
    s_cbranch_vccnz L_sk_271
    s_add_u32 m0, s54, 115712
    s_nop 0
    buffer_load_dwordx4 v13, s[28:31], s51 offen lds
    s_add_u32 s51, s51, s52
    s_cmp_eq_u32 s51, s55
    s_cselect_b32 s51, 0, s51
L_sk_271:
    s_waitcnt lgkmcnt(11)
    v_mfma_f32_32x32x16_bf16 v[128:143], v[208:211], v[164:167], v[128:143]
    ds_read_b64_tr_b16 v[184:185], v28 offset:49152
    ds_read_b64_tr_b16 v[186:187], v28 offset:49664
    s_waitcnt lgkmcnt(11)
    v_mfma_f32_32x32x16_bf16 v[144:159], v[212:215], v[164:167], v[144:159]
    ds_read_b64_tr_b16 v[188:189], v29 offset:49152
    ds_read_b64_tr_b16 v[190:191], v29 offset:49664
    s_waitcnt lgkmcnt(10)
    v_mfma_f32_32x32x16_bf16 v[64:79], v[168:171], v[160:163], v[64:79]
    ds_read_b128 v[164:167], v23 offset:0
    ds_read_b64_tr_b16 v[192:193], v24 offset:53248
    ds_read_b64_tr_b16 v[194:195], v24 offset:54272
    s_cbranch_vccnz L_sk_272
    s_add_u32 m0, s53, 32768
    s_nop 0
    buffer_load_dwordx4 v8, s[24:27], s50 offen lds
L_sk_272:
    s_waitcnt lgkmcnt(11)
    v_mfma_f32_32x32x16_bf16 v[80:95], v[172:175], v[160:163], v[80:95]
    ds_read_b64_tr_b16 v[196:197], v25 offset:53248
    ds_read_b64_tr_b16 v[198:199], v25 offset:54272
    s_cbranch_vccz L_sk_273
    s_add_u32 m0, s53, 32768
    s_nop 0
    buffer_load_dwordx4 v8, s[24:27], s50 offen lds
L_sk_273:
    s_waitcnt lgkmcnt(11)
    v_mfma_f32_32x32x16_bf16 v[96:111], v[176:179], v[160:163], v[96:111]
    ds_read_b64_tr_b16 v[200:201], v26 offset:53248
    ds_read_b64_tr_b16 v[202:203], v26 offset:54272
    s_waitcnt lgkmcnt(11)
    v_mfma_f32_32x32x16_bf16 v[112:127], v[180:183], v[160:163], v[112:127]
    ds_read_b64_tr_b16 v[204:205], v27 offset:53248
    ds_read_b64_tr_b16 v[206:207], v27 offset:54272
    s_cbranch_vccnz L_sk_274
    s_add_u32 m0, s53, 33792
    s_nop 0
    buffer_load_dwordx4 v9, s[24:27], s50 offen lds
L_sk_274:
    s_waitcnt lgkmcnt(11)
    v_mfma_f32_32x32x16_bf16 v[128:143], v[184:187], v[160:163], v[128:143]
    ds_read_b64_tr_b16 v[208:209], v28 offset:51200
    ds_read_b64_tr_b16 v[210:211], v28 offset:51712
    s_cbranch_vccz L_sk_275
    s_add_u32 m0, s53, 33792
    s_nop 0
    buffer_load_dwordx4 v9, s[24:27], s50 offen lds
L_sk_275:
    s_waitcnt lgkmcnt(11)
    v_mfma_f32_32x32x16_bf16 v[144:159], v[188:191], v[160:163], v[144:159]
    ds_read_b64_tr_b16 v[212:213], v29 offset:51200
    ds_read_b64_tr_b16 v[214:215], v29 offset:51712
    buffer_store_dwordx4 v[244:247], v15, s[32:35], s90 offen offset:1024
    s_add_u32 s90, s90, 8192
    s_waitcnt lgkmcnt(10)
    v_mfma_f32_32x32x16_bf16 v[64:79], v[192:195], v[164:167], v[64:79]
    s_cbranch_vccnz L_vw_276
    s_waitcnt vmcnt(5)
    s_branch L_vw_277
L_vw_276:
    s_waitcnt vmcnt(4)
L_vw_277:
    s_barrier
    ds_read_b128 v[160:163], v16 offset:0
    ds_read_b64_tr_b16 v[168:169], v24 offset:0
    ds_read_b64_tr_b16 v[170:171], v24 offset:1024
    s_cbranch_vccnz L_sk_278
    s_add_u32 m0, s54, 131072
    s_nop 0
    buffer_load_dwordx4 v12, s[28:31], s51 offen lds
L_sk_278:
    s_waitcnt lgkmcnt(11)
    v_mfma_f32_32x32x16_bf16 v[80:95], v[196:199], v[164:167], v[80:95]
    ds_read_b64_tr_b16 v[172:173], v25 offset:0
    ds_read_b64_tr_b16 v[174:175], v25 offset:1024
    s_cbranch_vccz L_sk_279
    s_add_u32 m0, s54, 131072
    s_nop 0
    buffer_load_dwordx4 v12, s[28:31], s51 offen lds
    s_add_u32 s51, s51, s52
    s_cmp_eq_u32 s51, s55
    s_cselect_b32 s51, 0, s51
L_sk_279:
    s_waitcnt lgkmcnt(11)
    v_mfma_f32_32x32x16_bf16 v[96:111], v[200:203], v[164:167], v[96:111]
    ds_read_b64_tr_b16 v[176:177], v26 offset:0
    ds_read_b64_tr_b16 v[178:179], v26 offset:1024
    s_waitcnt lgkmcnt(11)
    v_mfma_f32_32x32x16_bf16 v[112:127], v[204:207], v[164:167], v[112:127]
    ds_read_b64_tr_b16 v[180:181], v27 offset:0
    ds_read_b64_tr_b16 v[182:183], v27 offset:1024
    s_cbranch_vccnz L_sk_280
    s_add_u32 m0, s54, 132096
    s_nop 0
    buffer_load_dwordx4 v13, s[28:31], s51 offen lds
    s_add_u32 s51, s51, s52
    s_cmp_eq_u32 s51, s55
    s_cselect_b32 s51, 0, s51
L_sk_280:
    s_waitcnt lgkmcnt(11)
    v_mfma_f32_32x32x16_bf16 v[128:143], v[208:211], v[164:167], v[128:143]
    ds_read_b64_tr_b16 v[184:185], v28 offset:0
    ds_read_b64_tr_b16 v[186:187], v28 offset:512
    s_waitcnt lgkmcnt(11)
    v_mfma_f32_32x32x16_bf16 v[144:159], v[212:215], v[164:167], v[144:159]
    ds_read_b64_tr_b16 v[188:189], v29 offset:0
    ds_read_b64_tr_b16 v[190:191], v29 offset:512
    s_waitcnt lgkmcnt(10)
    v_mfma_f32_32x32x16_bf16 v[64:79], v[168:171], v[160:163], v[64:79]
    ds_read_b128 v[164:167], v17 offset:0
    ds_read_b64_tr_b16 v[192:193], v24 offset:4096
    ds_read_b64_tr_b16 v[194:195], v24 offset:5120
    s_cbranch_vccnz L_sk_281
    s_add_u32 m0, s53, 34816
    s_nop 0
    buffer_load_dwordx4 v10, s[24:27], s50 offen lds
L_sk_281:
    s_waitcnt lgkmcnt(11)
    v_mfma_f32_32x32x16_bf16 v[80:95], v[172:175], v[160:163], v[80:95]
    ds_read_b64_tr_b16 v[196:197], v25 offset:4096
    ds_read_b64_tr_b16 v[198:199], v25 offset:5120
    s_cbranch_vccz L_sk_282
    s_add_u32 m0, s53, 34816
    s_nop 0
    buffer_load_dwordx4 v10, s[24:27], s50 offen lds
L_sk_282:
    s_waitcnt lgkmcnt(11)
    v_mfma_f32_32x32x16_bf16 v[96:111], v[176:179], v[160:163], v[96:111]
    ds_read_b64_tr_b16 v[200:201], v26 offset:4096
    ds_read_b64_tr_b16 v[202:203], v26 offset:5120
    s_waitcnt lgkmcnt(11)
    v_mfma_f32_32x32x16_bf16 v[112:127], v[180:183], v[160:163], v[112:127]
    ds_read_b64_tr_b16 v[204:205], v27 offset:4096
    ds_read_b64_tr_b16 v[206:207], v27 offset:5120
    s_cbranch_vccnz L_sk_283
    s_add_u32 m0, s53, 35840
    s_nop 0
    buffer_load_dwordx4 v11, s[24:27], s50 offen lds
    s_add_u32 s50, s50, 128
    s_and_b32 s50, s50, 1023
L_sk_283:
    s_waitcnt lgkmcnt(11)
    v_mfma_f32_32x32x16_bf16 v[128:143], v[184:187], v[160:163], v[128:143]
    ds_read_b64_tr_b16 v[208:209], v28 offset:2048
    ds_read_b64_tr_b16 v[210:211], v28 offset:2560
    s_cbranch_vccz L_sk_284
    s_add_u32 m0, s53, 35840
    s_nop 0
    buffer_load_dwordx4 v11, s[24:27], s50 offen lds
    s_add_u32 s50, s50, 128
    s_and_b32 s50, s50, 1023
L_sk_284:
    s_waitcnt lgkmcnt(11)
    v_mfma_f32_32x32x16_bf16 v[144:159], v[188:191], v[160:163], v[144:159]
    ds_read_b64_tr_b16 v[212:213], v29 offset:2048
    ds_read_b64_tr_b16 v[214:215], v29 offset:2560
    buffer_store_dwordx4 v[248:251], v14, s[32:35], s90 offen offset:0
    s_waitcnt lgkmcnt(10)
    v_mfma_f32_32x32x16_bf16 v[64:79], v[192:195], v[164:167], v[64:79]
    s_cbranch_vccnz L_vw_285
    s_waitcnt vmcnt(5)
    s_branch L_vw_286
L_vw_285:
    s_waitcnt vmcnt(4)
L_vw_286:
    s_barrier
    ds_read_b128 v[160:163], v18 offset:0
    ds_read_b64_tr_b16 v[168:169], v24 offset:16384
    ds_read_b64_tr_b16 v[170:171], v24 offset:17408
    s_cbranch_vccnz L_sk_287
    s_add_u32 m0, s54, 147456
    s_nop 0
    buffer_load_dwordx4 v12, s[28:31], s51 offen lds
L_sk_287:
    s_waitcnt lgkmcnt(11)
    v_mfma_f32_32x32x16_bf16 v[80:95], v[196:199], v[164:167], v[80:95]
    ds_read_b64_tr_b16 v[172:173], v25 offset:16384
    ds_read_b64_tr_b16 v[174:175], v25 offset:17408
    s_cbranch_vccz L_sk_288
    s_add_u32 m0, s54, 147456
    s_nop 0
    buffer_load_dwordx4 v12, s[28:31], s51 offen lds
    s_add_u32 s51, s51, s52
    s_cmp_eq_u32 s51, s55
    s_cselect_b32 s51, 0, s51
L_sk_288:
    s_waitcnt lgkmcnt(11)
    v_mfma_f32_32x32x16_bf16 v[96:111], v[200:203], v[164:167], v[96:111]
    ds_read_b64_tr_b16 v[176:177], v26 offset:16384
    ds_read_b64_tr_b16 v[178:179], v26 offset:17408
    s_waitcnt lgkmcnt(11)
    v_mfma_f32_32x32x16_bf16 v[112:127], v[204:207], v[164:167], v[112:127]
    ds_read_b64_tr_b16 v[180:181], v27 offset:16384
    ds_read_b64_tr_b16 v[182:183], v27 offset:17408
    s_cbranch_vccnz L_sk_289
    s_add_u32 m0, s54, 148480
    s_nop 0
    buffer_load_dwordx4 v13, s[28:31], s51 offen lds
    s_add_u32 s51, s51, s52
    s_cmp_eq_u32 s51, s55
    s_cselect_b32 s51, 0, s51
L_sk_289:
    s_waitcnt lgkmcnt(11)
    v_mfma_f32_32x32x16_bf16 v[128:143], v[208:211], v[164:167], v[128:143]
    ds_read_b64_tr_b16 v[184:185], v28 offset:16384
    ds_read_b64_tr_b16 v[186:187], v28 offset:16896
    s_waitcnt lgkmcnt(11)
    v_mfma_f32_32x32x16_bf16 v[144:159], v[212:215], v[164:167], v[144:159]
    ds_read_b64_tr_b16 v[188:189], v29 offset:16384
    ds_read_b64_tr_b16 v[190:191], v29 offset:16896
    s_waitcnt lgkmcnt(10)
    v_mfma_f32_32x32x16_bf16 v[64:79], v[168:171], v[160:163], v[64:79]
    ds_read_b128 v[164:167], v19 offset:0
    ds_read_b64_tr_b16 v[192:193], v24 offset:20480
    ds_read_b64_tr_b16 v[194:195], v24 offset:21504
    s_cbranch_vccnz L_sk_290
    s_add_u32 m0, s53, 65536
    s_nop 0
    buffer_load_dwordx4 v8, s[24:27], s50 offen lds
L_sk_290:
    s_waitcnt lgkmcnt(11)
    v_mfma_f32_32x32x16_bf16 v[80:95], v[172:175], v[160:163], v[80:95]
    ds_read_b64_tr_b16 v[196:197], v25 offset:20480
    ds_read_b64_tr_b16 v[198:199], v25 offset:21504
    s_cbranch_vccz L_sk_291
    s_add_u32 m0, s53, 65536
    s_nop 0
    buffer_load_dwordx4 v8, s[24:27], s50 offen lds
L_sk_291:
    s_waitcnt lgkmcnt(11)
    v_mfma_f32_32x32x16_bf16 v[96:111], v[176:179], v[160:163], v[96:111]
    ds_read_b64_tr_b16 v[200:201], v26 offset:20480
    ds_read_b64_tr_b16 v[202:203], v26 offset:21504
    s_waitcnt lgkmcnt(11)
    v_mfma_f32_32x32x16_bf16 v[112:127], v[180:183], v[160:163], v[112:127]
    ds_read_b64_tr_b16 v[204:205], v27 offset:20480
    ds_read_b64_tr_b16 v[206:207], v27 offset:21504
    s_cbranch_vccnz L_sk_292
    s_add_u32 m0, s53, 66560
    s_nop 0
    buffer_load_dwordx4 v9, s[24:27], s50 offen lds
L_sk_292:
    s_waitcnt lgkmcnt(11)
    v_mfma_f32_32x32x16_bf16 v[128:143], v[184:187], v[160:163], v[128:143]
    ds_read_b64_tr_b16 v[208:209], v28 offset:18432
    ds_read_b64_tr_b16 v[210:211], v28 offset:18944
    s_cbranch_vccz L_sk_293
    s_add_u32 m0, s53, 66560
    s_nop 0
    buffer_load_dwordx4 v9, s[24:27], s50 offen lds
L_sk_293:
    s_waitcnt lgkmcnt(11)
    v_mfma_f32_32x32x16_bf16 v[144:159], v[188:191], v[160:163], v[144:159]
    ds_read_b64_tr_b16 v[212:213], v29 offset:18432
    ds_read_b64_tr_b16 v[214:215], v29 offset:18944
    buffer_store_dwordx4 v[252:255], v14, s[32:35], s90 offen offset:1024
    s_waitcnt lgkmcnt(10)
    v_mfma_f32_32x32x16_bf16 v[64:79], v[192:195], v[164:167], v[64:79]
    s_cbranch_vccnz L_vw_294
    s_waitcnt vmcnt(5)
    s_branch L_vw_295
L_vw_294:
    s_waitcnt vmcnt(4)
L_vw_295:
    s_barrier
    ds_read_b128 v[160:163], v16 offset:32768
    ds_read_b64_tr_b16 v[168:169], v24 offset:32768
    ds_read_b64_tr_b16 v[170:171], v24 offset:33792
    s_cbranch_vccnz L_sk_296
    s_add_u32 m0, s54, 98304
    s_nop 0
    buffer_load_dwordx4 v12, s[28:31], s51 offen lds
L_sk_296:
    s_waitcnt lgkmcnt(11)
    v_mfma_f32_32x32x16_bf16 v[80:95], v[196:199], v[164:167], v[80:95]
    ds_read_b64_tr_b16 v[172:173], v25 offset:32768
    ds_read_b64_tr_b16 v[174:175], v25 offset:33792
    s_cbranch_vccz L_sk_297
    s_add_u32 m0, s54, 98304
    s_nop 0
    buffer_load_dwordx4 v12, s[28:31], s51 offen lds
    s_add_u32 s51, s51, s52
    s_cmp_eq_u32 s51, s55
    s_cselect_b32 s51, 0, s51
L_sk_297:
    s_waitcnt lgkmcnt(11)
    v_mfma_f32_32x32x16_bf16 v[96:111], v[200:203], v[164:167], v[96:111]
    ds_read_b64_tr_b16 v[176:177], v26 offset:32768
    ds_read_b64_tr_b16 v[178:179], v26 offset:33792
    s_waitcnt lgkmcnt(11)
    v_mfma_f32_32x32x16_bf16 v[112:127], v[204:207], v[164:167], v[112:127]
    ds_read_b64_tr_b16 v[180:181], v27 offset:32768
    ds_read_b64_tr_b16 v[182:183], v27 offset:33792
    s_cbranch_vccnz L_sk_298
    s_add_u32 m0, s54, 99328
    s_nop 0
    buffer_load_dwordx4 v13, s[28:31], s51 offen lds
    s_add_u32 s51, s51, s52
    s_cmp_eq_u32 s51, s55
    s_cselect_b32 s51, 0, s51
L_sk_298:
    s_waitcnt lgkmcnt(11)
    v_mfma_f32_32x32x16_bf16 v[128:143], v[208:211], v[164:167], v[128:143]
    ds_read_b64_tr_b16 v[184:185], v28 offset:32768
    ds_read_b64_tr_b16 v[186:187], v28 offset:33280
    s_waitcnt lgkmcnt(11)
    v_mfma_f32_32x32x16_bf16 v[144:159], v[212:215], v[164:167], v[144:159]
    ds_read_b64_tr_b16 v[188:189], v29 offset:32768
    ds_read_b64_tr_b16 v[190:191], v29 offset:33280
    s_waitcnt lgkmcnt(10)
    v_mfma_f32_32x32x16_bf16 v[64:79], v[168:171], v[160:163], v[64:79]
    ds_read_b128 v[164:167], v17 offset:32768
    ds_read_b64_tr_b16 v[192:193], v24 offset:36864
    ds_read_b64_tr_b16 v[194:195], v24 offset:37888
    s_cbranch_vccnz L_sk_299
    s_add_u32 m0, s53, 67584
    s_nop 0
    buffer_load_dwordx4 v10, s[24:27], s50 offen lds
L_sk_299:
    s_waitcnt lgkmcnt(11)
    v_mfma_f32_32x32x16_bf16 v[80:95], v[172:175], v[160:163], v[80:95]
    ds_read_b64_tr_b16 v[196:197], v25 offset:36864
    ds_read_b64_tr_b16 v[198:199], v25 offset:37888
    s_cbranch_vccz L_sk_300
    s_add_u32 m0, s53, 67584
    s_nop 0
    buffer_load_dwordx4 v10, s[24:27], s50 offen lds
L_sk_300:
    s_waitcnt lgkmcnt(11)
    v_mfma_f32_32x32x16_bf16 v[96:111], v[176:179], v[160:163], v[96:111]
    ds_read_b64_tr_b16 v[200:201], v26 offset:36864
    ds_read_b64_tr_b16 v[202:203], v26 offset:37888
    s_waitcnt lgkmcnt(11)
    v_mfma_f32_32x32x16_bf16 v[112:127], v[180:183], v[160:163], v[112:127]
    ds_read_b64_tr_b16 v[204:205], v27 offset:36864
    ds_read_b64_tr_b16 v[206:207], v27 offset:37888
    s_cbranch_vccnz L_sk_301
    s_add_u32 m0, s53, 68608
    s_nop 0
    buffer_load_dwordx4 v11, s[24:27], s50 offen lds
    s_add_u32 s50, s50, 128
    s_and_b32 s50, s50, 1023
L_sk_301:
    s_waitcnt lgkmcnt(11)
    v_mfma_f32_32x32x16_bf16 v[128:143], v[184:187], v[160:163], v[128:143]
    ds_read_b64_tr_b16 v[208:209], v28 offset:34816
    ds_read_b64_tr_b16 v[210:211], v28 offset:35328
    s_cbranch_vccz L_sk_302
    s_add_u32 m0, s53, 68608
    s_nop 0
    buffer_load_dwordx4 v11, s[24:27], s50 offen lds
    s_add_u32 s50, s50, 128
    s_and_b32 s50, s50, 1023
L_sk_302:
    s_waitcnt lgkmcnt(11)
    v_mfma_f32_32x32x16_bf16 v[144:159], v[188:191], v[160:163], v[144:159]
    ds_read_b64_tr_b16 v[212:213], v29 offset:34816
    ds_read_b64_tr_b16 v[214:215], v29 offset:35328
    buffer_store_dwordx4 v[48:51], v15, s[32:35], s90 offen offset:0
    s_waitcnt lgkmcnt(10)
    v_mfma_f32_32x32x16_bf16 v[64:79], v[192:195], v[164:167], v[64:79]
    s_cbranch_vccnz L_vw_303
    s_waitcnt vmcnt(5)
    s_branch L_vw_304
L_vw_303:
    s_waitcnt vmcnt(4)
L_vw_304:
    s_barrier
    ds_read_b128 v[160:163], v18 offset:32768
    ds_read_b64_tr_b16 v[168:169], v24 offset:49152
    ds_read_b64_tr_b16 v[170:171], v24 offset:50176
    s_cbranch_vccnz L_sk_305
    s_add_u32 m0, s54, 114688
    s_nop 0
    buffer_load_dwordx4 v12, s[28:31], s51 offen lds
L_sk_305:
    s_waitcnt lgkmcnt(11)
    v_mfma_f32_32x32x16_bf16 v[80:95], v[196:199], v[164:167], v[80:95]
    ds_read_b64_tr_b16 v[172:173], v25 offset:49152
    ds_read_b64_tr_b16 v[174:175], v25 offset:50176
    s_cbranch_vccz L_sk_306
    s_add_u32 m0, s54, 114688
    s_nop 0
    buffer_load_dwordx4 v12, s[28:31], s51 offen lds
    s_add_u32 s51, s51, s52
    s_cmp_eq_u32 s51, s55
    s_cselect_b32 s51, 0, s51
L_sk_306:
    s_waitcnt lgkmcnt(11)
    v_mfma_f32_32x32x16_bf16 v[96:111], v[200:203], v[164:167], v[96:111]
    ds_read_b64_tr_b16 v[176:177], v26 offset:49152
    ds_read_b64_tr_b16 v[178:179], v26 offset:50176
    s_waitcnt lgkmcnt(11)
    v_mfma_f32_32x32x16_bf16 v[112:127], v[204:207], v[164:167], v[112:127]
    ds_read_b64_tr_b16 v[180:181], v27 offset:49152
    ds_read_b64_tr_b16 v[182:183], v27 offset:50176
    s_cbranch_vccnz L_sk_307
    s_add_u32 m0, s54, 115712
    s_nop 0
    buffer_load_dwordx4 v13, s[28:31], s51 offen lds
    s_add_u32 s51, s51, s52
    s_cmp_eq_u32 s51, s55
    s_cselect_b32 s51, 0, s51
L_sk_307:
    s_waitcnt lgkmcnt(11)
    v_mfma_f32_32x32x16_bf16 v[128:143], v[208:211], v[164:167], v[128:143]
    ds_read_b64_tr_b16 v[184:185], v28 offset:49152
    ds_read_b64_tr_b16 v[186:187], v28 offset:49664
    s_waitcnt lgkmcnt(11)
    v_mfma_f32_32x32x16_bf16 v[144:159], v[212:215], v[164:167], v[144:159]
    ds_read_b64_tr_b16 v[188:189], v29 offset:49152
    ds_read_b64_tr_b16 v[190:191], v29 offset:49664
    s_waitcnt lgkmcnt(10)
    v_mfma_f32_32x32x16_bf16 v[64:79], v[168:171], v[160:163], v[64:79]
    ds_read_b128 v[164:167], v19 offset:32768
    ds_read_b64_tr_b16 v[192:193], v24 offset:53248
    ds_read_b64_tr_b16 v[194:195], v24 offset:54272
    s_cbranch_vccnz L_sk_308
    s_add_u32 m0, s53, 0
    s_nop 0
    buffer_load_dwordx4 v8, s[24:27], s50 offen lds
L_sk_308:
    s_waitcnt lgkmcnt(11)
    v_mfma_f32_32x32x16_bf16 v[80:95], v[172:175], v[160:163], v[80:95]
    ds_read_b64_tr_b16 v[196:197], v25 offset:53248
    ds_read_b64_tr_b16 v[198:199], v25 offset:54272
    s_cbranch_vccz L_sk_309
    s_add_u32 m0, s53, 0
    s_nop 0
    buffer_load_dwordx4 v8, s[24:27], s50 offen lds
L_sk_309:
    s_waitcnt lgkmcnt(11)
    v_mfma_f32_32x32x16_bf16 v[96:111], v[176:179], v[160:163], v[96:111]
    ds_read_b64_tr_b16 v[200:201], v26 offset:53248
    ds_read_b64_tr_b16 v[202:203], v26 offset:54272
    s_waitcnt lgkmcnt(11)
    v_mfma_f32_32x32x16_bf16 v[112:127], v[180:183], v[160:163], v[112:127]
    ds_read_b64_tr_b16 v[204:205], v27 offset:53248
    ds_read_b64_tr_b16 v[206:207], v27 offset:54272
    s_cbranch_vccnz L_sk_310
    s_add_u32 m0, s53, 1024
    s_nop 0
    buffer_load_dwordx4 v9, s[24:27], s50 offen lds
L_sk_310:
    s_waitcnt lgkmcnt(11)
    v_mfma_f32_32x32x16_bf16 v[128:143], v[184:187], v[160:163], v[128:143]
    ds_read_b64_tr_b16 v[208:209], v28 offset:51200
    ds_read_b64_tr_b16 v[210:211], v28 offset:51712
    s_cbranch_vccz L_sk_311
    s_add_u32 m0, s53, 1024
    s_nop 0
    buffer_load_dwordx4 v9, s[24:27], s50 offen lds
L_sk_311:
    s_waitcnt lgkmcnt(11)
    v_mfma_f32_32x32x16_bf16 v[144:159], v[188:191], v[160:163], v[144:159]
    ds_read_b64_tr_b16 v[212:213], v29 offset:51200
    ds_read_b64_tr_b16 v[214:215], v29 offset:51712
    buffer_store_dwordx4 v[52:55], v15, s[32:35], s90 offen offset:1024
    s_add_u32 s90, s90, 8192
    s_waitcnt lgkmcnt(10)
    v_mfma_f32_32x32x16_bf16 v[64:79], v[192:195], v[164:167], v[64:79]
    s_cbranch_vccnz L_vw_312
    s_waitcnt vmcnt(5)
    s_branch L_vw_313
L_vw_312:
    s_waitcnt vmcnt(4)
L_vw_313:
    s_barrier
    ds_read_b128 v[160:163], v20 offset:0
    ds_read_b64_tr_b16 v[168:169], v24 offset:0
    ds_read_b64_tr_b16 v[170:171], v24 offset:1024
    s_cbranch_vccnz L_sk_314
    s_add_u32 m0, s54, 131072
    s_nop 0
    buffer_load_dwordx4 v12, s[28:31], s51 offen lds
L_sk_314:
    s_waitcnt lgkmcnt(11)
    v_mfma_f32_32x32x16_bf16 v[80:95], v[196:199], v[164:167], v[80:95]
    ds_read_b64_tr_b16 v[172:173], v25 offset:0
    ds_read_b64_tr_b16 v[174:175], v25 offset:1024
    s_cbranch_vccz L_sk_315
    s_add_u32 m0, s54, 131072
    s_nop 0
    buffer_load_dwordx4 v12, s[28:31], s51 offen lds
    s_add_u32 s51, s51, s52
    s_cmp_eq_u32 s51, s55
    s_cselect_b32 s51, 0, s51
L_sk_315:
    s_waitcnt lgkmcnt(11)
    v_mfma_f32_32x32x16_bf16 v[96:111], v[200:203], v[164:167], v[96:111]
    ds_read_b64_tr_b16 v[176:177], v26 offset:0
    ds_read_b64_tr_b16 v[178:179], v26 offset:1024
    s_waitcnt lgkmcnt(11)
    v_mfma_f32_32x32x16_bf16 v[112:127], v[204:207], v[164:167], v[112:127]
    ds_read_b64_tr_b16 v[180:181], v27 offset:0
    ds_read_b64_tr_b16 v[182:183], v27 offset:1024
    s_cbranch_vccnz L_sk_316
    s_add_u32 m0, s54, 132096
    s_nop 0
    buffer_load_dwordx4 v13, s[28:31], s51 offen lds
    s_add_u32 s51, s51, s52
    s_cmp_eq_u32 s51, s55
    s_cselect_b32 s51, 0, s51
L_sk_316:
    s_waitcnt lgkmcnt(11)
    v_mfma_f32_32x32x16_bf16 v[128:143], v[208:211], v[164:167], v[128:143]
    ds_read_b64_tr_b16 v[184:185], v28 offset:0
    ds_read_b64_tr_b16 v[186:187], v28 offset:512
    s_waitcnt lgkmcnt(11)
    v_mfma_f32_32x32x16_bf16 v[144:159], v[212:215], v[164:167], v[144:159]
    ds_read_b64_tr_b16 v[188:189], v29 offset:0
    ds_read_b64_tr_b16 v[190:191], v29 offset:512
    s_waitcnt lgkmcnt(10)
    v_mfma_f32_32x32x16_bf16 v[64:79], v[168:171], v[160:163], v[64:79]
    ds_read_b128 v[164:167], v21 offset:0
    ds_read_b64_tr_b16 v[192:193], v24 offset:4096
    ds_read_b64_tr_b16 v[194:195], v24 offset:5120
    s_cbranch_vccnz L_sk_317
    s_add_u32 m0, s53, 2048
    s_nop 0
    buffer_load_dwordx4 v10, s[24:27], s50 offen lds
L_sk_317:
    s_waitcnt lgkmcnt(11)
    v_mfma_f32_32x32x16_bf16 v[80:95], v[172:175], v[160:163], v[80:95]
    ds_read_b64_tr_b16 v[196:197], v25 offset:4096
    ds_read_b64_tr_b16 v[198:199], v25 offset:5120
    s_cbranch_vccz L_sk_318
    s_add_u32 m0, s53, 2048
    s_nop 0
    buffer_load_dwordx4 v10, s[24:27], s50 offen lds
L_sk_318:
    s_waitcnt lgkmcnt(11)
    v_mfma_f32_32x32x16_bf16 v[96:111], v[176:179], v[160:163], v[96:111]
    ds_read_b64_tr_b16 v[200:201], v26 offset:4096
    ds_read_b64_tr_b16 v[202:203], v26 offset:5120
    s_waitcnt lgkmcnt(11)
    v_mfma_f32_32x32x16_bf16 v[112:127], v[180:183], v[160:163], v[112:127]
    ds_read_b64_tr_b16 v[204:205], v27 offset:4096
    ds_read_b64_tr_b16 v[206:207], v27 offset:5120
    s_cbranch_vccnz L_sk_319
    s_add_u32 m0, s53, 3072
    s_nop 0
    buffer_load_dwordx4 v11, s[24:27], s50 offen lds
    s_add_u32 s50, s50, 128
    s_and_b32 s50, s50, 1023
L_sk_319:
    s_waitcnt lgkmcnt(11)
    v_mfma_f32_32x32x16_bf16 v[128:143], v[184:187], v[160:163], v[128:143]
    ds_read_b64_tr_b16 v[208:209], v28 offset:2048
    ds_read_b64_tr_b16 v[210:211], v28 offset:2560
    s_cbranch_vccz L_sk_320
    s_add_u32 m0, s53, 3072
    s_nop 0
    buffer_load_dwordx4 v11, s[24:27], s50 offen lds
    s_add_u32 s50, s50, 128
    s_and_b32 s50, s50, 1023
L_sk_320:
    s_waitcnt lgkmcnt(11)
    v_mfma_f32_32x32x16_bf16 v[144:159], v[188:191], v[160:163], v[144:159]
    ds_read_b64_tr_b16 v[212:213], v29 offset:2048
    ds_read_b64_tr_b16 v[214:215], v29 offset:2560
    buffer_store_dwordx4 v[56:59], v14, s[32:35], s90 offen offset:0
    s_waitcnt lgkmcnt(10)
    v_mfma_f32_32x32x16_bf16 v[64:79], v[192:195], v[164:167], v[64:79]
    s_cbranch_vccnz L_vw_321
    s_waitcnt vmcnt(5)
    s_branch L_vw_322
L_vw_321:
    s_waitcnt vmcnt(4)
L_vw_322:
    s_barrier
    ds_read_b128 v[160:163], v22 offset:0
    ds_read_b64_tr_b16 v[168:169], v24 offset:16384
    ds_read_b64_tr_b16 v[170:171], v24 offset:17408
    s_cbranch_vccnz L_sk_323
    s_add_u32 m0, s54, 147456
    s_nop 0
    buffer_load_dwordx4 v12, s[28:31], s51 offen lds
L_sk_323:
    s_waitcnt lgkmcnt(11)
    v_mfma_f32_32x32x16_bf16 v[80:95], v[196:199], v[164:167], v[80:95]
    ds_read_b64_tr_b16 v[172:173], v25 offset:16384
    ds_read_b64_tr_b16 v[174:175], v25 offset:17408
    s_cbranch_vccz L_sk_324
    s_add_u32 m0, s54, 147456
    s_nop 0
    buffer_load_dwordx4 v12, s[28:31], s51 offen lds
    s_add_u32 s51, s51, s52
    s_cmp_eq_u32 s51, s55
    s_cselect_b32 s51, 0, s51
L_sk_324:
    s_waitcnt lgkmcnt(11)
    v_mfma_f32_32x32x16_bf16 v[96:111], v[200:203], v[164:167], v[96:111]
    ds_read_b64_tr_b16 v[176:177], v26 offset:16384
    ds_read_b64_tr_b16 v[178:179], v26 offset:17408
    s_waitcnt lgkmcnt(11)
    v_mfma_f32_32x32x16_bf16 v[112:127], v[204:207], v[164:167], v[112:127]
    ds_read_b64_tr_b16 v[180:181], v27 offset:16384
    ds_read_b64_tr_b16 v[182:183], v27 offset:17408
    s_cbranch_vccnz L_sk_325
    s_add_u32 m0, s54, 148480
    s_nop 0
    buffer_load_dwordx4 v13, s[28:31], s51 offen lds
    s_add_u32 s51, s51, s52
    s_cmp_eq_u32 s51, s55
    s_cselect_b32 s51, 0, s51
L_sk_325:
    s_waitcnt lgkmcnt(11)
    v_mfma_f32_32x32x16_bf16 v[128:143], v[208:211], v[164:167], v[128:143]
    ds_read_b64_tr_b16 v[184:185], v28 offset:16384
    ds_read_b64_tr_b16 v[186:187], v28 offset:16896
    s_waitcnt lgkmcnt(11)
    v_mfma_f32_32x32x16_bf16 v[144:159], v[212:215], v[164:167], v[144:159]
    ds_read_b64_tr_b16 v[188:189], v29 offset:16384
    ds_read_b64_tr_b16 v[190:191], v29 offset:16896
    s_waitcnt lgkmcnt(10)
    v_mfma_f32_32x32x16_bf16 v[64:79], v[168:171], v[160:163], v[64:79]
    ds_read_b128 v[164:167], v23 offset:0
    ds_read_b64_tr_b16 v[192:193], v24 offset:20480
    ds_read_b64_tr_b16 v[194:195], v24 offset:21504
    s_waitcnt lgkmcnt(11)
    v_mfma_f32_32x32x16_bf16 v[80:95], v[172:175], v[160:163], v[80:95]
    ds_read_b64_tr_b16 v[196:197], v25 offset:20480
    ds_read_b64_tr_b16 v[198:199], v25 offset:21504
    s_waitcnt lgkmcnt(11)
    v_mfma_f32_32x32x16_bf16 v[96:111], v[176:179], v[160:163], v[96:111]
    ds_read_b64_tr_b16 v[200:201], v26 offset:20480
    ds_read_b64_tr_b16 v[202:203], v26 offset:21504
    s_waitcnt lgkmcnt(11)
    v_mfma_f32_32x32x16_bf16 v[112:127], v[180:183], v[160:163], v[112:127]
    ds_read_b64_tr_b16 v[204:205], v27 offset:20480
    ds_read_b64_tr_b16 v[206:207], v27 offset:21504
    s_waitcnt lgkmcnt(11)
    v_mfma_f32_32x32x16_bf16 v[128:143], v[184:187], v[160:163], v[128:143]
    ds_read_b64_tr_b16 v[208:209], v28 offset:18432
    ds_read_b64_tr_b16 v[210:211], v28 offset:18944
    s_waitcnt lgkmcnt(11)
    v_mfma_f32_32x32x16_bf16 v[144:159], v[188:191], v[160:163], v[144:159]
    ds_read_b64_tr_b16 v[212:213], v29 offset:18432
    ds_read_b64_tr_b16 v[214:215], v29 offset:18944
    buffer_store_dwordx4 v[60:63], v14, s[32:35], s90 offen offset:1024
    s_waitcnt lgkmcnt(10)
    v_mfma_f32_32x32x16_bf16 v[64:79], v[192:195], v[164:167], v[64:79]
    s_cbranch_vccnz L_vw_326
    s_waitcnt vmcnt(3)
    s_branch L_vw_327
L_vw_326:
    s_waitcnt vmcnt(2)
L_vw_327:
    s_barrier
    ds_read_b128 v[160:163], v16 offset:0
    ds_read_b64_tr_b16 v[168:169], v24 offset:32768
    ds_read_b64_tr_b16 v[170:171], v24 offset:33792
    s_waitcnt lgkmcnt(11)
    v_mfma_f32_32x32x16_bf16 v[80:95], v[196:199], v[164:167], v[80:95]
    ds_read_b64_tr_b16 v[172:173], v25 offset:32768
    ds_read_b64_tr_b16 v[174:175], v25 offset:33792
    s_waitcnt lgkmcnt(11)
    v_mfma_f32_32x32x16_bf16 v[96:111], v[200:203], v[164:167], v[96:111]
    ds_read_b64_tr_b16 v[176:177], v26 offset:32768
    ds_read_b64_tr_b16 v[178:179], v26 offset:33792
    s_waitcnt lgkmcnt(11)
    v_mfma_f32_32x32x16_bf16 v[112:127], v[204:207], v[164:167], v[112:127]
    ds_read_b64_tr_b16 v[180:181], v27 offset:32768
    ds_read_b64_tr_b16 v[182:183], v27 offset:33792
    s_waitcnt lgkmcnt(11)
    v_mfma_f32_32x32x16_bf16 v[128:143], v[208:211], v[164:167], v[128:143]
    ds_read_b64_tr_b16 v[184:185], v28 offset:32768
    ds_read_b64_tr_b16 v[186:187], v28 offset:33280
    s_waitcnt lgkmcnt(11)
    v_mfma_f32_32x32x16_bf16 v[144:159], v[212:215], v[164:167], v[144:159]
    ds_read_b64_tr_b16 v[188:189], v29 offset:32768
    ds_read_b64_tr_b16 v[190:191], v29 offset:33280
    s_waitcnt lgkmcnt(10)
    v_mfma_f32_32x32x16_bf16 v[64:79], v[168:171], v[160:163], v[64:79]
    ds_read_b128 v[164:167], v17 offset:0
    ds_read_b64_tr_b16 v[192:193], v24 offset:36864
    ds_read_b64_tr_b16 v[194:195], v24 offset:37888
    s_waitcnt lgkmcnt(11)
    v_mfma_f32_32x32x16_bf16 v[80:95], v[172:175], v[160:163], v[80:95]
    ds_read_b64_tr_b16 v[196:197], v25 offset:36864
    ds_read_b64_tr_b16 v[198:199], v25 offset:37888
    s_waitcnt lgkmcnt(11)
    v_mfma_f32_32x32x16_bf16 v[96:111], v[176:179], v[160:163], v[96:111]
    ds_read_b64_tr_b16 v[200:201], v26 offset:36864
    ds_read_b64_tr_b16 v[202:203], v26 offset:37888
    s_waitcnt lgkmcnt(11)
    v_mfma_f32_32x32x16_bf16 v[112:127], v[180:183], v[160:163], v[112:127]
    ds_read_b64_tr_b16 v[204:205], v27 offset:36864
    ds_read_b64_tr_b16 v[206:207], v27 offset:37888
    s_waitcnt lgkmcnt(11)
    v_mfma_f32_32x32x16_bf16 v[128:143], v[184:187], v[160:163], v[128:143]
    ds_read_b64_tr_b16 v[208:209], v28 offset:34816
    ds_read_b64_tr_b16 v[210:211], v28 offset:35328
    s_waitcnt lgkmcnt(11)
    v_mfma_f32_32x32x16_bf16 v[144:159], v[188:191], v[160:163], v[144:159]
    ds_read_b64_tr_b16 v[212:213], v29 offset:34816
    ds_read_b64_tr_b16 v[214:215], v29 offset:35328
    buffer_store_dwordx4 v[32:35], v15, s[32:35], s90 offen offset:0
    s_waitcnt lgkmcnt(10)
    v_mfma_f32_32x32x16_bf16 v[64:79], v[192:195], v[164:167], v[64:79]
    s_waitcnt vmcnt(1)
    s_barrier
    ds_read_b128 v[160:163], v18 offset:0
    ds_read_b64_tr_b16 v[168:169], v24 offset:49152
    ds_read_b64_tr_b16 v[170:171], v24 offset:50176
    s_waitcnt lgkmcnt(11)
    v_mfma_f32_32x32x16_bf16 v[80:95], v[196:199], v[164:167], v[80:95]
    ds_read_b64_tr_b16 v[172:173], v25 offset:49152
    ds_read_b64_tr_b16 v[174:175], v25 offset:50176
    s_waitcnt lgkmcnt(11)
    v_mfma_f32_32x32x16_bf16 v[96:111], v[200:203], v[164:167], v[96:111]
    ds_read_b64_tr_b16 v[176:177], v26 offset:49152
    ds_read_b64_tr_b16 v[178:179], v26 offset:50176
    s_waitcnt lgkmcnt(11)
    v_mfma_f32_32x32x16_bf16 v[112:127], v[204:207], v[164:167], v[112:127]
    ds_read_b64_tr_b16 v[180:181], v27 offset:49152
    ds_read_b64_tr_b16 v[182:183], v27 offset:50176
    s_waitcnt lgkmcnt(11)
    v_mfma_f32_32x32x16_bf16 v[128:143], v[208:211], v[164:167], v[128:143]
    ds_read_b64_tr_b16 v[184:185], v28 offset:49152
    ds_read_b64_tr_b16 v[186:187], v28 offset:49664
    s_waitcnt lgkmcnt(11)
    v_mfma_f32_32x32x16_bf16 v[144:159], v[212:215], v[164:167], v[144:159]
    ds_read_b64_tr_b16 v[188:189], v29 offset:49152
    ds_read_b64_tr_b16 v[190:191], v29 offset:49664
    s_waitcnt lgkmcnt(10)
    v_mfma_f32_32x32x16_bf16 v[64:79], v[168:171], v[160:163], v[64:79]
    ds_read_b128 v[164:167], v19 offset:0
    ds_read_b64_tr_b16 v[192:193], v24 offset:53248
    ds_read_b64_tr_b16 v[194:195], v24 offset:54272
    s_waitcnt lgkmcnt(11)
    v_mfma_f32_32x32x16_bf16 v[80:95], v[172:175], v[160:163], v[80:95]
    ds_read_b64_tr_b16 v[196:197], v25 offset:53248
    ds_read_b64_tr_b16 v[198:199], v25 offset:54272
    s_waitcnt lgkmcnt(11)
    v_mfma_f32_32x32x16_bf16 v[96:111], v[176:179], v[160:163], v[96:111]
    ds_read_b64_tr_b16 v[200:201], v26 offset:53248
    ds_read_b64_tr_b16 v[202:203], v26 offset:54272
    s_waitcnt lgkmcnt(11)
    v_mfma_f32_32x32x16_bf16 v[112:127], v[180:183], v[160:163], v[112:127]
    ds_read_b64_tr_b16 v[204:205], v27 offset:53248
    ds_read_b64_tr_b16 v[206:207], v27 offset:54272
    s_waitcnt lgkmcnt(11)
    v_mfma_f32_32x32x16_bf16 v[128:143], v[184:187], v[160:163], v[128:143]
    ds_read_b64_tr_b16 v[208:209], v28 offset:51200
    ds_read_b64_tr_b16 v[210:211], v28 offset:51712
    s_waitcnt lgkmcnt(11)
    v_mfma_f32_32x32x16_bf16 v[144:159], v[188:191], v[160:163], v[144:159]
    ds_read_b64_tr_b16 v[212:213], v29 offset:51200
    ds_read_b64_tr_b16 v[214:215], v29 offset:51712
    buffer_store_dwordx4 v[36:39], v15, s[32:35], s90 offen offset:1024
    s_add_u32 s90, s90, 8192
    s_waitcnt lgkmcnt(10)
    v_mfma_f32_32x32x16_bf16 v[64:79], v[192:195], v[164:167], v[64:79]
    s_waitcnt lgkmcnt(8)
    v_mfma_f32_32x32x16_bf16 v[80:95], v[196:199], v[164:167], v[80:95]
    s_waitcnt lgkmcnt(6)
    v_mfma_f32_32x32x16_bf16 v[96:111], v[200:203], v[164:167], v[96:111]
    s_waitcnt lgkmcnt(4)
    v_mfma_f32_32x32x16_bf16 v[112:127], v[204:207], v[164:167], v[112:127]
    s_waitcnt lgkmcnt(2)
    v_mfma_f32_32x32x16_bf16 v[128:143], v[208:211], v[164:167], v[128:143]
    s_waitcnt lgkmcnt(0)
    v_mfma_f32_32x32x16_bf16 v[144:159], v[212:215], v[164:167], v[144:159]
    s_nop 15
    v_and_b32 v3, 31, v2
    v_lshrrev_b32 v4, 5, v2
    s_lshl_b32 s46, s40, 3
    s_add_u32 s46, s46, s41
    s_lshl_b32 s46, s46, 16
    s_lshl_b32 s47, s42, 13
    s_add_u32 s46, s46, s47
    s_add_u32 s91, s46, 0x0
    v_lshlrev_b32 v5, 4, v2
    v_add_u32 v14, 4096, v5
    s_barrier

    v_cvt_pk_bf16_f32 v160, v128, v129
    v_cvt_pk_bf16_f32 v161, v130, v131
    v_cvt_pk_bf16_f32 v162, v132, v133
    v_cvt_pk_bf16_f32 v163, v134, v135
    v_cvt_pk_bf16_f32 v164, v136, v137
    v_cvt_pk_bf16_f32 v165, v138, v139
    v_cvt_pk_bf16_f32 v166, v140, v141
    v_cvt_pk_bf16_f32 v167, v142, v143
    v_cvt_pk_bf16_f32 v168, v144, v145
    v_cvt_pk_bf16_f32 v169, v146, v147
    v_cvt_pk_bf16_f32 v170, v148, v149
    v_cvt_pk_bf16_f32 v171, v150, v151
    v_cmp_lt_u32 vcc, 15, v3
    v_mov_b32 v6, 0
    v_mov_b32 v7, 0x80008000
    s_nop 0
    v_cndmask_b32 v6, v6, v7, vcc
    v_lshl_or_b32 v28, v41, 16, v40
    v_xor_b32 v28, v28, v6
    v_lshl_or_b32 v29, v43, 16, v42
    v_xor_b32 v29, v29, v6
    v_lshl_or_b32 v30, v45, 16, v44
    v_xor_b32 v30, v30, v6
    v_lshl_or_b32 v31, v47, 16, v46
    v_xor_b32 v31, v31, v6
    s_nop 1
    v_mfma_f32_32x32x16_bf16 v[128:143], v[28:31], v[164:167], 0

    v_cvt_pk_bf16_f32 v208, v64, v65
    v_cvt_pk_bf16_f32 v209, v66, v67
    v_cvt_pk_bf16_f32 v210, v68, v69
    v_cvt_pk_bf16_f32 v211, v70, v71
    buffer_store_dwordx4 v[208:211], v5, s[32:35], s91 offen offset:0
    v_cvt_pk_bf16_f32 v212, v72, v73
    v_cvt_pk_bf16_f32 v213, v74, v75
    v_cvt_pk_bf16_f32 v214, v76, v77
    v_cvt_pk_bf16_f32 v215, v78, v79
    buffer_store_dwordx4 v[212:215], v5, s[32:35], s91 offen offset:1024
    v_cvt_pk_bf16_f32 v216, v80, v81
    v_cvt_pk_bf16_f32 v217, v82, v83
    v_cvt_pk_bf16_f32 v218, v84, v85
    v_cvt_pk_bf16_f32 v219, v86, v87
    buffer_store_dwordx4 v[216:219], v5, s[32:35], s91 offen offset:2048
    v_cvt_pk_bf16_f32 v220, v88, v89
    v_cvt_pk_bf16_f32 v221, v90, v91
    v_cvt_pk_bf16_f32 v222, v92, v93
    v_cvt_pk_bf16_f32 v223, v94, v95
    buffer_store_dwordx4 v[220:223], v5, s[32:35], s91 offen offset:3072
    v_cvt_pk_bf16_f32 v224, v96, v97
    v_cvt_pk_bf16_f32 v225, v98, v99
    v_cvt_pk_bf16_f32 v226, v100, v101
    v_cvt_pk_bf16_f32 v227, v102, v103
    buffer_store_dwordx4 v[224:227], v14, s[32:35], s91 offen offset:0
    v_cvt_pk_bf16_f32 v228, v104, v105
    v_cvt_pk_bf16_f32 v229, v106, v107
    v_cvt_pk_bf16_f32 v230, v108, v109
    v_cvt_pk_bf16_f32 v231, v110, v111
    buffer_store_dwordx4 v[228:231], v14, s[32:35], s91 offen offset:1024
    v_cvt_pk_bf16_f32 v232, v112, v113
    v_cvt_pk_bf16_f32 v233, v114, v115
    v_cvt_pk_bf16_f32 v234, v116, v117
    v_cvt_pk_bf16_f32 v235, v118, v119
    buffer_store_dwordx4 v[232:235], v14, s[32:35], s91 offen offset:2048
    v_cvt_pk_bf16_f32 v236, v120, v121
    v_cvt_pk_bf16_f32 v237, v122, v123
    v_cvt_pk_bf16_f32 v238, v124, v125
    v_cvt_pk_bf16_f32 v239, v126, v127
    buffer_store_dwordx4 v[236:239], v14, s[32:35], s91 offen offset:3072
    s_mov_b32 s56, s40
    s_mov_b32 s40, 0x3fb8aa3b
    s_lshl_b32 s28, s42, 12
    s_add_u32 s28, s28, 32768
    v_lshlrev_b32 v33, 6, v3
    v_add_u32 v33, s28, v33
    v_lshl_add_u32 v34, v4, 3, v33
    v_lshl_add_u32 v33, v4, 4, v33
    v_bfe_u32 v7, v2, 2, 2
    v_lshl_add_u32 v6, v4, 3, v7
    v_lshlrev_b32 v6, 6, v6
    v_and_b32 v7, 3, v2
    v_lshl_add_u32 v6, v7, 3, v6
    v_bfe_u32 v7, v2, 4, 1
    v_lshl_add_u32 v6, v7, 5, v6
    v_add_u32 v35, s28, v6
    v_mov_b32 v40, 0
    v_mov_b32 v41, 0
    v_mov_b32 v42, 0
    v_mov_b32 v43, 0
    v_mov_b32 v7, 0x3f80
    v_cmp_eq_u32 vcc, 0, v4
    s_nop 1
    v_cndmask_b32 v40, v40, v7, vcc
    ds_write_b128 v33, v[40:43] offset:2080
    ds_write_b128 v33, v[168:171] offset:2048

    v_cvt_pk_bf16_f32 v44, v128, v129
    v_lshlrev_b32 v128, 16, v44
    v_and_b32 v129, 0xffff0000, v44
    v_cvt_pk_bf16_f32 v44, v130, v131
    v_lshlrev_b32 v130, 16, v44
    v_and_b32 v131, 0xffff0000, v44
    v_cvt_pk_bf16_f32 v44, v132, v133
    v_lshlrev_b32 v132, 16, v44
    v_and_b32 v133, 0xffff0000, v44
    v_cvt_pk_bf16_f32 v44, v134, v135
    v_lshlrev_b32 v134, 16, v44
    v_and_b32 v135, 0xffff0000, v44
    v_cvt_pk_bf16_f32 v44, v136, v137
    v_lshlrev_b32 v136, 16, v44
    v_and_b32 v137, 0xffff0000, v44
    v_cvt_pk_bf16_f32 v44, v138, v139
    v_lshlrev_b32 v138, 16, v44
    v_and_b32 v139, 0xffff0000, v44
    v_cvt_pk_bf16_f32 v44, v140, v141
    v_lshlrev_b32 v140, 16, v44
    v_and_b32 v141, 0xffff0000, v44
    v_cvt_pk_bf16_f32 v44, v142, v143
    v_lshlrev_b32 v142, 16, v44
    v_and_b32 v143, 0xffff0000, v44
    v_max3_f32 v44, v128, v129, v130
    v_max3_f32 v44, v44, v131, v132
    v_max3_f32 v44, v44, v133, v134
    v_max_f32 v44, v44, v135
    v_mov_b32 v45, v44
    s_nop 1
    v_permlane32_swap_b32 v44, v45
    s_nop 1
    v_max_f32 v44, v44, v45
    v_mul_f32 v44, s40, v44

    v_fma_f32 v128, v128, s40, -v44
    v_fma_f32 v129, v129, s40, -v44
    v_fma_f32 v130, v130, s40, -v44
    v_fma_f32 v131, v131, s40, -v44
    v_fma_f32 v132, v132, s40, -v44
    v_fma_f32 v133, v133, s40, -v44
    v_fma_f32 v134, v134, s40, -v44
    v_fma_f32 v135, v135, s40, -v44
    v_exp_f32 v128, v128
    v_exp_f32 v129, v129
    v_exp_f32 v130, v130
    v_exp_f32 v131, v131
    v_exp_f32 v132, v132
    v_exp_f32 v133, v133
    v_exp_f32 v134, v134
    v_exp_f32 v135, v135
    s_nop 0
    v_add_f32 v44, v128, v129
    v_add_f32 v44, v44, v130
    v_add_f32 v44, v44, v131
    v_add_f32 v44, v44, v132
    v_add_f32 v44, v44, v133
    v_add_f32 v44, v44, v134
    v_add_f32 v44, v44, v135
    v_mov_b32 v45, v44
    s_nop 1
    v_permlane32_swap_b32 v44, v45
    s_nop 1
    v_add_f32 v44, v44, v45
    v_rcp_f32 v44, v44
    s_nop 0

    v_mul_f32 v128, v128, v44
    v_mul_f32 v129, v129, v44
    v_mul_f32 v130, v130, v44
    v_mul_f32 v131, v131, v44
    v_mul_f32 v132, v132, v44
    v_mul_f32 v133, v133, v44
    v_mul_f32 v134, v134, v44
    v_mul_f32 v135, v135, v44
    v_max3_f32 v44, v136, v137, v138
    v_max3_f32 v44, v44, v139, v140
    v_max3_f32 v44, v44, v141, v142
    v_max_f32 v44, v44, v143
    v_mov_b32 v45, v44
    s_nop 1
    v_permlane32_swap_b32 v44, v45
    s_nop 1
    v_max_f32 v44, v44, v45
    v_mul_f32 v44, s40, v44

    v_fma_f32 v136, v136, s40, -v44
    v_fma_f32 v137, v137, s40, -v44
    v_fma_f32 v138, v138, s40, -v44
    v_fma_f32 v139, v139, s40, -v44
    v_fma_f32 v140, v140, s40, -v44
    v_fma_f32 v141, v141, s40, -v44
    v_fma_f32 v142, v142, s40, -v44
    v_fma_f32 v143, v143, s40, -v44
    v_exp_f32 v136, v136
    v_exp_f32 v137, v137
    v_exp_f32 v138, v138
    v_exp_f32 v139, v139
    v_exp_f32 v140, v140
    v_exp_f32 v141, v141
    v_exp_f32 v142, v142
    v_exp_f32 v143, v143
    s_nop 0
    v_add_f32 v44, v136, v137
    v_add_f32 v44, v44, v138
    v_add_f32 v44, v44, v139
    v_add_f32 v44, v44, v140
    v_add_f32 v44, v44, v141
    v_add_f32 v44, v44, v142
    v_add_f32 v44, v44, v143
    v_mov_b32 v45, v44
    s_nop 1
    v_permlane32_swap_b32 v44, v45
    s_nop 1
    v_add_f32 v44, v44, v45
    v_rcp_f32 v44, v44
    s_nop 0

    v_mul_f32 v136, v136, v44
    v_mul_f32 v137, v137, v44
    v_mul_f32 v138, v138, v44
    v_mul_f32 v139, v139, v44
    v_mul_f32 v140, v140, v44
    v_mul_f32 v141, v141, v44
    v_mul_f32 v142, v142, v44
    v_mul_f32 v143, v143, v44
    v_cvt_pk_bf16_f32 v64, v128, v129
    v_cvt_pk_bf16_f32 v65, v130, v131
    v_cvt_pk_bf16_f32 v66, v132, v133
    v_cvt_pk_bf16_f32 v67, v134, v135
    v_cvt_pk_bf16_f32 v68, v136, v137
    v_cvt_pk_bf16_f32 v69, v138, v139
    v_cvt_pk_bf16_f32 v70, v140, v141
    v_cvt_pk_bf16_f32 v71, v142, v143
    ds_write_b64 v34, v[64:65] offset:0
    ds_write_b64 v34, v[66:67] offset:16
    ds_write_b64 v34, v[68:69] offset:32
    ds_write_b64 v34, v[70:71] offset:48
    s_waitcnt lgkmcnt(0)
    ds_read_b64_tr_b16 v[48:49], v35 offset:0
    ds_read_b64_tr_b16 v[50:51], v35 offset:256
    ds_read_b64_tr_b16 v[52:53], v35 offset:2048
    ds_read_b64_tr_b16 v[54:55], v35 offset:2304

    ds_read_b64_tr_b16 v[56:57], v35 offset:1024
    ds_read_b64_tr_b16 v[58:59], v35 offset:1280
    ds_read_b64_tr_b16 v[60:61], v35 offset:3072
    ds_read_b64_tr_b16 v[62:63], v35 offset:3328

    s_waitcnt lgkmcnt(0)
    v_mfma_f32_32x32x16_bf16 v[216:231], v[48:51], v[52:55], 0
    v_mfma_f32_32x32x16_bf16 v[216:231], v[56:59], v[60:63], v[216:231]
    s_lshl_b32 s46, s56, 11
    s_add_u32 s46, s46, s43
    v_add_u32 v6, s46, v3
    v_lshlrev_b32 v6, 5, v6
    v_lshl_add_u32 v6, v4, 4, v6
    s_mov_b32 s47, 0x4400000
    buffer_store_dwordx4 v[160:163], v6, s[32:35], s47 offen
    s_nop 7
    s_nop 7
    v_lshlrev_b32 v5, 4, v2
    v_add_u32 v6, s28, v5

    ds_write_b128 v6, v[216:219] offset:32768
    ds_write_b128 v6, v[220:223] offset:33792
    ds_write_b128 v6, v[224:227] offset:34816
    ds_write_b128 v6, v[228:231] offset:35840
    s_waitcnt lgkmcnt(0)
    s_barrier
    s_cmp_ge_u32 s42, 4
    s_cbranch_scc1 L_k2_nored
    s_lshl_b32 s3, s42, 10
    v_add_u32 v5, s3, v5
    v_add_u32 v7, 0x8000, v5

    ds_read_b128 v[64:67], v7 offset:32768
    ds_read_b128 v[68:71], v7 offset:36864
    ds_read_b128 v[72:75], v7 offset:40960
    ds_read_b128 v[76:79], v7 offset:45056
    ds_read_b128 v[80:83], v7 offset:49152
    ds_read_b128 v[84:87], v7 offset:53248
    ds_read_b128 v[88:91], v7 offset:57344
    ds_read_b128 v[92:95], v7 offset:61440
    s_waitcnt lgkmcnt(0)
    v_add_f32 v64, v64, v68
    v_add_f32 v72, v72, v76
    v_add_f32 v80, v80, v84
    v_add_f32 v88, v88, v92
    v_add_f32 v64, v64, v72
    v_add_f32 v80, v80, v88
    v_add_f32 v64, v64, v80
    v_add_f32 v65, v65, v69
    v_add_f32 v73, v73, v77
    v_add_f32 v81, v81, v85
    v_add_f32 v89, v89, v93
    v_add_f32 v65, v65, v73
    v_add_f32 v81, v81, v89
    v_add_f32 v65, v65, v81
    v_add_f32 v66, v66, v70
    v_add_f32 v74, v74, v78
    v_add_f32 v82, v82, v86
    v_add_f32 v90, v90, v94
    v_add_f32 v66, v66, v74
    v_add_f32 v82, v82, v90
    v_add_f32 v66, v66, v82
    v_add_f32 v67, v67, v71
    v_add_f32 v75, v75, v79
    v_add_f32 v83, v83, v87
    v_add_f32 v91, v91, v95
    v_add_f32 v67, v67, v75
    v_add_f32 v83, v83, v91
    v_add_f32 v67, v67, v83
    s_lshl_b32 s3, s56, 3
    s_add_u32 s3, s3, s41
    s_lshl_b32 s3, s3, 12
    s_add_u32 s3, s3, 0x4c00000
    buffer_store_dwordx4 v[64:67], v5, s[32:35], s3 offen
L_k2_nored:
    s_barrier

L_k1_end:
    s_endpgm
.globl attn_kernel
.p2align 8
.type attn_kernel,@function
attn_kernel:
    s_cmp_ge_u32 s2, 256
    s_cbranch_scc1 L_k2_end

    s_load_dwordx2 s[4:5], s[0:1], 104
    s_load_dwordx2 s[72:73], s[0:1], 0
    s_load_dwordx2 s[68:69], s[0:1], 64
    s_load_dwordx2 s[76:77], s[0:1], 80
    s_load_dwordx2 s[86:87], s[0:1], 40
    s_load_dwordx2 s[88:89], s[0:1], 72
    s_and_b32 s24, s2, 7
    s_lshl_b32 s24, s24, 2
    s_bfe_u32 s3, s2, 0x20003
    s_add_u32 s24, s24, s3
    s_lshr_b32 s25, s2, 5
    v_lshrrev_b32 v1, 6, v0
    s_nop 0
    v_readfirstlane_b32 s26, v1
    v_and_b32 v2, 63, v0
    s_lshr_b32 s27, s26, 2
    s_and_b32 s28, s26, 3
    s_lshl_b32 s34, s26, 12
    s_mov_b32 s35, 0x3e0293ee
    s_lshl_b32 s3, s24, 19
    s_waitcnt lgkmcnt(0)
    s_add_u32 s6, s4, s3
    s_addc_u32 s7, s5, 0

    s_add_u32 s8, s6, 0x1000000
    s_addc_u32 s9, s7, 0
    s_mov_b32 s10, 0x80000
    s_mov_b32 s11, 0x00020000
    s_add_u32 s12, s6, 0x2000000
    s_addc_u32 s13, s7, 0
    s_mov_b32 s14, 0x80000
    s_mov_b32 s15, 0x00020000
    s_add_u32 s16, s6, 0x0
    s_addc_u32 s17, s7, 0
    s_mov_b32 s18, 0x80000
    s_mov_b32 s19, 0x00020000
    s_add_u32 s20, s4, 0x3000000
    s_addc_u32 s21, s5, 0
    s_mov_b32 s22, 0x1200000
    s_mov_b32 s23, 0x00020000
    s_mov_b32 s64, s4
    s_mov_b32 s65, s5
    s_mov_b32 s66, 0x10000000
    s_mov_b32 s67, 0x00020000
    s_movk_i32 s70, 16384
    s_mov_b32 s71, 0x00020000
    s_mov_b32 s74, 0x200000
    s_mov_b32 s75, 0x00020000
    s_movk_i32 s78, 1024
    s_mov_b32 s79, 0x00020000
    s_lshl_b32 s81, s24, 8
    s_add_u32 s81, s81, 0x4f00000
    s_mov_b32 s80, 1
    v_mov_b32 v245, 1
    v_mov_b32 v247, 0
    s_add_u32 s3, s25, 8
    s_lshl_b32 s3, 1, s3
    v_mov_b32 v246, s3
    v_and_b32 v3, 31, v2
    v_lshrrev_b32 v4, 5, v2
    v_lshlrev_b32 v23, 4, v2
    v_add_u32 v23, s34, v23
    s_lshl_b32 s3, s27, 14
    v_lshlrev_b32 v5, 4, v2
    v_add_u32 v8, s3, v5
    v_add_u32 v16, 0x10000, v8
    s_lshl_b32 s3, s28, 5
    s_lshl_b32 s37, s27, 6
    s_sub_u32 s3, s3, s37
    v_lshlrev_b32 v5, 2, v4
    v_sub_u32 v5, v3, v5
    v_add_u32 v22, s3, v5
    s_mov_b32 s36, 0
    s_mov_b32 s59, 0

    v_and_b32 v3, 31, v2
    v_lshrrev_b32 v4, 5, v2
    s_lshl_b32 s83, s2, 3
    s_add_u32 s83, s83, s26
    s_lshl_b32 s3, s83, 10
    v_lshlrev_b32 v6, 4, v2
    buffer_load_dwordx4 v[208:211], v6, s[72:75], s3 offen
    buffer_load_dwordx4 v[212:215], v6, s[76:79], 0 offen
    s_bitcmp0_b32 s80, 0
    s_cbranch_scc1 L_k2_nopf

    s_sub_u32 s82, 15, s25
    s_cmp_eq_u32 s27, 0
    s_cselect_b32 s82, s82, s25
    s_lshl_b32 s82, s82, 7
    s_lshl_b32 s3, s28, 5
    s_add_u32 s82, s82, s3

    s_lshl_b32 s3, s24, 11
    s_add_u32 s3, s3, s82
    v_add_u32 v6, s3, v3
    v_lshlrev_b32 v6, 5, v6
    v_lshl_add_u32 v6, v4, 4, v6
    s_mov_b32 s3, 0x4400000
    buffer_load_dwordx4 v[176:179], v6, s[64:67], s3 offen

    v_and_b32 v5, 15, v3
    v_lshlrev_b32 v5, 1, v5
    v_lshl_add_u32 v5, v4, 7, v5
    s_lshl_b32 s3, s24, 9
    v_add_u32 v5, s3, v5

    buffer_load_ushort v180, v5, s[68:71], 0 offen offset:0
    buffer_load_ushort v181, v5, s[68:71], 0 offen offset:32
    buffer_load_ushort v182, v5, s[68:71], 0 offen offset:64
    buffer_load_ushort v183, v5, s[68:71], 0 offen offset:96
    buffer_load_ushort v184, v5, s[68:71], 0 offen offset:256
    buffer_load_ushort v185, v5, s[68:71], 0 offen offset:288
    buffer_load_ushort v186, v5, s[68:71], 0 offen offset:320
    buffer_load_ushort v187, v5, s[68:71], 0 offen offset:352
    s_lshl_b32 s3, s24, 15
    s_lshl_b32 s37, s27, 14
    s_add_u32 s3, s3, s37
    s_lshl_b32 s37, s28, 10
    s_add_u32 s3, s3, s37
    s_add_u32 s3, s3, 0x4c00000
    v_lshlrev_b32 v5, 4, v2
    v_cmp_gt_u32 vcc, 17, v3
    s_nop 1
    s_mov_b64 exec, vcc

    buffer_load_dwordx4 v[160:163], v5, s[64:67], s3 offen
    s_add_u32 s3, s3, 4096
    buffer_load_dwordx4 v[164:167], v5, s[64:67], s3 offen
    s_add_u32 s3, s3, 4096
    buffer_load_dwordx4 v[168:171], v5, s[64:67], s3 offen
    s_add_u32 s3, s3, 4096
    buffer_load_dwordx4 v[172:175], v5, s[64:67], s3 offen
    s_add_u32 s3, s3, 4096
    s_mov_b64 exec, -1
L_k2_nopf:
    s_lshl_b32 s3, s24, 3
    s_add_u32 s3, s3, s25
    s_lshl_b32 s3, s3, 16
    s_lshl_b32 s37, s26, 12
    s_add_u32 s3, s3, s37
    s_add_u32 s3, s3, 0x0
    s_lshl_b32 s37, s26, 13
    s_add_u32 s37, s37, 98304

    s_add_u32 m0, s37, 0
    s_nop 0
    buffer_load_dwordx4 v23, s[64:67], s3 offen offset:0 lds
    buffer_load_dwordx4 v23, s[64:67], s3 offen offset:1024 lds
    buffer_load_dwordx4 v23, s[64:67], s3 offen offset:2048 lds
    buffer_load_dwordx4 v23, s[64:67], s3 offen offset:3072 lds
    s_add_u32 s3, s3, 4096
    s_add_u32 m0, s37, 4096
    s_nop 0
    buffer_load_dwordx4 v23, s[64:67], s3 offen offset:0 lds
    buffer_load_dwordx4 v23, s[64:67], s3 offen offset:1024 lds
    buffer_load_dwordx4 v23, s[64:67], s3 offen offset:2048 lds
    buffer_load_dwordx4 v23, s[64:67], s3 offen offset:3072 lds
    s_add_u32 s3, s3, 4096
    s_add_u32 m0, s34, 0
    s_nop 0
    buffer_load_dwordx4 v23, s[8:11], 0 offen offset:0 lds
    buffer_load_dwordx4 v23, s[8:11], 0 offen offset:1024 lds
    buffer_load_dwordx4 v23, s[8:11], 0 offen offset:2048 lds
    buffer_load_dwordx4 v23, s[8:11], 0 offen offset:3072 lds
    s_waitcnt vmcnt(12)
    s_mov_b32 s40, 0x3fb8aa3b
    s_bitcmp0_b32 s80, 0
    s_cbranch_scc1 L_k2_gate

    v_add_f32 v160, v160, v164
    v_add_f32 v168, v168, v172
    v_add_f32 v160, v160, v168
    v_add_f32 v161, v161, v165
    v_add_f32 v169, v169, v173
    v_add_f32 v161, v161, v169
    v_add_f32 v162, v162, v166
    v_add_f32 v170, v170, v174
    v_add_f32 v162, v162, v170
    v_add_f32 v163, v163, v167
    v_add_f32 v171, v171, v175
    v_add_f32 v163, v163, v171
    v_lshlrev_b32 v5, 4, v2
    s_lshl_b32 s3, s26, 10
    v_add_u32 v6, s3, v5
    v_add_u32 v6, 0x10000, v6
    ds_write_b128 v6, v[160:163]
    v_cmp_lt_u32 vcc, 15, v3
    v_mov_b32 v6, 0
    v_mov_b32 v7, 0x80008000
    s_nop 0
    v_cndmask_b32 v6, v6, v7, vcc

    v_lshl_or_b32 v36, v181, 16, v180
    v_xor_b32 v36, v36, v6
    v_lshl_or_b32 v37, v183, 16, v182
    v_xor_b32 v37, v37, v6
    v_lshl_or_b32 v38, v185, 16, v184
    v_xor_b32 v38, v38, v6
    v_lshl_or_b32 v39, v187, 16, v186
    v_xor_b32 v39, v39, v6
    v_add_u32 v7, 0x10000, v5
    s_waitcnt lgkmcnt(0)
    s_barrier
    ds_read_b128 v[64:67], v7 offset:0
    ds_read_b128 v[68:71], v7 offset:1024
    ds_read_b128 v[72:75], v7 offset:2048
    ds_read_b128 v[76:79], v7 offset:3072
    ds_read_b128 v[80:83], v7 offset:4096
    ds_read_b128 v[84:87], v7 offset:5120
    ds_read_b128 v[88:91], v7 offset:6144
    ds_read_b128 v[92:95], v7 offset:7168
L_k2_obloop:
    v_mfma_f32_32x32x16_bf16 v[128:143], v[36:39], v[176:179], 0
    s_lshr_b32 s3, s82, 5
    s_mul_i32 s3, s3, 294912
    s_lshl_b32 s37, s24, 10
    s_add_u32 s3, s3, s37
    s_add_u32 s84, s3, 262144
    s_waitcnt lgkmcnt(0)

    v_add_f32 v96, v64, v80
    v_add_f32 v97, v65, v81
    v_add_f32 v98, v66, v82
    v_add_f32 v99, v67, v83
    v_add_f32 v100, v68, v84
    v_add_f32 v101, v69, v85
    v_add_f32 v102, v70, v86
    v_add_f32 v103, v71, v87
    v_add_f32 v104, v72, v88
    v_add_f32 v105, v73, v89
    v_add_f32 v106, v74, v90
    v_add_f32 v107, v75, v91
    v_add_f32 v108, v76, v92
    v_add_f32 v109, v77, v93
    v_add_f32 v110, v78, v94
    v_add_f32 v111, v79, v95
    v_cvt_pk_bf16_f32 v56, v96, v97
    v_cvt_pk_bf16_f32 v57, v98, v99
    v_cvt_pk_bf16_f32 v58, v100, v101
    v_cvt_pk_bf16_f32 v59, v102, v103
    v_cvt_pk_bf16_f32 v60, v104, v105
    v_cvt_pk_bf16_f32 v61, v106, v107
    v_cvt_pk_bf16_f32 v62, v108, v109
    v_cvt_pk_bf16_f32 v63, v110, v111
    v_cvt_pk_bf16_f32 v40, v128, v129
    v_lshlrev_b32 v128, 16, v40
    v_and_b32 v129, 0xffff0000, v40
    v_cvt_pk_bf16_f32 v40, v130, v131
    v_lshlrev_b32 v130, 16, v40
    v_and_b32 v131, 0xffff0000, v40
    v_cvt_pk_bf16_f32 v40, v132, v133
    v_lshlrev_b32 v132, 16, v40
    v_and_b32 v133, 0xffff0000, v40
    v_cvt_pk_bf16_f32 v40, v134, v135
    v_lshlrev_b32 v134, 16, v40
    v_and_b32 v135, 0xffff0000, v40
    v_cvt_pk_bf16_f32 v40, v136, v137
    v_lshlrev_b32 v136, 16, v40
    v_and_b32 v137, 0xffff0000, v40
    v_cvt_pk_bf16_f32 v40, v138, v139
    v_lshlrev_b32 v138, 16, v40
    v_and_b32 v139, 0xffff0000, v40
    v_cvt_pk_bf16_f32 v40, v140, v141
    v_lshlrev_b32 v140, 16, v40
    v_and_b32 v141, 0xffff0000, v40
    v_cvt_pk_bf16_f32 v40, v142, v143
    v_lshlrev_b32 v142, 16, v40
    v_and_b32 v143, 0xffff0000, v40
    v_max3_f32 v40, v128, v129, v130
    v_max3_f32 v40, v40, v131, v132
    v_max3_f32 v40, v40, v133, v134
    v_max_f32 v40, v40, v135
    v_mov_b32 v41, v40
    s_nop 1
    v_permlane32_swap_b32 v40, v41
    s_nop 1
    v_max_f32 v40, v40, v41
    v_mul_f32 v40, s40, v40

    v_fma_f32 v128, v128, s40, -v40
    v_fma_f32 v129, v129, s40, -v40
    v_fma_f32 v130, v130, s40, -v40
    v_fma_f32 v131, v131, s40, -v40
    v_fma_f32 v132, v132, s40, -v40
    v_fma_f32 v133, v133, s40, -v40
    v_fma_f32 v134, v134, s40, -v40
    v_fma_f32 v135, v135, s40, -v40
    v_exp_f32 v128, v128
    v_exp_f32 v129, v129
    v_exp_f32 v130, v130
    v_exp_f32 v131, v131
    v_exp_f32 v132, v132
    v_exp_f32 v133, v133
    v_exp_f32 v134, v134
    v_exp_f32 v135, v135
    s_nop 0
    v_add_f32 v40, v128, v129
    v_add_f32 v40, v40, v130
    v_add_f32 v40, v40, v131
    v_add_f32 v40, v40, v132
    v_add_f32 v40, v40, v133
    v_add_f32 v40, v40, v134
    v_add_f32 v40, v40, v135
    v_mov_b32 v41, v40
    s_nop 1
    v_permlane32_swap_b32 v40, v41
    s_nop 1
    v_add_f32 v40, v40, v41
    v_rcp_f32 v40, v40
    s_nop 0

    v_mul_f32 v128, v128, v40
    v_mul_f32 v129, v129, v40
    v_mul_f32 v130, v130, v40
    v_mul_f32 v131, v131, v40
    v_mul_f32 v132, v132, v40
    v_mul_f32 v133, v133, v40
    v_mul_f32 v134, v134, v40
    v_mul_f32 v135, v135, v40
    v_max3_f32 v40, v136, v137, v138
    v_max3_f32 v40, v40, v139, v140
    v_max3_f32 v40, v40, v141, v142
    v_max_f32 v40, v40, v143
    v_mov_b32 v41, v40
    s_nop 1
    v_permlane32_swap_b32 v40, v41
    s_nop 1
    v_max_f32 v40, v40, v41
    v_mul_f32 v40, s40, v40

    v_fma_f32 v136, v136, s40, -v40
    v_fma_f32 v137, v137, s40, -v40
    v_fma_f32 v138, v138, s40, -v40
    v_fma_f32 v139, v139, s40, -v40
    v_fma_f32 v140, v140, s40, -v40
    v_fma_f32 v141, v141, s40, -v40
    v_fma_f32 v142, v142, s40, -v40
    v_fma_f32 v143, v143, s40, -v40
    v_exp_f32 v136, v136
    v_exp_f32 v137, v137
    v_exp_f32 v138, v138
    v_exp_f32 v139, v139
    v_exp_f32 v140, v140
    v_exp_f32 v141, v141
    v_exp_f32 v142, v142
    v_exp_f32 v143, v143
    s_nop 0
    v_add_f32 v40, v136, v137
    v_add_f32 v40, v40, v138
    v_add_f32 v40, v40, v139
    v_add_f32 v40, v40, v140
    v_add_f32 v40, v40, v141
    v_add_f32 v40, v40, v142
    v_add_f32 v40, v40, v143
    v_mov_b32 v41, v40
    s_nop 1
    v_permlane32_swap_b32 v40, v41
    s_nop 1
    v_add_f32 v40, v40, v41
    v_rcp_f32 v40, v40
    s_nop 0

    v_mul_f32 v136, v136, v40
    v_mul_f32 v137, v137, v40
    v_mul_f32 v138, v138, v40
    v_mul_f32 v139, v139, v40
    v_mul_f32 v140, v140, v40
    v_mul_f32 v141, v141, v40
    v_mul_f32 v142, v142, v40
    v_mul_f32 v143, v143, v40
    v_cvt_pk_bf16_f32 v48, v128, v129
    v_cvt_pk_bf16_f32 v49, v130, v131
    v_cvt_pk_bf16_f32 v50, v132, v133
    v_cvt_pk_bf16_f32 v51, v134, v135
    v_cvt_pk_bf16_f32 v52, v136, v137
    v_cvt_pk_bf16_f32 v53, v138, v139
    v_cvt_pk_bf16_f32 v54, v140, v141
    v_cvt_pk_bf16_f32 v55, v142, v143
    s_nop 1
    v_mfma_f32_32x32x16_bf16 v[128:143], v[56:59], v[48:51], 0
    v_mfma_f32_32x32x16_bf16 v[128:143], v[60:63], v[52:55], v[128:143]
    s_nop 15
    s_nop 3
    v_mov_b32 v40, v136
    v_mov_b32 v41, v136
    s_nop 1
    v_permlane32_swap_b32 v40, v41
    s_nop 1
    v_cvt_pk_bf16_f32 v40, v40, v40
    v_and_b32 v40, 0xffff0000, v40
    v_add_f32 v40, 0x358637bd, v40
    v_cvt_pk_bf16_f32 v40, v40, v40
    v_and_b32 v40, 0xffff0000, v40
    v_rcp_f32 v40, v40

    v_cvt_pk_bf16_f32 v41, v128, v129
    v_lshlrev_b32 v128, 16, v41
    v_and_b32 v129, 0xffff0000, v41
    v_cvt_pk_bf16_f32 v41, v130, v131
    v_lshlrev_b32 v130, 16, v41
    v_and_b32 v131, 0xffff0000, v41
    v_cvt_pk_bf16_f32 v41, v132, v133
    v_lshlrev_b32 v132, 16, v41
    v_and_b32 v133, 0xffff0000, v41
    v_cvt_pk_bf16_f32 v41, v134, v135
    v_lshlrev_b32 v134, 16, v41
    v_and_b32 v135, 0xffff0000, v41
    v_mul_f32 v128, v128, v40
    v_mul_f32 v129, v129, v40
    v_mul_f32 v130, v130, v40
    v_mul_f32 v131, v131, v40
    v_mul_f32 v132, v132, v40
    v_mul_f32 v133, v133, v40
    v_mul_f32 v134, v134, v40
    v_mul_f32 v135, v135, v40
    v_cvt_pk_bf16_f32 v44, v128, v129
    v_cvt_pk_bf16_f32 v45, v130, v131
    v_cvt_pk_bf16_f32 v46, v132, v133
    v_cvt_pk_bf16_f32 v47, v134, v135
    buffer_store_dwordx4 v[44:47], v5, s[20:23], s84 offen
    s_lshr_b32 s3, s80, 8
    s_cmp_eq_u32 s3, 0
    s_cbranch_scc1 L_k2_gate
    s_ff1_i32_b32 s85, s3
    s_add_u32 s3, s85, 8
    s_bitset0_b32 s80, s3

    s_sub_u32 s82, 15, s85
    s_cmp_eq_u32 s27, 0
    s_cselect_b32 s82, s82, s85
    s_lshl_b32 s82, s82, 7
    s_lshl_b32 s3, s28, 5
    s_add_u32 s82, s82, s3

    s_lshl_b32 s3, s24, 11
    s_add_u32 s3, s3, s82
    v_add_u32 v6, s3, v3
    v_lshlrev_b32 v6, 5, v6
    v_lshl_add_u32 v6, v4, 4, v6
    s_mov_b32 s3, 0x4400000
    buffer_load_dwordx4 v[176:179], v6, s[64:67], s3 offen

    s_waitcnt vmcnt(0)
    s_branch L_k2_obloop
L_k2_gate:
    v_mov_b32 v24, 0
    v_mov_b32 v25, 0
    v_lshlrev_b32 v26, 16, v208
    v_lshlrev_b32 v27, 16, v212
    v_fmac_f32 v24, v26, v27
    v_and_b32 v26, 0xffff0000, v208
    v_and_b32 v27, 0xffff0000, v212
    v_fmac_f32 v25, v26, v27

    v_lshlrev_b32 v26, 16, v209
    v_lshlrev_b32 v27, 16, v213
    v_fmac_f32 v24, v26, v27
    v_and_b32 v26, 0xffff0000, v209
    v_and_b32 v27, 0xffff0000, v213
    v_fmac_f32 v25, v26, v27

    v_lshlrev_b32 v26, 16, v210
    v_lshlrev_b32 v27, 16, v214
    v_fmac_f32 v24, v26, v27
    v_and_b32 v26, 0xffff0000, v210
    v_and_b32 v27, 0xffff0000, v214
    v_fmac_f32 v25, v26, v27

    v_lshlrev_b32 v26, 16, v211
    v_lshlrev_b32 v27, 16, v215
    v_fmac_f32 v24, v26, v27
    v_and_b32 v26, 0xffff0000, v211
    v_and_b32 v27, 0xffff0000, v215
    v_fmac_f32 v25, v26, v27

    v_add_f32 v24, v24, v25
    ds_swizzle_b32 v25, v24 offset:0x41f
    s_waitcnt lgkmcnt(0)
    v_add_f32 v24, v24, v25
    ds_swizzle_b32 v25, v24 offset:0x81f
    s_waitcnt lgkmcnt(0)
    v_add_f32 v24, v24, v25
    ds_swizzle_b32 v25, v24 offset:0x101f
    s_waitcnt lgkmcnt(0)
    v_add_f32 v24, v24, v25
    ds_swizzle_b32 v25, v24 offset:0x201f
    s_waitcnt lgkmcnt(0)
    v_add_f32 v24, v24, v25
    ds_swizzle_b32 v25, v24 offset:0x401f
    s_waitcnt lgkmcnt(0)
    v_add_f32 v24, v24, v25
    v_mov_b32 v25, v24
    s_nop 1
    v_permlane32_swap_b32 v24, v25
    s_nop 1
    v_add_f32 v24, v24, v25
    v_cvt_pk_bf16_f32 v24, v24, v24
    v_and_b32 v24, 0xffff0000, v24
    v_mul_f32 v24, s40, v24
    v_sub_f32 v24, 0, v24
    v_exp_f32 v24, v24
    s_nop 0
    v_add_f32 v24, 1.0, v24
    v_rcp_f32 v24, v24
    s_nop 0
    v_cvt_pk_bf16_f32 v24, v24, v24
    v_and_b32 v24, 0xffff0000, v24
    s_lshl_b32 s3, s83, 2
    s_add_u32 s3, s3, 0x4e00000
    s_mov_b64 exec, 1
    buffer_store_dword v24, v247, s[64:67], s3 offen
    s_mov_b64 exec, -1
L_k2_obskip:

    s_waitcnt vmcnt(6)
    s_barrier
L_k2_pass:
    s_sub_u32 s29, 15, s25
    s_cmp_eq_u32 s36, 0
    s_cselect_b32 s29, s29, s25
    s_add_u32 s30, s29, 1
    s_lshl_b32 s3, s36, 15
    s_lshl_b32 s37, s28, 13
    s_add_u32 s3, s3, s37
    s_add_u32 s3, s3, 98304
    v_lshlrev_b32 v5, 4, v2
    v_add_u32 v5, s3, v5

    ds_read_b128 v[208:211], v5 offset:0
    ds_read_b128 v[212:215], v5 offset:1024
    ds_read_b128 v[216:219], v5 offset:2048
    ds_read_b128 v[220:223], v5 offset:3072
    ds_read_b128 v[224:227], v5 offset:4096
    ds_read_b128 v[228:231], v5 offset:5120
    ds_read_b128 v[232:235], v5 offset:6144
    ds_read_b128 v[236:239], v5 offset:7168
    s_add_u32 m0, s34, 65536
    s_nop 0
    buffer_load_dwordx4 v23, s[12:15], 0 offen offset:0 lds
    buffer_load_dwordx4 v23, s[12:15], 0 offen offset:1024 lds
    buffer_load_dwordx4 v23, s[12:15], 0 offen offset:2048 lds
    buffer_load_dwordx4 v23, s[12:15], 0 offen offset:3072 lds
    v_mov_b32 v20, 0xe0ad78ec
    v_mov_b32 v21, 0
    v_mov_b32 v64, 0
    v_mov_b32 v65, 0
    v_mov_b32 v66, 0
    v_mov_b32 v67, 0
    v_mov_b32 v68, 0
    v_mov_b32 v69, 0
    v_mov_b32 v70, 0
    v_mov_b32 v71, 0
    v_mov_b32 v72, 0
    v_mov_b32 v73, 0
    v_mov_b32 v74, 0
    v_mov_b32 v75, 0
    v_mov_b32 v76, 0
    v_mov_b32 v77, 0
    v_mov_b32 v78, 0
    v_mov_b32 v79, 0
    v_mov_b32 v80, 0
    v_mov_b32 v81, 0
    v_mov_b32 v82, 0
    v_mov_b32 v83, 0
    v_mov_b32 v84, 0
    v_mov_b32 v85, 0
    v_mov_b32 v86, 0
    v_mov_b32 v87, 0
    v_mov_b32 v88, 0
    v_mov_b32 v89, 0
    v_mov_b32 v90, 0
    v_mov_b32 v91, 0
    v_mov_b32 v92, 0
    v_mov_b32 v93, 0
    v_mov_b32 v94, 0
    v_mov_b32 v95, 0
    v_mov_b32 v96, 0
    v_mov_b32 v97, 0
    v_mov_b32 v98, 0
    v_mov_b32 v99, 0
    v_mov_b32 v100, 0
    v_mov_b32 v101, 0
    v_mov_b32 v102, 0
    v_mov_b32 v103, 0
    v_mov_b32 v104, 0
    v_mov_b32 v105, 0
    v_mov_b32 v106, 0
    v_mov_b32 v107, 0
    v_mov_b32 v108, 0
    v_mov_b32 v109, 0
    v_mov_b32 v110, 0
    v_mov_b32 v111, 0
    v_mov_b32 v112, 0
    v_mov_b32 v113, 0
    v_mov_b32 v114, 0
    v_mov_b32 v115, 0
    v_mov_b32 v116, 0
    v_mov_b32 v117, 0
    v_mov_b32 v118, 0
    v_mov_b32 v119, 0
    v_mov_b32 v120, 0
    v_mov_b32 v121, 0
    v_mov_b32 v122, 0
    v_mov_b32 v123, 0
    v_mov_b32 v124, 0
    v_mov_b32 v125, 0
    v_mov_b32 v126, 0
    v_mov_b32 v127, 0
    s_cmp_lt_u32 s30, 2
    s_cbranch_scc1 L_nok1_328
    s_mov_b32 s32, 32768
    s_add_u32 m0, s34, 32768
    s_nop 0
    buffer_load_dwordx4 v23, s[8:11], s32 offen offset:0 lds
    buffer_load_dwordx4 v23, s[8:11], s32 offen offset:1024 lds
    buffer_load_dwordx4 v23, s[8:11], s32 offen offset:2048 lds
    buffer_load_dwordx4 v23, s[8:11], s32 offen offset:3072 lds
    s_waitcnt vmcnt(8)
    s_branch L_nok1b_329
L_nok1_328:
    s_waitcnt vmcnt(4)
L_nok1b_329:
    s_mov_b32 s31, 0
    s_waitcnt lgkmcnt(0)
    s_barrier
    ds_read_b128 v[36:39], v8 offset:0
    ds_read_b128 v[40:43], v8 offset:8192
    ds_read_b128 v[44:47], v8 offset:1024
    ds_read_b128 v[48:51], v8 offset:9216
    ds_read_b128 v[52:55], v8 offset:2048
    ds_read_b128 v[56:59], v8 offset:10240
    ds_read_b128 v[60:63], v8 offset:3072
    ds_read_b128 v[240:243], v8 offset:11264
    s_waitcnt lgkmcnt(7)
    v_mfma_f32_32x32x16_bf16 v[128:143], v[36:39], v[208:211], 0
    ds_read_b128 v[36:39], v8 offset:4096
    s_waitcnt lgkmcnt(7)
    v_mfma_f32_32x32x16_bf16 v[144:159], v[40:43], v[208:211], 0
    ds_read_b128 v[40:43], v8 offset:12288
    s_waitcnt lgkmcnt(7)
    v_mfma_f32_32x32x16_bf16 v[128:143], v[44:47], v[212:215], v[128:143]
    ds_read_b128 v[44:47], v8 offset:5120
    s_waitcnt lgkmcnt(7)
    v_mfma_f32_32x32x16_bf16 v[144:159], v[48:51], v[212:215], v[144:159]
    ds_read_b128 v[48:51], v8 offset:13312
    s_waitcnt lgkmcnt(7)
    v_mfma_f32_32x32x16_bf16 v[128:143], v[52:55], v[216:219], v[128:143]
    ds_read_b128 v[52:55], v8 offset:6144
    s_waitcnt lgkmcnt(7)
    v_mfma_f32_32x32x16_bf16 v[144:159], v[56:59], v[216:219], v[144:159]
    ds_read_b128 v[56:59], v8 offset:14336
    s_waitcnt lgkmcnt(7)
    v_mfma_f32_32x32x16_bf16 v[128:143], v[60:63], v[220:223], v[128:143]
    ds_read_b128 v[60:63], v8 offset:7168
    s_waitcnt lgkmcnt(7)
    v_mfma_f32_32x32x16_bf16 v[144:159], v[240:243], v[220:223], v[144:159]
    ds_read_b128 v[240:243], v8 offset:15360
    s_waitcnt lgkmcnt(7)
    v_mfma_f32_32x32x16_bf16 v[128:143], v[36:39], v[224:227], v[128:143]
    s_waitcnt lgkmcnt(6)
    v_mfma_f32_32x32x16_bf16 v[144:159], v[40:43], v[224:227], v[144:159]
    s_waitcnt lgkmcnt(5)
    v_mfma_f32_32x32x16_bf16 v[128:143], v[44:47], v[228:231], v[128:143]
    s_waitcnt lgkmcnt(4)
    v_mfma_f32_32x32x16_bf16 v[144:159], v[48:51], v[228:231], v[144:159]
    s_waitcnt lgkmcnt(3)
    v_mfma_f32_32x32x16_bf16 v[128:143], v[52:55], v[232:235], v[128:143]
    s_waitcnt lgkmcnt(2)
    v_mfma_f32_32x32x16_bf16 v[144:159], v[56:59], v[232:235], v[144:159]
    s_waitcnt lgkmcnt(1)
    v_mfma_f32_32x32x16_bf16 v[128:143], v[60:63], v[236:239], v[128:143]
    s_waitcnt lgkmcnt(0)
    v_mfma_f32_32x32x16_bf16 v[144:159], v[240:243], v[236:239], v[144:159]
    s_cmp_lg_u32 s27, 0
    s_cbranch_scc1 L_k2_g1loop
L_k2_loop:
    s_waitcnt vmcnt(0)
    s_barrier
    s_add_u32 s3, s31, 1
    s_lshl_b32 s33, s3, 15
    s_sub_u32 s38, s30, s3
    s_add_u32 s3, s31, 2
    s_lshl_b32 s32, s3, 15
    s_lshl_b32 s39, s31, 15
    s_cmp_eq_u32 s38, 0

    s_cbranch_scc1 L_k2_tail0
    ds_read_b128 v[36:39], v8 offset:32768
    ds_read_b128 v[40:43], v8 offset:40960
    ds_read_b128 v[44:47], v8 offset:33792
    ds_read_b128 v[48:51], v8 offset:41984
    ds_read_b128 v[52:55], v8 offset:34816
    ds_read_b128 v[56:59], v8 offset:43008
    ds_read_b128 v[60:63], v8 offset:35840
    ds_read_b128 v[240:243], v8 offset:44032
    v_max3_f32 v24, v128, v129, v130
    v_max3_f32 v25, v144, v145, v146
    v_max3_f32 v24, v24, v131, v132
    v_max3_f32 v25, v25, v147, v148
    v_max3_f32 v24, v24, v133, v134
    v_max3_f32 v25, v25, v149, v150
    v_max3_f32 v24, v24, v135, v136
    v_max3_f32 v25, v25, v151, v152
    s_waitcnt lgkmcnt(7)
    v_mfma_f32_32x32x16_bf16 v[160:175], v[36:39], v[208:211], 0
    ds_read_b128 v[36:39], v8 offset:36864
    v_max3_f32 v24, v24, v137, v138
    v_max3_f32 v25, v25, v153, v154
    v_max3_f32 v24, v24, v139, v140
    v_max3_f32 v25, v25, v155, v156
    s_waitcnt lgkmcnt(7)
    v_mfma_f32_32x32x16_bf16 v[176:191], v[40:43], v[208:211], 0
    ds_read_b128 v[40:43], v8 offset:45056
    v_max3_f32 v24, v24, v141, v142
    v_max3_f32 v25, v25, v157, v158
    v_max3_f32 v24, v24, v143, v25
    v_max_f32 v24, v24, v159
    v_mov_b32 v25, v24
    s_nop 1
    v_permlane32_swap_b32 v24, v25
    s_nop 1
    v_max_f32 v24, v24, v25
    v_mul_f32 v24, s35, v24
    v_max_f32 v25, v20, v24
    v_sub_f32 v26, v25, v20
    v_cmp_lt_f32 vcc, 0x41000000, v26
    s_cbranch_vccz L_noresc_330
    v_sub_f32 v26, 0, v26
    v_exp_f32 v26, v26
    v_mov_b32 v20, v25
    s_nop 0
    v_mov_b32 v27, v26
    v_mul_f32 v21, v21, v26
    v_pk_mul_f32 v[64:65], v[64:65], v[26:27]
    v_pk_mul_f32 v[66:67], v[66:67], v[26:27]
    v_pk_mul_f32 v[68:69], v[68:69], v[26:27]
    v_pk_mul_f32 v[70:71], v[70:71], v[26:27]
    v_pk_mul_f32 v[72:73], v[72:73], v[26:27]
    v_pk_mul_f32 v[74:75], v[74:75], v[26:27]
    v_pk_mul_f32 v[76:77], v[76:77], v[26:27]
    v_pk_mul_f32 v[78:79], v[78:79], v[26:27]
    v_pk_mul_f32 v[80:81], v[80:81], v[26:27]
    v_pk_mul_f32 v[82:83], v[82:83], v[26:27]
    v_pk_mul_f32 v[84:85], v[84:85], v[26:27]
    v_pk_mul_f32 v[86:87], v[86:87], v[26:27]
    v_pk_mul_f32 v[88:89], v[88:89], v[26:27]
    v_pk_mul_f32 v[90:91], v[90:91], v[26:27]
    v_pk_mul_f32 v[92:93], v[92:93], v[26:27]
    v_pk_mul_f32 v[94:95], v[94:95], v[26:27]
    v_pk_mul_f32 v[96:97], v[96:97], v[26:27]
    v_pk_mul_f32 v[98:99], v[98:99], v[26:27]
    v_pk_mul_f32 v[100:101], v[100:101], v[26:27]
    v_pk_mul_f32 v[102:103], v[102:103], v[26:27]
    v_pk_mul_f32 v[104:105], v[104:105], v[26:27]
    v_pk_mul_f32 v[106:107], v[106:107], v[26:27]
    v_pk_mul_f32 v[108:109], v[108:109], v[26:27]
    v_pk_mul_f32 v[110:111], v[110:111], v[26:27]
    v_pk_mul_f32 v[112:113], v[112:113], v[26:27]
    v_pk_mul_f32 v[114:115], v[114:115], v[26:27]
    v_pk_mul_f32 v[116:117], v[116:117], v[26:27]
    v_pk_mul_f32 v[118:119], v[118:119], v[26:27]
    v_pk_mul_f32 v[120:121], v[120:121], v[26:27]
    v_pk_mul_f32 v[122:123], v[122:123], v[26:27]
    v_pk_mul_f32 v[124:125], v[124:125], v[26:27]
    v_pk_mul_f32 v[126:127], v[126:127], v[26:27]
L_noresc_330:
    v_sub_f32 v28, 0, v20
    s_waitcnt lgkmcnt(7)
    v_mfma_f32_32x32x16_bf16 v[160:175], v[44:47], v[212:215], v[160:175]
    ds_read_b128 v[44:47], v8 offset:37888
    v_fma_f32 v128, v128, s35, v28
    v_fma_f32 v129, v129, s35, v28
    v_fma_f32 v130, v130, s35, v28
    v_fma_f32 v131, v131, s35, v28
    v_exp_f32 v128, v128
    v_exp_f32 v129, v129
    v_fma_f32 v132, v132, s35, v28
    v_fma_f32 v133, v133, s35, v28
    v_exp_f32 v130, v130
    s_waitcnt lgkmcnt(7)
    v_mfma_f32_32x32x16_bf16 v[176:191], v[48:51], v[212:215], v[176:191]
    ds_read_b128 v[48:51], v8 offset:46080
    v_exp_f32 v131, v131
    v_add_f32 v21, v21, v128
    v_mov_b32 v29, v129
    v_cvt_pk_bf16_f32 v192, v128, v129
    v_fma_f32 v134, v134, s35, v28
    v_fma_f32 v135, v135, s35, v28
    v_exp_f32 v132, v132
    v_exp_f32 v133, v133
    v_add_f32 v21, v21, v130
    s_waitcnt lgkmcnt(7)
    v_mfma_f32_32x32x16_bf16 v[160:175], v[52:55], v[216:219], v[160:175]
    ds_read_b128 v[52:55], v8 offset:38912
    v_add_f32 v29, v29, v131
    v_cvt_pk_bf16_f32 v193, v130, v131
    v_fma_f32 v136, v136, s35, v28
    v_fma_f32 v137, v137, s35, v28
    v_exp_f32 v134, v134
    v_exp_f32 v135, v135
    v_add_f32 v21, v21, v132
    v_add_f32 v29, v29, v133
    v_cvt_pk_bf16_f32 v194, v132, v133
    s_waitcnt lgkmcnt(7)
    v_mfma_f32_32x32x16_bf16 v[176:191], v[56:59], v[216:219], v[176:191]
    ds_read_b128 v[56:59], v8 offset:47104
    v_fma_f32 v138, v138, s35, v28
    v_fma_f32 v139, v139, s35, v28
    v_exp_f32 v136, v136
    v_exp_f32 v137, v137
    v_add_f32 v21, v21, v134
    v_add_f32 v29, v29, v135
    v_cvt_pk_bf16_f32 v195, v134, v135
    v_fma_f32 v140, v140, s35, v28
    v_fma_f32 v141, v141, s35, v28
    s_waitcnt lgkmcnt(7)
    v_mfma_f32_32x32x16_bf16 v[160:175], v[60:63], v[220:223], v[160:175]
    ds_read_b128 v[60:63], v8 offset:39936
    v_exp_f32 v138, v138
    v_exp_f32 v139, v139
    v_add_f32 v21, v21, v136
    v_add_f32 v29, v29, v137
    v_cvt_pk_bf16_f32 v196, v136, v137
    v_fma_f32 v142, v142, s35, v28
    v_fma_f32 v143, v143, s35, v28
    v_exp_f32 v140, v140
    v_exp_f32 v141, v141
    s_waitcnt lgkmcnt(7)
    v_mfma_f32_32x32x16_bf16 v[176:191], v[240:243], v[220:223], v[176:191]
    ds_read_b128 v[240:243], v8 offset:48128
    v_add_f32 v21, v21, v138
    v_add_f32 v29, v29, v139
    v_cvt_pk_bf16_f32 v197, v138, v139
    v_fma_f32 v144, v144, s35, v28
    v_fma_f32 v145, v145, s35, v28
    v_exp_f32 v142, v142
    v_exp_f32 v143, v143
    v_add_f32 v21, v21, v140
    v_add_f32 v29, v29, v141
    s_waitcnt lgkmcnt(7)
    v_mfma_f32_32x32x16_bf16 v[160:175], v[36:39], v[224:227], v[160:175]
    ds_read_b128 v[36:39], v16 offset:0
    v_cvt_pk_bf16_f32 v198, v140, v141
    v_fma_f32 v146, v146, s35, v28
    v_fma_f32 v147, v147, s35, v28
    v_exp_f32 v144, v144
    v_exp_f32 v145, v145
    v_add_f32 v21, v21, v142
    v_add_f32 v29, v29, v143
    v_cvt_pk_bf16_f32 v199, v142, v143
    v_fma_f32 v148, v148, s35, v28
    s_waitcnt lgkmcnt(7)
    v_mfma_f32_32x32x16_bf16 v[176:191], v[40:43], v[224:227], v[176:191]
    ds_read_b128 v[40:43], v16 offset:1024
    v_fma_f32 v149, v149, s35, v28
    v_exp_f32 v146, v146
    v_exp_f32 v147, v147
    v_add_f32 v21, v21, v144
    v_add_f32 v29, v29, v145
    v_cvt_pk_bf16_f32 v200, v144, v145
    v_fma_f32 v150, v150, s35, v28
    v_fma_f32 v151, v151, s35, v28
    v_exp_f32 v148, v148
    s_waitcnt lgkmcnt(7)
    v_mfma_f32_32x32x16_bf16 v[160:175], v[44:47], v[228:231], v[160:175]
    ds_read_b128 v[44:47], v16 offset:2048
    v_exp_f32 v149, v149
    v_add_f32 v21, v21, v146
    v_add_f32 v29, v29, v147
    v_cvt_pk_bf16_f32 v201, v146, v147
    v_fma_f32 v152, v152, s35, v28
    v_fma_f32 v153, v153, s35, v28
    v_exp_f32 v150, v150
    v_exp_f32 v151, v151
    v_add_f32 v21, v21, v148
    s_waitcnt lgkmcnt(7)
    v_mfma_f32_32x32x16_bf16 v[176:191], v[48:51], v[228:231], v[176:191]
    ds_read_b128 v[48:51], v16 offset:3072
    v_add_f32 v29, v29, v149
    v_cvt_pk_bf16_f32 v202, v148, v149
    v_fma_f32 v154, v154, s35, v28
    v_fma_f32 v155, v155, s35, v28
    v_exp_f32 v152, v152
    v_exp_f32 v153, v153
    v_add_f32 v21, v21, v150
    v_add_f32 v29, v29, v151
    v_cvt_pk_bf16_f32 v203, v150, v151
    s_waitcnt lgkmcnt(7)
    v_mfma_f32_32x32x16_bf16 v[160:175], v[52:55], v[232:235], v[160:175]
    ds_read_b128 v[52:55], v16 offset:4096
    v_fma_f32 v156, v156, s35, v28
    v_fma_f32 v157, v157, s35, v28
    v_exp_f32 v154, v154
    v_exp_f32 v155, v155
    v_add_f32 v21, v21, v152
    v_add_f32 v29, v29, v153
    v_cvt_pk_bf16_f32 v204, v152, v153
    v_fma_f32 v158, v158, s35, v28
    v_fma_f32 v159, v159, s35, v28
    s_waitcnt lgkmcnt(7)
    v_mfma_f32_32x32x16_bf16 v[176:191], v[56:59], v[232:235], v[176:191]
    ds_read_b128 v[56:59], v16 offset:5120
    v_exp_f32 v156, v156
    v_exp_f32 v157, v157
    v_add_f32 v21, v21, v154
    v_add_f32 v29, v29, v155
    v_cvt_pk_bf16_f32 v205, v154, v155
    v_exp_f32 v158, v158
    v_exp_f32 v159, v159
    v_add_f32 v21, v21, v156
    v_add_f32 v29, v29, v157
    s_waitcnt lgkmcnt(7)
    v_mfma_f32_32x32x16_bf16 v[160:175], v[60:63], v[236:239], v[160:175]
    ds_read_b128 v[60:63], v16 offset:6144
    v_cvt_pk_bf16_f32 v206, v156, v157
    s_nop 0
    v_add_f32 v21, v21, v158
    v_add_f32 v29, v29, v159
    v_cvt_pk_bf16_f32 v207, v158, v159
    v_add_f32 v21, v21, v29
    s_waitcnt lgkmcnt(7)
    v_mfma_f32_32x32x16_bf16 v[176:191], v[240:243], v[236:239], v[176:191]
    ds_read_b128 v[240:243], v16 offset:7168
    s_waitcnt lgkmcnt(7)
    s_nop 1
    v_mfma_f32_32x32x16_bf16 v[64:79], v[36:39], v[192:195], v[64:79]
    ds_read_b128 v[36:39], v16 offset:8192
    s_waitcnt lgkmcnt(7)
    v_mfma_f32_32x32x16_bf16 v[80:95], v[40:43], v[192:195], v[80:95]
    ds_read_b128 v[40:43], v16 offset:9216
    s_add_u32 m0, s34, 98304
    s_nop 0
    buffer_load_dwordx4 v23, s[12:15], s33 offen offset:0 lds
    s_waitcnt lgkmcnt(7)
    v_mfma_f32_32x32x16_bf16 v[96:111], v[44:47], v[192:195], v[96:111]
    ds_read_b128 v[44:47], v16 offset:10240
    s_waitcnt lgkmcnt(7)
    v_mfma_f32_32x32x16_bf16 v[112:127], v[48:51], v[192:195], v[112:127]
    ds_read_b128 v[48:51], v16 offset:11264
    s_add_u32 m0, s34, 98304
    s_nop 0
    buffer_load_dwordx4 v23, s[12:15], s33 offen offset:1024 lds
    s_waitcnt lgkmcnt(7)
    v_mfma_f32_32x32x16_bf16 v[64:79], v[52:55], v[196:199], v[64:79]
    ds_read_b128 v[52:55], v16 offset:12288
    s_waitcnt lgkmcnt(7)
    v_mfma_f32_32x32x16_bf16 v[80:95], v[56:59], v[196:199], v[80:95]
    ds_read_b128 v[56:59], v16 offset:13312
    s_add_u32 m0, s34, 98304
    s_nop 0
    buffer_load_dwordx4 v23, s[12:15], s33 offen offset:2048 lds
    s_waitcnt lgkmcnt(7)
    v_mfma_f32_32x32x16_bf16 v[96:111], v[60:63], v[196:199], v[96:111]
    ds_read_b128 v[60:63], v16 offset:14336
    s_waitcnt lgkmcnt(7)
    v_mfma_f32_32x32x16_bf16 v[112:127], v[240:243], v[196:199], v[112:127]
    ds_read_b128 v[240:243], v16 offset:15360
    s_add_u32 m0, s34, 98304
    s_nop 0
    buffer_load_dwordx4 v23, s[12:15], s33 offen offset:3072 lds
    s_waitcnt lgkmcnt(7)
    v_mfma_f32_32x32x16_bf16 v[64:79], v[36:39], v[200:203], v[64:79]
    s_waitcnt lgkmcnt(6)
    v_mfma_f32_32x32x16_bf16 v[80:95], v[40:43], v[200:203], v[80:95]
    s_cmp_lt_u32 s38, 2
    s_cbranch_scc1 L_nd_331
    s_add_u32 m0, s34, 0
    s_nop 0
    buffer_load_dwordx4 v23, s[8:11], s32 offen offset:0 lds
L_nd_331:
    s_waitcnt lgkmcnt(5)
    v_mfma_f32_32x32x16_bf16 v[96:111], v[44:47], v[200:203], v[96:111]
    s_waitcnt lgkmcnt(4)
    v_mfma_f32_32x32x16_bf16 v[112:127], v[48:51], v[200:203], v[112:127]
    s_cmp_lt_u32 s38, 2
    s_cbranch_scc1 L_nd_332
    s_add_u32 m0, s34, 0
    s_nop 0
    buffer_load_dwordx4 v23, s[8:11], s32 offen offset:1024 lds
L_nd_332:
    s_waitcnt lgkmcnt(3)
    v_mfma_f32_32x32x16_bf16 v[64:79], v[52:55], v[204:207], v[64:79]
    s_waitcnt lgkmcnt(2)
    v_mfma_f32_32x32x16_bf16 v[80:95], v[56:59], v[204:207], v[80:95]
    s_cmp_lt_u32 s38, 2
    s_cbranch_scc1 L_nd_333
    s_add_u32 m0, s34, 0
    s_nop 0
    buffer_load_dwordx4 v23, s[8:11], s32 offen offset:2048 lds
L_nd_333:
    s_waitcnt lgkmcnt(1)
    v_mfma_f32_32x32x16_bf16 v[96:111], v[60:63], v[204:207], v[96:111]
    s_waitcnt lgkmcnt(0)
    v_mfma_f32_32x32x16_bf16 v[112:127], v[240:243], v[204:207], v[112:127]
    s_cmp_lt_u32 s38, 2
    s_cbranch_scc1 L_nd_334
    s_add_u32 m0, s34, 0
    s_nop 0
    buffer_load_dwordx4 v23, s[8:11], s32 offen offset:3072 lds
L_nd_334:
    s_add_u32 s31, s31, 1
    s_waitcnt vmcnt(0)
    s_barrier
    s_add_u32 s3, s31, 1
    s_lshl_b32 s33, s3, 15
    s_sub_u32 s38, s30, s3
    s_add_u32 s3, s31, 2
    s_lshl_b32 s32, s3, 15
    s_lshl_b32 s39, s31, 15
    s_cmp_eq_u32 s38, 0

    s_cbranch_scc1 L_k2_tail1
    ds_read_b128 v[36:39], v8 offset:0
    ds_read_b128 v[40:43], v8 offset:8192
    ds_read_b128 v[44:47], v8 offset:1024
    ds_read_b128 v[48:51], v8 offset:9216
    ds_read_b128 v[52:55], v8 offset:2048
    ds_read_b128 v[56:59], v8 offset:10240
    ds_read_b128 v[60:63], v8 offset:3072
    ds_read_b128 v[240:243], v8 offset:11264
    v_max3_f32 v24, v160, v161, v162
    v_max3_f32 v25, v176, v177, v178
    v_max3_f32 v24, v24, v163, v164
    v_max3_f32 v25, v25, v179, v180
    v_max3_f32 v24, v24, v165, v166
    v_max3_f32 v25, v25, v181, v182
    v_max3_f32 v24, v24, v167, v168
    v_max3_f32 v25, v25, v183, v184
    s_waitcnt lgkmcnt(7)
    v_mfma_f32_32x32x16_bf16 v[128:143], v[36:39], v[208:211], 0
    ds_read_b128 v[36:39], v8 offset:4096
    v_max3_f32 v24, v24, v169, v170
    v_max3_f32 v25, v25, v185, v186
    v_max3_f32 v24, v24, v171, v172
    v_max3_f32 v25, v25, v187, v188
    s_waitcnt lgkmcnt(7)
    v_mfma_f32_32x32x16_bf16 v[144:159], v[40:43], v[208:211], 0
    ds_read_b128 v[40:43], v8 offset:12288
    v_max3_f32 v24, v24, v173, v174
    v_max3_f32 v25, v25, v189, v190
    v_max3_f32 v24, v24, v175, v25
    v_max_f32 v24, v24, v191
    v_mov_b32 v25, v24
    s_nop 1
    v_permlane32_swap_b32 v24, v25
    s_nop 1
    v_max_f32 v24, v24, v25
    v_mul_f32 v24, s35, v24
    v_max_f32 v25, v20, v24
    v_sub_f32 v26, v25, v20
    v_cmp_lt_f32 vcc, 0x41000000, v26
    s_cbranch_vccz L_noresc_335
    v_sub_f32 v26, 0, v26
    v_exp_f32 v26, v26
    v_mov_b32 v20, v25
    s_nop 0
    v_mov_b32 v27, v26
    v_mul_f32 v21, v21, v26
    v_pk_mul_f32 v[64:65], v[64:65], v[26:27]
    v_pk_mul_f32 v[66:67], v[66:67], v[26:27]
    v_pk_mul_f32 v[68:69], v[68:69], v[26:27]
    v_pk_mul_f32 v[70:71], v[70:71], v[26:27]
    v_pk_mul_f32 v[72:73], v[72:73], v[26:27]
    v_pk_mul_f32 v[74:75], v[74:75], v[26:27]
    v_pk_mul_f32 v[76:77], v[76:77], v[26:27]
    v_pk_mul_f32 v[78:79], v[78:79], v[26:27]
    v_pk_mul_f32 v[80:81], v[80:81], v[26:27]
    v_pk_mul_f32 v[82:83], v[82:83], v[26:27]
    v_pk_mul_f32 v[84:85], v[84:85], v[26:27]
    v_pk_mul_f32 v[86:87], v[86:87], v[26:27]
    v_pk_mul_f32 v[88:89], v[88:89], v[26:27]
    v_pk_mul_f32 v[90:91], v[90:91], v[26:27]
    v_pk_mul_f32 v[92:93], v[92:93], v[26:27]
    v_pk_mul_f32 v[94:95], v[94:95], v[26:27]
    v_pk_mul_f32 v[96:97], v[96:97], v[26:27]
    v_pk_mul_f32 v[98:99], v[98:99], v[26:27]
    v_pk_mul_f32 v[100:101], v[100:101], v[26:27]
    v_pk_mul_f32 v[102:103], v[102:103], v[26:27]
    v_pk_mul_f32 v[104:105], v[104:105], v[26:27]
    v_pk_mul_f32 v[106:107], v[106:107], v[26:27]
    v_pk_mul_f32 v[108:109], v[108:109], v[26:27]
    v_pk_mul_f32 v[110:111], v[110:111], v[26:27]
    v_pk_mul_f32 v[112:113], v[112:113], v[26:27]
    v_pk_mul_f32 v[114:115], v[114:115], v[26:27]
    v_pk_mul_f32 v[116:117], v[116:117], v[26:27]
    v_pk_mul_f32 v[118:119], v[118:119], v[26:27]
    v_pk_mul_f32 v[120:121], v[120:121], v[26:27]
    v_pk_mul_f32 v[122:123], v[122:123], v[26:27]
    v_pk_mul_f32 v[124:125], v[124:125], v[26:27]
    v_pk_mul_f32 v[126:127], v[126:127], v[26:27]
L_noresc_335:
    v_sub_f32 v28, 0, v20
    s_waitcnt lgkmcnt(7)
    v_mfma_f32_32x32x16_bf16 v[128:143], v[44:47], v[212:215], v[128:143]
    ds_read_b128 v[44:47], v8 offset:5120
    v_fma_f32 v160, v160, s35, v28
    v_fma_f32 v161, v161, s35, v28
    v_fma_f32 v162, v162, s35, v28
    v_fma_f32 v163, v163, s35, v28
    v_exp_f32 v160, v160
    v_exp_f32 v161, v161
    v_fma_f32 v164, v164, s35, v28
    v_fma_f32 v165, v165, s35, v28
    v_exp_f32 v162, v162
    s_waitcnt lgkmcnt(7)
    v_mfma_f32_32x32x16_bf16 v[144:159], v[48:51], v[212:215], v[144:159]
    ds_read_b128 v[48:51], v8 offset:13312
    v_exp_f32 v163, v163
    v_add_f32 v21, v21, v160
    v_mov_b32 v29, v161
    v_cvt_pk_bf16_f32 v192, v160, v161
    v_fma_f32 v166, v166, s35, v28
    v_fma_f32 v167, v167, s35, v28
    v_exp_f32 v164, v164
    v_exp_f32 v165, v165
    v_add_f32 v21, v21, v162
    s_waitcnt lgkmcnt(7)
    v_mfma_f32_32x32x16_bf16 v[128:143], v[52:55], v[216:219], v[128:143]
    ds_read_b128 v[52:55], v8 offset:6144
    v_add_f32 v29, v29, v163
    v_cvt_pk_bf16_f32 v193, v162, v163
    v_fma_f32 v168, v168, s35, v28
    v_fma_f32 v169, v169, s35, v28
    v_exp_f32 v166, v166
    v_exp_f32 v167, v167
    v_add_f32 v21, v21, v164
    v_add_f32 v29, v29, v165
    v_cvt_pk_bf16_f32 v194, v164, v165
    s_waitcnt lgkmcnt(7)
    v_mfma_f32_32x32x16_bf16 v[144:159], v[56:59], v[216:219], v[144:159]
    ds_read_b128 v[56:59], v8 offset:14336
    v_fma_f32 v170, v170, s35, v28
    v_fma_f32 v171, v171, s35, v28
    v_exp_f32 v168, v168
    v_exp_f32 v169, v169
    v_add_f32 v21, v21, v166
    v_add_f32 v29, v29, v167
    v_cvt_pk_bf16_f32 v195, v166, v167
    v_fma_f32 v172, v172, s35, v28
    v_fma_f32 v173, v173, s35, v28
    s_waitcnt lgkmcnt(7)
    v_mfma_f32_32x32x16_bf16 v[128:143], v[60:63], v[220:223], v[128:143]
    ds_read_b128 v[60:63], v8 offset:7168
    v_exp_f32 v170, v170
    v_exp_f32 v171, v171
    v_add_f32 v21, v21, v168
    v_add_f32 v29, v29, v169
    v_cvt_pk_bf16_f32 v196, v168, v169
    v_fma_f32 v174, v174, s35, v28
    v_fma_f32 v175, v175, s35, v28
    v_exp_f32 v172, v172
    v_exp_f32 v173, v173
    s_waitcnt lgkmcnt(7)
    v_mfma_f32_32x32x16_bf16 v[144:159], v[240:243], v[220:223], v[144:159]
    ds_read_b128 v[240:243], v8 offset:15360
    v_add_f32 v21, v21, v170
    v_add_f32 v29, v29, v171
    v_cvt_pk_bf16_f32 v197, v170, v171
    v_fma_f32 v176, v176, s35, v28
    v_fma_f32 v177, v177, s35, v28
    v_exp_f32 v174, v174
    v_exp_f32 v175, v175
    v_add_f32 v21, v21, v172
    v_add_f32 v29, v29, v173
    s_waitcnt lgkmcnt(7)
    v_mfma_f32_32x32x16_bf16 v[128:143], v[36:39], v[224:227], v[128:143]
    ds_read_b128 v[36:39], v16 offset:32768
    v_cvt_pk_bf16_f32 v198, v172, v173
    v_fma_f32 v178, v178, s35, v28
    v_fma_f32 v179, v179, s35, v28
    v_exp_f32 v176, v176
    v_exp_f32 v177, v177
    v_add_f32 v21, v21, v174
    v_add_f32 v29, v29, v175
    v_cvt_pk_bf16_f32 v199, v174, v175
    v_fma_f32 v180, v180, s35, v28
    s_waitcnt lgkmcnt(7)
    v_mfma_f32_32x32x16_bf16 v[144:159], v[40:43], v[224:227], v[144:159]
    ds_read_b128 v[40:43], v16 offset:33792
    v_fma_f32 v181, v181, s35, v28
    v_exp_f32 v178, v178
    v_exp_f32 v179, v179
    v_add_f32 v21, v21, v176
    v_add_f32 v29, v29, v177
    v_cvt_pk_bf16_f32 v200, v176, v177
    v_fma_f32 v182, v182, s35, v28
    v_fma_f32 v183, v183, s35, v28
    v_exp_f32 v180, v180
    s_waitcnt lgkmcnt(7)
    v_mfma_f32_32x32x16_bf16 v[128:143], v[44:47], v[228:231], v[128:143]
    ds_read_b128 v[44:47], v16 offset:34816
    v_exp_f32 v181, v181
    v_add_f32 v21, v21, v178
    v_add_f32 v29, v29, v179
    v_cvt_pk_bf16_f32 v201, v178, v179
    v_fma_f32 v184, v184, s35, v28
    v_fma_f32 v185, v185, s35, v28
    v_exp_f32 v182, v182
    v_exp_f32 v183, v183
    v_add_f32 v21, v21, v180
    s_waitcnt lgkmcnt(7)
    v_mfma_f32_32x32x16_bf16 v[144:159], v[48:51], v[228:231], v[144:159]
    ds_read_b128 v[48:51], v16 offset:35840
    v_add_f32 v29, v29, v181
    v_cvt_pk_bf16_f32 v202, v180, v181
    v_fma_f32 v186, v186, s35, v28
    v_fma_f32 v187, v187, s35, v28
    v_exp_f32 v184, v184
    v_exp_f32 v185, v185
    v_add_f32 v21, v21, v182
    v_add_f32 v29, v29, v183
    v_cvt_pk_bf16_f32 v203, v182, v183
    s_waitcnt lgkmcnt(7)
    v_mfma_f32_32x32x16_bf16 v[128:143], v[52:55], v[232:235], v[128:143]
    ds_read_b128 v[52:55], v16 offset:36864
    v_fma_f32 v188, v188, s35, v28
    v_fma_f32 v189, v189, s35, v28
    v_exp_f32 v186, v186
    v_exp_f32 v187, v187
    v_add_f32 v21, v21, v184
    v_add_f32 v29, v29, v185
    v_cvt_pk_bf16_f32 v204, v184, v185
    v_fma_f32 v190, v190, s35, v28
    v_fma_f32 v191, v191, s35, v28
    s_waitcnt lgkmcnt(7)
    v_mfma_f32_32x32x16_bf16 v[144:159], v[56:59], v[232:235], v[144:159]
    ds_read_b128 v[56:59], v16 offset:37888
    v_exp_f32 v188, v188
    v_exp_f32 v189, v189
    v_add_f32 v21, v21, v186
    v_add_f32 v29, v29, v187
    v_cvt_pk_bf16_f32 v205, v186, v187
    v_exp_f32 v190, v190
    v_exp_f32 v191, v191
    v_add_f32 v21, v21, v188
    v_add_f32 v29, v29, v189
    s_waitcnt lgkmcnt(7)
    v_mfma_f32_32x32x16_bf16 v[128:143], v[60:63], v[236:239], v[128:143]
    ds_read_b128 v[60:63], v16 offset:38912
    v_cvt_pk_bf16_f32 v206, v188, v189
    s_nop 0
    v_add_f32 v21, v21, v190
    v_add_f32 v29, v29, v191
    v_cvt_pk_bf16_f32 v207, v190, v191
    v_add_f32 v21, v21, v29
    s_waitcnt lgkmcnt(7)
    v_mfma_f32_32x32x16_bf16 v[144:159], v[240:243], v[236:239], v[144:159]
    ds_read_b128 v[240:243], v16 offset:39936
    s_waitcnt lgkmcnt(7)
    s_nop 1
    v_mfma_f32_32x32x16_bf16 v[64:79], v[36:39], v[192:195], v[64:79]
    ds_read_b128 v[36:39], v16 offset:40960
    s_waitcnt lgkmcnt(7)
    v_mfma_f32_32x32x16_bf16 v[80:95], v[40:43], v[192:195], v[80:95]
    ds_read_b128 v[40:43], v16 offset:41984
    s_add_u32 m0, s34, 65536
    s_nop 0
    buffer_load_dwordx4 v23, s[12:15], s33 offen offset:0 lds
    s_waitcnt lgkmcnt(7)
    v_mfma_f32_32x32x16_bf16 v[96:111], v[44:47], v[192:195], v[96:111]
    ds_read_b128 v[44:47], v16 offset:43008
    s_waitcnt lgkmcnt(7)
    v_mfma_f32_32x32x16_bf16 v[112:127], v[48:51], v[192:195], v[112:127]
    ds_read_b128 v[48:51], v16 offset:44032
    s_add_u32 m0, s34, 65536
    s_nop 0
    buffer_load_dwordx4 v23, s[12:15], s33 offen offset:1024 lds
    s_waitcnt lgkmcnt(7)
    v_mfma_f32_32x32x16_bf16 v[64:79], v[52:55], v[196:199], v[64:79]
    ds_read_b128 v[52:55], v16 offset:45056
    s_waitcnt lgkmcnt(7)
    v_mfma_f32_32x32x16_bf16 v[80:95], v[56:59], v[196:199], v[80:95]
    ds_read_b128 v[56:59], v16 offset:46080
    s_add_u32 m0, s34, 65536
    s_nop 0
    buffer_load_dwordx4 v23, s[12:15], s33 offen offset:2048 lds
    s_waitcnt lgkmcnt(7)
    v_mfma_f32_32x32x16_bf16 v[96:111], v[60:63], v[196:199], v[96:111]
    ds_read_b128 v[60:63], v16 offset:47104
    s_waitcnt lgkmcnt(7)
    v_mfma_f32_32x32x16_bf16 v[112:127], v[240:243], v[196:199], v[112:127]
    ds_read_b128 v[240:243], v16 offset:48128
    s_add_u32 m0, s34, 65536
    s_nop 0
    buffer_load_dwordx4 v23, s[12:15], s33 offen offset:3072 lds
    s_waitcnt lgkmcnt(7)
    v_mfma_f32_32x32x16_bf16 v[64:79], v[36:39], v[200:203], v[64:79]
    s_waitcnt lgkmcnt(6)
    v_mfma_f32_32x32x16_bf16 v[80:95], v[40:43], v[200:203], v[80:95]
    s_cmp_lt_u32 s38, 2
    s_cbranch_scc1 L_nd_336
    s_add_u32 m0, s34, 32768
    s_nop 0
    buffer_load_dwordx4 v23, s[8:11], s32 offen offset:0 lds
L_nd_336:
    s_waitcnt lgkmcnt(5)
    v_mfma_f32_32x32x16_bf16 v[96:111], v[44:47], v[200:203], v[96:111]
    s_waitcnt lgkmcnt(4)
    v_mfma_f32_32x32x16_bf16 v[112:127], v[48:51], v[200:203], v[112:127]
    s_cmp_lt_u32 s38, 2
    s_cbranch_scc1 L_nd_337
    s_add_u32 m0, s34, 32768
    s_nop 0
    buffer_load_dwordx4 v23, s[8:11], s32 offen offset:1024 lds
L_nd_337:
    s_waitcnt lgkmcnt(3)
    v_mfma_f32_32x32x16_bf16 v[64:79], v[52:55], v[204:207], v[64:79]
    s_waitcnt lgkmcnt(2)
    v_mfma_f32_32x32x16_bf16 v[80:95], v[56:59], v[204:207], v[80:95]
    s_cmp_lt_u32 s38, 2
    s_cbranch_scc1 L_nd_338
    s_add_u32 m0, s34, 32768
    s_nop 0
    buffer_load_dwordx4 v23, s[8:11], s32 offen offset:2048 lds
L_nd_338:
    s_waitcnt lgkmcnt(1)
    v_mfma_f32_32x32x16_bf16 v[96:111], v[60:63], v[204:207], v[96:111]
    s_waitcnt lgkmcnt(0)
    v_mfma_f32_32x32x16_bf16 v[112:127], v[240:243], v[204:207], v[112:127]
    s_cmp_lt_u32 s38, 2
    s_cbranch_scc1 L_nd_339
    s_add_u32 m0, s34, 32768
    s_nop 0
    buffer_load_dwordx4 v23, s[8:11], s32 offen offset:3072 lds
L_nd_339:
    s_add_u32 s31, s31, 1
    s_branch L_k2_loop
L_k2_tail0:
    ds_read_b128 v[36:39], v16 offset:0
    ds_read_b128 v[40:43], v16 offset:1024
    ds_read_b128 v[44:47], v16 offset:2048
    ds_read_b128 v[48:51], v16 offset:3072
    ds_read_b128 v[52:55], v16 offset:4096
    ds_read_b128 v[56:59], v16 offset:5120
    ds_read_b128 v[60:63], v16 offset:6144
    ds_read_b128 v[240:243], v16 offset:7168
    s_cmp_lg_u32 s36, 0
    s_cbranch_scc1 L_wpf_340
    s_lshl_b32 s83, s2, 2
    s_add_u32 s83, s83, s28
    s_cmp_ge_u32 s83, 576
    s_cbranch_scc1 L_wpf_340
    s_sub_u32 s3, s83, 512
    s_mov_b32 s94, 0x400000
    s_cmp_lt_u32 s83, 512
    s_cselect_b32 s92, s86, s88
    s_cselect_b32 s93, s87, s89
    s_cselect_b32 s94, s94, 0x80000
    s_cselect_b32 s3, s83, s3
    s_mov_b32 s95, 0x00020000
    s_lshl_b32 s3, s3, 13
    v_lshlrev_b32 v244, 7, v2
    buffer_load_dword v244, v244, s[92:95], s3 offen
L_wpf_340:

    s_cmp_lg_u32 s36, 0
    s_cbranch_scc1 L_k0pf_341
    s_add_u32 m0, s34, 0
    s_nop 0
    buffer_load_dwordx4 v23, s[8:11], 0 offen offset:0 lds
    buffer_load_dwordx4 v23, s[8:11], 0 offen offset:1024 lds
    buffer_load_dwordx4 v23, s[8:11], 0 offen offset:2048 lds
    buffer_load_dwordx4 v23, s[8:11], 0 offen offset:3072 lds
L_k0pf_341:
    s_nop 7
    v_mov_b32 v24, 0xf149f2ca
    v_cmp_gt_i32 vcc, 0, v22
    s_nop 1
    v_cndmask_b32 v128, v128, v24, vcc
    v_cmp_gt_i32 vcc, 1, v22
    s_nop 1
    v_cndmask_b32 v129, v129, v24, vcc
    v_cmp_gt_i32 vcc, 2, v22
    s_nop 1
    v_cndmask_b32 v130, v130, v24, vcc
    v_cmp_gt_i32 vcc, 3, v22
    s_nop 1
    v_cndmask_b32 v131, v131, v24, vcc
    v_cmp_gt_i32 vcc, 8, v22
    s_nop 1
    v_cndmask_b32 v132, v132, v24, vcc
    v_cmp_gt_i32 vcc, 9, v22
    s_nop 1
    v_cndmask_b32 v133, v133, v24, vcc
    v_cmp_gt_i32 vcc, 10, v22
    s_nop 1
    v_cndmask_b32 v134, v134, v24, vcc
    v_cmp_gt_i32 vcc, 11, v22
    s_nop 1
    v_cndmask_b32 v135, v135, v24, vcc
    v_cmp_gt_i32 vcc, 16, v22
    s_nop 1
    v_cndmask_b32 v136, v136, v24, vcc
    v_cmp_gt_i32 vcc, 17, v22
    s_nop 1
    v_cndmask_b32 v137, v137, v24, vcc
    v_cmp_gt_i32 vcc, 18, v22
    s_nop 1
    v_cndmask_b32 v138, v138, v24, vcc
    v_cmp_gt_i32 vcc, 19, v22
    s_nop 1
    v_cndmask_b32 v139, v139, v24, vcc
    v_cmp_gt_i32 vcc, 24, v22
    s_nop 1
    v_cndmask_b32 v140, v140, v24, vcc
    v_cmp_gt_i32 vcc, 25, v22
    s_nop 1
    v_cndmask_b32 v141, v141, v24, vcc
    v_cmp_gt_i32 vcc, 26, v22
    s_nop 1
    v_cndmask_b32 v142, v142, v24, vcc
    v_cmp_gt_i32 vcc, 27, v22
    s_nop 1
    v_cndmask_b32 v143, v143, v24, vcc
    v_cmp_gt_i32 vcc, 32, v22
    s_nop 1
    v_cndmask_b32 v144, v144, v24, vcc
    v_cmp_gt_i32 vcc, 33, v22
    s_nop 1
    v_cndmask_b32 v145, v145, v24, vcc
    v_cmp_gt_i32 vcc, 34, v22
    s_nop 1
    v_cndmask_b32 v146, v146, v24, vcc
    v_cmp_gt_i32 vcc, 35, v22
    s_nop 1
    v_cndmask_b32 v147, v147, v24, vcc
    v_cmp_gt_i32 vcc, 40, v22
    s_nop 1
    v_cndmask_b32 v148, v148, v24, vcc
    v_cmp_gt_i32 vcc, 41, v22
    s_nop 1
    v_cndmask_b32 v149, v149, v24, vcc
    v_cmp_gt_i32 vcc, 42, v22
    s_nop 1
    v_cndmask_b32 v150, v150, v24, vcc
    v_cmp_gt_i32 vcc, 43, v22
    s_nop 1
    v_cndmask_b32 v151, v151, v24, vcc
    v_cmp_gt_i32 vcc, 48, v22
    s_nop 1
    v_cndmask_b32 v152, v152, v24, vcc
    v_cmp_gt_i32 vcc, 49, v22
    s_nop 1
    v_cndmask_b32 v153, v153, v24, vcc
    v_cmp_gt_i32 vcc, 50, v22
    s_nop 1
    v_cndmask_b32 v154, v154, v24, vcc
    v_cmp_gt_i32 vcc, 51, v22
    s_nop 1
    v_cndmask_b32 v155, v155, v24, vcc
    v_cmp_gt_i32 vcc, 56, v22
    s_nop 1
    v_cndmask_b32 v156, v156, v24, vcc
    v_cmp_gt_i32 vcc, 57, v22
    s_nop 1
    v_cndmask_b32 v157, v157, v24, vcc
    v_cmp_gt_i32 vcc, 58, v22
    s_nop 1
    v_cndmask_b32 v158, v158, v24, vcc
    v_cmp_gt_i32 vcc, 59, v22
    s_nop 1
    v_cndmask_b32 v159, v159, v24, vcc
    v_max3_f32 v24, v128, v129, v130
    v_max3_f32 v25, v144, v145, v146
    v_max3_f32 v24, v24, v131, v132
    v_max3_f32 v25, v25, v147, v148
    v_max3_f32 v24, v24, v133, v134
    v_max3_f32 v25, v25, v149, v150
    v_max3_f32 v24, v24, v135, v136
    v_max3_f32 v25, v25, v151, v152
    v_max3_f32 v24, v24, v137, v138
    v_max3_f32 v25, v25, v153, v154
    v_max3_f32 v24, v24, v139, v140
    v_max3_f32 v25, v25, v155, v156
    v_max3_f32 v24, v24, v141, v142
    v_max3_f32 v25, v25, v157, v158
    v_max3_f32 v24, v24, v143, v25
    v_max_f32 v24, v24, v159
    v_mov_b32 v25, v24
    s_nop 1
    v_permlane32_swap_b32 v24, v25
    s_nop 1
    v_max_f32 v24, v24, v25
    v_mul_f32 v24, s35, v24
    v_max_f32 v25, v20, v24
    v_sub_f32 v26, v25, v20
    v_cmp_lt_f32 vcc, 0x41000000, v26
    s_cbranch_vccz L_noresc_342
    v_sub_f32 v26, 0, v26
    v_exp_f32 v26, v26
    v_mov_b32 v20, v25
    s_nop 0
    v_mov_b32 v27, v26
    v_mul_f32 v21, v21, v26
    v_pk_mul_f32 v[64:65], v[64:65], v[26:27]
    v_pk_mul_f32 v[66:67], v[66:67], v[26:27]
    v_pk_mul_f32 v[68:69], v[68:69], v[26:27]
    v_pk_mul_f32 v[70:71], v[70:71], v[26:27]
    v_pk_mul_f32 v[72:73], v[72:73], v[26:27]
    v_pk_mul_f32 v[74:75], v[74:75], v[26:27]
    v_pk_mul_f32 v[76:77], v[76:77], v[26:27]
    v_pk_mul_f32 v[78:79], v[78:79], v[26:27]
    v_pk_mul_f32 v[80:81], v[80:81], v[26:27]
    v_pk_mul_f32 v[82:83], v[82:83], v[26:27]
    v_pk_mul_f32 v[84:85], v[84:85], v[26:27]
    v_pk_mul_f32 v[86:87], v[86:87], v[26:27]
    v_pk_mul_f32 v[88:89], v[88:89], v[26:27]
    v_pk_mul_f32 v[90:91], v[90:91], v[26:27]
    v_pk_mul_f32 v[92:93], v[92:93], v[26:27]
    v_pk_mul_f32 v[94:95], v[94:95], v[26:27]
    v_pk_mul_f32 v[96:97], v[96:97], v[26:27]
    v_pk_mul_f32 v[98:99], v[98:99], v[26:27]
    v_pk_mul_f32 v[100:101], v[100:101], v[26:27]
    v_pk_mul_f32 v[102:103], v[102:103], v[26:27]
    v_pk_mul_f32 v[104:105], v[104:105], v[26:27]
    v_pk_mul_f32 v[106:107], v[106:107], v[26:27]
    v_pk_mul_f32 v[108:109], v[108:109], v[26:27]
    v_pk_mul_f32 v[110:111], v[110:111], v[26:27]
    v_pk_mul_f32 v[112:113], v[112:113], v[26:27]
    v_pk_mul_f32 v[114:115], v[114:115], v[26:27]
    v_pk_mul_f32 v[116:117], v[116:117], v[26:27]
    v_pk_mul_f32 v[118:119], v[118:119], v[26:27]
    v_pk_mul_f32 v[120:121], v[120:121], v[26:27]
    v_pk_mul_f32 v[122:123], v[122:123], v[26:27]
    v_pk_mul_f32 v[124:125], v[124:125], v[26:27]
    v_pk_mul_f32 v[126:127], v[126:127], v[26:27]
L_noresc_342:
    v_sub_f32 v28, 0, v20
    v_fma_f32 v128, v128, s35, v28
    v_fma_f32 v129, v129, s35, v28
    v_fma_f32 v130, v130, s35, v28
    v_fma_f32 v131, v131, s35, v28
    v_exp_f32 v128, v128
    v_exp_f32 v129, v129
    v_fma_f32 v132, v132, s35, v28
    v_fma_f32 v133, v133, s35, v28
    v_exp_f32 v130, v130
    v_exp_f32 v131, v131
    v_add_f32 v21, v21, v128
    v_mov_b32 v29, v129
    v_cvt_pk_bf16_f32 v192, v128, v129
    v_fma_f32 v134, v134, s35, v28
    v_fma_f32 v135, v135, s35, v28
    v_exp_f32 v132, v132
    v_exp_f32 v133, v133
    v_add_f32 v21, v21, v130
    v_add_f32 v29, v29, v131
    v_cvt_pk_bf16_f32 v193, v130, v131
    v_fma_f32 v136, v136, s35, v28
    v_fma_f32 v137, v137, s35, v28
    v_exp_f32 v134, v134
    v_exp_f32 v135, v135
    v_add_f32 v21, v21, v132
    v_add_f32 v29, v29, v133
    v_cvt_pk_bf16_f32 v194, v132, v133
    v_fma_f32 v138, v138, s35, v28
    v_fma_f32 v139, v139, s35, v28
    v_exp_f32 v136, v136
    v_exp_f32 v137, v137
    v_add_f32 v21, v21, v134
    v_add_f32 v29, v29, v135
    v_cvt_pk_bf16_f32 v195, v134, v135
    v_fma_f32 v140, v140, s35, v28
    v_fma_f32 v141, v141, s35, v28
    v_exp_f32 v138, v138
    v_exp_f32 v139, v139
    v_add_f32 v21, v21, v136
    v_add_f32 v29, v29, v137
    v_cvt_pk_bf16_f32 v196, v136, v137
    v_fma_f32 v142, v142, s35, v28
    v_fma_f32 v143, v143, s35, v28
    v_exp_f32 v140, v140
    v_exp_f32 v141, v141
    v_add_f32 v21, v21, v138
    v_add_f32 v29, v29, v139
    v_cvt_pk_bf16_f32 v197, v138, v139
    v_fma_f32 v144, v144, s35, v28
    v_fma_f32 v145, v145, s35, v28
    v_exp_f32 v142, v142
    v_exp_f32 v143, v143
    v_add_f32 v21, v21, v140
    v_add_f32 v29, v29, v141
    v_cvt_pk_bf16_f32 v198, v140, v141
    v_fma_f32 v146, v146, s35, v28
    v_fma_f32 v147, v147, s35, v28
    v_exp_f32 v144, v144
    v_exp_f32 v145, v145
    v_add_f32 v21, v21, v142
    v_add_f32 v29, v29, v143
    v_cvt_pk_bf16_f32 v199, v142, v143
    v_fma_f32 v148, v148, s35, v28
    v_fma_f32 v149, v149, s35, v28
    v_exp_f32 v146, v146
    v_exp_f32 v147, v147
    v_add_f32 v21, v21, v144
    v_add_f32 v29, v29, v145
    v_cvt_pk_bf16_f32 v200, v144, v145
    v_fma_f32 v150, v150, s35, v28
    v_fma_f32 v151, v151, s35, v28
    v_exp_f32 v148, v148
    v_exp_f32 v149, v149
    v_add_f32 v21, v21, v146
    v_add_f32 v29, v29, v147
    v_cvt_pk_bf16_f32 v201, v146, v147
    v_fma_f32 v152, v152, s35, v28
    v_fma_f32 v153, v153, s35, v28
    v_exp_f32 v150, v150
    v_exp_f32 v151, v151
    v_add_f32 v21, v21, v148
    v_add_f32 v29, v29, v149
    v_cvt_pk_bf16_f32 v202, v148, v149
    v_fma_f32 v154, v154, s35, v28
    v_fma_f32 v155, v155, s35, v28
    v_exp_f32 v152, v152
    v_exp_f32 v153, v153
    v_add_f32 v21, v21, v150
    v_add_f32 v29, v29, v151
    v_cvt_pk_bf16_f32 v203, v150, v151
    v_fma_f32 v156, v156, s35, v28
    v_fma_f32 v157, v157, s35, v28
    v_exp_f32 v154, v154
    v_exp_f32 v155, v155
    v_add_f32 v21, v21, v152
    v_add_f32 v29, v29, v153
    v_cvt_pk_bf16_f32 v204, v152, v153
    v_fma_f32 v158, v158, s35, v28
    v_fma_f32 v159, v159, s35, v28
    v_exp_f32 v156, v156
    v_exp_f32 v157, v157
    v_add_f32 v21, v21, v154
    v_add_f32 v29, v29, v155
    v_cvt_pk_bf16_f32 v205, v154, v155
    v_exp_f32 v158, v158
    v_exp_f32 v159, v159
    v_add_f32 v21, v21, v156
    v_add_f32 v29, v29, v157
    v_cvt_pk_bf16_f32 v206, v156, v157
    s_nop 0
    v_add_f32 v21, v21, v158
    v_add_f32 v29, v29, v159
    v_cvt_pk_bf16_f32 v207, v158, v159
    v_add_f32 v21, v21, v29
    s_nop 1
    s_waitcnt lgkmcnt(7)
    v_mfma_f32_32x32x16_bf16 v[64:79], v[36:39], v[192:195], v[64:79]
    ds_read_b128 v[36:39], v16 offset:8192
    s_waitcnt lgkmcnt(7)
    v_mfma_f32_32x32x16_bf16 v[80:95], v[40:43], v[192:195], v[80:95]
    ds_read_b128 v[40:43], v16 offset:9216
    s_waitcnt lgkmcnt(7)
    v_mfma_f32_32x32x16_bf16 v[96:111], v[44:47], v[192:195], v[96:111]
    ds_read_b128 v[44:47], v16 offset:10240
    s_waitcnt lgkmcnt(7)
    v_mfma_f32_32x32x16_bf16 v[112:127], v[48:51], v[192:195], v[112:127]
    ds_read_b128 v[48:51], v16 offset:11264
    s_waitcnt lgkmcnt(7)
    v_mfma_f32_32x32x16_bf16 v[64:79], v[52:55], v[196:199], v[64:79]
    ds_read_b128 v[52:55], v16 offset:12288
    s_waitcnt lgkmcnt(7)
    v_mfma_f32_32x32x16_bf16 v[80:95], v[56:59], v[196:199], v[80:95]
    ds_read_b128 v[56:59], v16 offset:13312
    s_waitcnt lgkmcnt(7)
    v_mfma_f32_32x32x16_bf16 v[96:111], v[60:63], v[196:199], v[96:111]
    ds_read_b128 v[60:63], v16 offset:14336
    s_waitcnt lgkmcnt(7)
    v_mfma_f32_32x32x16_bf16 v[112:127], v[240:243], v[196:199], v[112:127]
    ds_read_b128 v[240:243], v16 offset:15360
    s_waitcnt lgkmcnt(7)
    v_mfma_f32_32x32x16_bf16 v[64:79], v[36:39], v[200:203], v[64:79]
    s_waitcnt lgkmcnt(6)
    v_mfma_f32_32x32x16_bf16 v[80:95], v[40:43], v[200:203], v[80:95]
    s_waitcnt lgkmcnt(5)
    v_mfma_f32_32x32x16_bf16 v[96:111], v[44:47], v[200:203], v[96:111]
    s_waitcnt lgkmcnt(4)
    v_mfma_f32_32x32x16_bf16 v[112:127], v[48:51], v[200:203], v[112:127]
    s_waitcnt lgkmcnt(3)
    v_mfma_f32_32x32x16_bf16 v[64:79], v[52:55], v[204:207], v[64:79]
    s_waitcnt lgkmcnt(2)
    v_mfma_f32_32x32x16_bf16 v[80:95], v[56:59], v[204:207], v[80:95]
    s_waitcnt lgkmcnt(1)
    v_mfma_f32_32x32x16_bf16 v[96:111], v[60:63], v[204:207], v[96:111]
    s_waitcnt lgkmcnt(0)
    v_mfma_f32_32x32x16_bf16 v[112:127], v[240:243], v[204:207], v[112:127]
    s_barrier
    s_branch L_k2_merge
L_k2_tail1:
    ds_read_b128 v[36:39], v16 offset:32768
    ds_read_b128 v[40:43], v16 offset:33792
    ds_read_b128 v[44:47], v16 offset:34816
    ds_read_b128 v[48:51], v16 offset:35840
    ds_read_b128 v[52:55], v16 offset:36864
    ds_read_b128 v[56:59], v16 offset:37888
    ds_read_b128 v[60:63], v16 offset:38912
    ds_read_b128 v[240:243], v16 offset:39936
    s_cmp_lg_u32 s36, 0
    s_cbranch_scc1 L_wpf_343
    s_lshl_b32 s83, s2, 2
    s_add_u32 s83, s83, s28
    s_cmp_ge_u32 s83, 576
    s_cbranch_scc1 L_wpf_343
    s_sub_u32 s3, s83, 512
    s_mov_b32 s94, 0x400000
    s_cmp_lt_u32 s83, 512
    s_cselect_b32 s92, s86, s88
    s_cselect_b32 s93, s87, s89
    s_cselect_b32 s94, s94, 0x80000
    s_cselect_b32 s3, s83, s3
    s_mov_b32 s95, 0x00020000
    s_lshl_b32 s3, s3, 13
    v_lshlrev_b32 v244, 7, v2
    buffer_load_dword v244, v244, s[92:95], s3 offen
L_wpf_343:

    s_cmp_lg_u32 s36, 0
    s_cbranch_scc1 L_k0pf_344
    s_add_u32 m0, s34, 0
    s_nop 0
    buffer_load_dwordx4 v23, s[8:11], 0 offen offset:0 lds
    buffer_load_dwordx4 v23, s[8:11], 0 offen offset:1024 lds
    buffer_load_dwordx4 v23, s[8:11], 0 offen offset:2048 lds
    buffer_load_dwordx4 v23, s[8:11], 0 offen offset:3072 lds
L_k0pf_344:
    s_nop 7
    v_mov_b32 v24, 0xf149f2ca
    v_cmp_gt_i32 vcc, 0, v22
    s_nop 1
    v_cndmask_b32 v160, v160, v24, vcc
    v_cmp_gt_i32 vcc, 1, v22
    s_nop 1
    v_cndmask_b32 v161, v161, v24, vcc
    v_cmp_gt_i32 vcc, 2, v22
    s_nop 1
    v_cndmask_b32 v162, v162, v24, vcc
    v_cmp_gt_i32 vcc, 3, v22
    s_nop 1
    v_cndmask_b32 v163, v163, v24, vcc
    v_cmp_gt_i32 vcc, 8, v22
    s_nop 1
    v_cndmask_b32 v164, v164, v24, vcc
    v_cmp_gt_i32 vcc, 9, v22
    s_nop 1
    v_cndmask_b32 v165, v165, v24, vcc
    v_cmp_gt_i32 vcc, 10, v22
    s_nop 1
    v_cndmask_b32 v166, v166, v24, vcc
    v_cmp_gt_i32 vcc, 11, v22
    s_nop 1
    v_cndmask_b32 v167, v167, v24, vcc
    v_cmp_gt_i32 vcc, 16, v22
    s_nop 1
    v_cndmask_b32 v168, v168, v24, vcc
    v_cmp_gt_i32 vcc, 17, v22
    s_nop 1
    v_cndmask_b32 v169, v169, v24, vcc
    v_cmp_gt_i32 vcc, 18, v22
    s_nop 1
    v_cndmask_b32 v170, v170, v24, vcc
    v_cmp_gt_i32 vcc, 19, v22
    s_nop 1
    v_cndmask_b32 v171, v171, v24, vcc
    v_cmp_gt_i32 vcc, 24, v22
    s_nop 1
    v_cndmask_b32 v172, v172, v24, vcc
    v_cmp_gt_i32 vcc, 25, v22
    s_nop 1
    v_cndmask_b32 v173, v173, v24, vcc
    v_cmp_gt_i32 vcc, 26, v22
    s_nop 1
    v_cndmask_b32 v174, v174, v24, vcc
    v_cmp_gt_i32 vcc, 27, v22
    s_nop 1
    v_cndmask_b32 v175, v175, v24, vcc
    v_cmp_gt_i32 vcc, 32, v22
    s_nop 1
    v_cndmask_b32 v176, v176, v24, vcc
    v_cmp_gt_i32 vcc, 33, v22
    s_nop 1
    v_cndmask_b32 v177, v177, v24, vcc
    v_cmp_gt_i32 vcc, 34, v22
    s_nop 1
    v_cndmask_b32 v178, v178, v24, vcc
    v_cmp_gt_i32 vcc, 35, v22
    s_nop 1
    v_cndmask_b32 v179, v179, v24, vcc
    v_cmp_gt_i32 vcc, 40, v22
    s_nop 1
    v_cndmask_b32 v180, v180, v24, vcc
    v_cmp_gt_i32 vcc, 41, v22
    s_nop 1
    v_cndmask_b32 v181, v181, v24, vcc
    v_cmp_gt_i32 vcc, 42, v22
    s_nop 1
    v_cndmask_b32 v182, v182, v24, vcc
    v_cmp_gt_i32 vcc, 43, v22
    s_nop 1
    v_cndmask_b32 v183, v183, v24, vcc
    v_cmp_gt_i32 vcc, 48, v22
    s_nop 1
    v_cndmask_b32 v184, v184, v24, vcc
    v_cmp_gt_i32 vcc, 49, v22
    s_nop 1
    v_cndmask_b32 v185, v185, v24, vcc
    v_cmp_gt_i32 vcc, 50, v22
    s_nop 1
    v_cndmask_b32 v186, v186, v24, vcc
    v_cmp_gt_i32 vcc, 51, v22
    s_nop 1
    v_cndmask_b32 v187, v187, v24, vcc
    v_cmp_gt_i32 vcc, 56, v22
    s_nop 1
    v_cndmask_b32 v188, v188, v24, vcc
    v_cmp_gt_i32 vcc, 57, v22
    s_nop 1
    v_cndmask_b32 v189, v189, v24, vcc
    v_cmp_gt_i32 vcc, 58, v22
    s_nop 1
    v_cndmask_b32 v190, v190, v24, vcc
    v_cmp_gt_i32 vcc, 59, v22
    s_nop 1
    v_cndmask_b32 v191, v191, v24, vcc
    v_max3_f32 v24, v160, v161, v162
    v_max3_f32 v25, v176, v177, v178
    v_max3_f32 v24, v24, v163, v164
    v_max3_f32 v25, v25, v179, v180
    v_max3_f32 v24, v24, v165, v166
    v_max3_f32 v25, v25, v181, v182
    v_max3_f32 v24, v24, v167, v168
    v_max3_f32 v25, v25, v183, v184
    v_max3_f32 v24, v24, v169, v170
    v_max3_f32 v25, v25, v185, v186
    v_max3_f32 v24, v24, v171, v172
    v_max3_f32 v25, v25, v187, v188
    v_max3_f32 v24, v24, v173, v174
    v_max3_f32 v25, v25, v189, v190
    v_max3_f32 v24, v24, v175, v25
    v_max_f32 v24, v24, v191
    v_mov_b32 v25, v24
    s_nop 1
    v_permlane32_swap_b32 v24, v25
    s_nop 1
    v_max_f32 v24, v24, v25
    v_mul_f32 v24, s35, v24
    v_max_f32 v25, v20, v24
    v_sub_f32 v26, v25, v20
    v_cmp_lt_f32 vcc, 0x41000000, v26
    s_cbranch_vccz L_noresc_345
    v_sub_f32 v26, 0, v26
    v_exp_f32 v26, v26
    v_mov_b32 v20, v25
    s_nop 0
    v_mov_b32 v27, v26
    v_mul_f32 v21, v21, v26
    v_pk_mul_f32 v[64:65], v[64:65], v[26:27]
    v_pk_mul_f32 v[66:67], v[66:67], v[26:27]
    v_pk_mul_f32 v[68:69], v[68:69], v[26:27]
    v_pk_mul_f32 v[70:71], v[70:71], v[26:27]
    v_pk_mul_f32 v[72:73], v[72:73], v[26:27]
    v_pk_mul_f32 v[74:75], v[74:75], v[26:27]
    v_pk_mul_f32 v[76:77], v[76:77], v[26:27]
    v_pk_mul_f32 v[78:79], v[78:79], v[26:27]
    v_pk_mul_f32 v[80:81], v[80:81], v[26:27]
    v_pk_mul_f32 v[82:83], v[82:83], v[26:27]
    v_pk_mul_f32 v[84:85], v[84:85], v[26:27]
    v_pk_mul_f32 v[86:87], v[86:87], v[26:27]
    v_pk_mul_f32 v[88:89], v[88:89], v[26:27]
    v_pk_mul_f32 v[90:91], v[90:91], v[26:27]
    v_pk_mul_f32 v[92:93], v[92:93], v[26:27]
    v_pk_mul_f32 v[94:95], v[94:95], v[26:27]
    v_pk_mul_f32 v[96:97], v[96:97], v[26:27]
    v_pk_mul_f32 v[98:99], v[98:99], v[26:27]
    v_pk_mul_f32 v[100:101], v[100:101], v[26:27]
    v_pk_mul_f32 v[102:103], v[102:103], v[26:27]
    v_pk_mul_f32 v[104:105], v[104:105], v[26:27]
    v_pk_mul_f32 v[106:107], v[106:107], v[26:27]
    v_pk_mul_f32 v[108:109], v[108:109], v[26:27]
    v_pk_mul_f32 v[110:111], v[110:111], v[26:27]
    v_pk_mul_f32 v[112:113], v[112:113], v[26:27]
    v_pk_mul_f32 v[114:115], v[114:115], v[26:27]
    v_pk_mul_f32 v[116:117], v[116:117], v[26:27]
    v_pk_mul_f32 v[118:119], v[118:119], v[26:27]
    v_pk_mul_f32 v[120:121], v[120:121], v[26:27]
    v_pk_mul_f32 v[122:123], v[122:123], v[26:27]
    v_pk_mul_f32 v[124:125], v[124:125], v[26:27]
    v_pk_mul_f32 v[126:127], v[126:127], v[26:27]
L_noresc_345:
    v_sub_f32 v28, 0, v20
    v_fma_f32 v160, v160, s35, v28
    v_fma_f32 v161, v161, s35, v28
    v_fma_f32 v162, v162, s35, v28
    v_fma_f32 v163, v163, s35, v28
    v_exp_f32 v160, v160
    v_exp_f32 v161, v161
    v_fma_f32 v164, v164, s35, v28
    v_fma_f32 v165, v165, s35, v28
    v_exp_f32 v162, v162
    v_exp_f32 v163, v163
    v_add_f32 v21, v21, v160
    v_mov_b32 v29, v161
    v_cvt_pk_bf16_f32 v192, v160, v161
    v_fma_f32 v166, v166, s35, v28
    v_fma_f32 v167, v167, s35, v28
    v_exp_f32 v164, v164
    v_exp_f32 v165, v165
    v_add_f32 v21, v21, v162
    v_add_f32 v29, v29, v163
    v_cvt_pk_bf16_f32 v193, v162, v163
    v_fma_f32 v168, v168, s35, v28
    v_fma_f32 v169, v169, s35, v28
    v_exp_f32 v166, v166
    v_exp_f32 v167, v167
    v_add_f32 v21, v21, v164
    v_add_f32 v29, v29, v165
    v_cvt_pk_bf16_f32 v194, v164, v165
    v_fma_f32 v170, v170, s35, v28
    v_fma_f32 v171, v171, s35, v28
    v_exp_f32 v168, v168
    v_exp_f32 v169, v169
    v_add_f32 v21, v21, v166
    v_add_f32 v29, v29, v167
    v_cvt_pk_bf16_f32 v195, v166, v167
    v_fma_f32 v172, v172, s35, v28
    v_fma_f32 v173, v173, s35, v28
    v_exp_f32 v170, v170
    v_exp_f32 v171, v171
    v_add_f32 v21, v21, v168
    v_add_f32 v29, v29, v169
    v_cvt_pk_bf16_f32 v196, v168, v169
    v_fma_f32 v174, v174, s35, v28
    v_fma_f32 v175, v175, s35, v28
    v_exp_f32 v172, v172
    v_exp_f32 v173, v173
    v_add_f32 v21, v21, v170
    v_add_f32 v29, v29, v171
    v_cvt_pk_bf16_f32 v197, v170, v171
    v_fma_f32 v176, v176, s35, v28
    v_fma_f32 v177, v177, s35, v28
    v_exp_f32 v174, v174
    v_exp_f32 v175, v175
    v_add_f32 v21, v21, v172
    v_add_f32 v29, v29, v173
    v_cvt_pk_bf16_f32 v198, v172, v173
    v_fma_f32 v178, v178, s35, v28
    v_fma_f32 v179, v179, s35, v28
    v_exp_f32 v176, v176
    v_exp_f32 v177, v177
    v_add_f32 v21, v21, v174
    v_add_f32 v29, v29, v175
    v_cvt_pk_bf16_f32 v199, v174, v175
    v_fma_f32 v180, v180, s35, v28
    v_fma_f32 v181, v181, s35, v28
    v_exp_f32 v178, v178
    v_exp_f32 v179, v179
    v_add_f32 v21, v21, v176
    v_add_f32 v29, v29, v177
    v_cvt_pk_bf16_f32 v200, v176, v177
    v_fma_f32 v182, v182, s35, v28
    v_fma_f32 v183, v183, s35, v28
    v_exp_f32 v180, v180
    v_exp_f32 v181, v181
    v_add_f32 v21, v21, v178
    v_add_f32 v29, v29, v179
    v_cvt_pk_bf16_f32 v201, v178, v179
    v_fma_f32 v184, v184, s35, v28
    v_fma_f32 v185, v185, s35, v28
    v_exp_f32 v182, v182
    v_exp_f32 v183, v183
    v_add_f32 v21, v21, v180
    v_add_f32 v29, v29, v181
    v_cvt_pk_bf16_f32 v202, v180, v181
    v_fma_f32 v186, v186, s35, v28
    v_fma_f32 v187, v187, s35, v28
    v_exp_f32 v184, v184
    v_exp_f32 v185, v185
    v_add_f32 v21, v21, v182
    v_add_f32 v29, v29, v183
    v_cvt_pk_bf16_f32 v203, v182, v183
    v_fma_f32 v188, v188, s35, v28
    v_fma_f32 v189, v189, s35, v28
    v_exp_f32 v186, v186
    v_exp_f32 v187, v187
    v_add_f32 v21, v21, v184
    v_add_f32 v29, v29, v185
    v_cvt_pk_bf16_f32 v204, v184, v185
    v_fma_f32 v190, v190, s35, v28
    v_fma_f32 v191, v191, s35, v28
    v_exp_f32 v188, v188
    v_exp_f32 v189, v189
    v_add_f32 v21, v21, v186
    v_add_f32 v29, v29, v187
    v_cvt_pk_bf16_f32 v205, v186, v187
    v_exp_f32 v190, v190
    v_exp_f32 v191, v191
    v_add_f32 v21, v21, v188
    v_add_f32 v29, v29, v189
    v_cvt_pk_bf16_f32 v206, v188, v189
    s_nop 0
    v_add_f32 v21, v21, v190
    v_add_f32 v29, v29, v191
    v_cvt_pk_bf16_f32 v207, v190, v191
    v_add_f32 v21, v21, v29
    s_nop 1
    s_waitcnt lgkmcnt(7)
    v_mfma_f32_32x32x16_bf16 v[64:79], v[36:39], v[192:195], v[64:79]
    ds_read_b128 v[36:39], v16 offset:40960
    s_waitcnt lgkmcnt(7)
    v_mfma_f32_32x32x16_bf16 v[80:95], v[40:43], v[192:195], v[80:95]
    ds_read_b128 v[40:43], v16 offset:41984
    s_waitcnt lgkmcnt(7)
    v_mfma_f32_32x32x16_bf16 v[96:111], v[44:47], v[192:195], v[96:111]
    ds_read_b128 v[44:47], v16 offset:43008
    s_waitcnt lgkmcnt(7)
    v_mfma_f32_32x32x16_bf16 v[112:127], v[48:51], v[192:195], v[112:127]
    ds_read_b128 v[48:51], v16 offset:44032
    s_waitcnt lgkmcnt(7)
    v_mfma_f32_32x32x16_bf16 v[64:79], v[52:55], v[196:199], v[64:79]
    ds_read_b128 v[52:55], v16 offset:45056
    s_waitcnt lgkmcnt(7)
    v_mfma_f32_32x32x16_bf16 v[80:95], v[56:59], v[196:199], v[80:95]
    ds_read_b128 v[56:59], v16 offset:46080
    s_waitcnt lgkmcnt(7)
    v_mfma_f32_32x32x16_bf16 v[96:111], v[60:63], v[196:199], v[96:111]
    ds_read_b128 v[60:63], v16 offset:47104
    s_waitcnt lgkmcnt(7)
    v_mfma_f32_32x32x16_bf16 v[112:127], v[240:243], v[196:199], v[112:127]
    ds_read_b128 v[240:243], v16 offset:48128
    s_waitcnt lgkmcnt(7)
    v_mfma_f32_32x32x16_bf16 v[64:79], v[36:39], v[200:203], v[64:79]
    s_waitcnt lgkmcnt(6)
    v_mfma_f32_32x32x16_bf16 v[80:95], v[40:43], v[200:203], v[80:95]
    s_waitcnt lgkmcnt(5)
    v_mfma_f32_32x32x16_bf16 v[96:111], v[44:47], v[200:203], v[96:111]
    s_waitcnt lgkmcnt(4)
    v_mfma_f32_32x32x16_bf16 v[112:127], v[48:51], v[200:203], v[112:127]
    s_waitcnt lgkmcnt(3)
    v_mfma_f32_32x32x16_bf16 v[64:79], v[52:55], v[204:207], v[64:79]
    s_waitcnt lgkmcnt(2)
    v_mfma_f32_32x32x16_bf16 v[80:95], v[56:59], v[204:207], v[80:95]
    s_waitcnt lgkmcnt(1)
    v_mfma_f32_32x32x16_bf16 v[96:111], v[60:63], v[204:207], v[96:111]
    s_waitcnt lgkmcnt(0)
    v_mfma_f32_32x32x16_bf16 v[112:127], v[240:243], v[204:207], v[112:127]
    s_barrier
    s_branch L_k2_merge
L_k2_g1first:
    ds_read_b128 v[36:39], v8 offset:32768
    ds_read_b128 v[40:43], v8 offset:40960
    ds_read_b128 v[44:47], v8 offset:33792
    ds_read_b128 v[48:51], v8 offset:41984
    ds_read_b128 v[52:55], v8 offset:34816
    ds_read_b128 v[56:59], v8 offset:43008
    ds_read_b128 v[60:63], v8 offset:35840
    ds_read_b128 v[240:243], v8 offset:44032
    s_cmp_lt_u32 s38, 2
    s_cbranch_scc1 L_nd_346
    s_add_u32 m0, s34, 0
    s_nop 0
    buffer_load_dwordx4 v23, s[8:11], s32 offen offset:0 lds
L_nd_346:
    s_cmp_lt_u32 s38, 2
    s_cbranch_scc1 L_nd_347
    s_add_u32 m0, s34, 0
    s_nop 0
    buffer_load_dwordx4 v23, s[8:11], s32 offen offset:1024 lds
L_nd_347:
    s_cmp_lt_u32 s38, 2
    s_cbranch_scc1 L_nd_348
    s_add_u32 m0, s34, 0
    s_nop 0
    buffer_load_dwordx4 v23, s[8:11], s32 offen offset:2048 lds
L_nd_348:
    s_cmp_lt_u32 s38, 2
    s_cbranch_scc1 L_nd_349
    s_add_u32 m0, s34, 0
    s_nop 0
    buffer_load_dwordx4 v23, s[8:11], s32 offen offset:3072 lds
L_nd_349:
    s_branch L_k2_g1qk0
L_k2_g1loop:
    s_waitcnt vmcnt(0)
    s_barrier
    s_add_u32 s3, s31, 1
    s_lshl_b32 s33, s3, 15
    s_sub_u32 s38, s30, s3
    s_add_u32 s3, s31, 2
    s_lshl_b32 s32, s3, 15
    s_lshl_b32 s39, s31, 15
    s_cmp_eq_u32 s38, 0

    s_cbranch_scc1 L_k2_g1tail0
    s_cmp_eq_u32 s31, 0
    s_cbranch_scc1 L_k2_g1first
    ds_read_b128 v[36:39], v16 offset:32768
    ds_read_b128 v[40:43], v16 offset:33792
    ds_read_b128 v[44:47], v16 offset:34816
    ds_read_b128 v[48:51], v16 offset:35840
    ds_read_b128 v[52:55], v16 offset:36864
    ds_read_b128 v[56:59], v16 offset:37888
    ds_read_b128 v[60:63], v16 offset:38912
    ds_read_b128 v[240:243], v16 offset:39936
    s_waitcnt lgkmcnt(7)
    v_mfma_f32_32x32x16_bf16 v[64:79], v[36:39], v[192:195], v[64:79]
    ds_read_b128 v[36:39], v16 offset:40960
    s_waitcnt lgkmcnt(7)
    v_mfma_f32_32x32x16_bf16 v[80:95], v[40:43], v[192:195], v[80:95]
    ds_read_b128 v[40:43], v16 offset:41984
    s_add_u32 m0, s34, 65536
    s_nop 0
    buffer_load_dwordx4 v23, s[12:15], s39 offen offset:0 lds
    s_waitcnt lgkmcnt(7)
    v_mfma_f32_32x32x16_bf16 v[96:111], v[44:47], v[192:195], v[96:111]
    ds_read_b128 v[44:47], v16 offset:43008
    s_waitcnt lgkmcnt(7)
    v_mfma_f32_32x32x16_bf16 v[112:127], v[48:51], v[192:195], v[112:127]
    ds_read_b128 v[48:51], v16 offset:44032
    s_add_u32 m0, s34, 65536
    s_nop 0
    buffer_load_dwordx4 v23, s[12:15], s39 offen offset:1024 lds
    s_waitcnt lgkmcnt(7)
    v_mfma_f32_32x32x16_bf16 v[64:79], v[52:55], v[196:199], v[64:79]
    ds_read_b128 v[52:55], v16 offset:45056
    s_waitcnt lgkmcnt(7)
    v_mfma_f32_32x32x16_bf16 v[80:95], v[56:59], v[196:199], v[80:95]
    ds_read_b128 v[56:59], v16 offset:46080
    s_add_u32 m0, s34, 65536
    s_nop 0
    buffer_load_dwordx4 v23, s[12:15], s39 offen offset:2048 lds
    s_waitcnt lgkmcnt(7)
    v_mfma_f32_32x32x16_bf16 v[96:111], v[60:63], v[196:199], v[96:111]
    ds_read_b128 v[60:63], v16 offset:47104
    s_waitcnt lgkmcnt(7)
    v_mfma_f32_32x32x16_bf16 v[112:127], v[240:243], v[196:199], v[112:127]
    ds_read_b128 v[240:243], v16 offset:48128
    s_add_u32 m0, s34, 65536
    s_nop 0
    buffer_load_dwordx4 v23, s[12:15], s39 offen offset:3072 lds
    s_waitcnt lgkmcnt(7)
    v_mfma_f32_32x32x16_bf16 v[64:79], v[36:39], v[200:203], v[64:79]
    ds_read_b128 v[36:39], v8 offset:32768
    s_waitcnt lgkmcnt(7)
    v_mfma_f32_32x32x16_bf16 v[80:95], v[40:43], v[200:203], v[80:95]
    ds_read_b128 v[40:43], v8 offset:40960
    s_cmp_lt_u32 s38, 2
    s_cbranch_scc1 L_nd_351
    s_add_u32 m0, s34, 0
    s_nop 0
    buffer_load_dwordx4 v23, s[8:11], s32 offen offset:0 lds
L_nd_351:
    s_waitcnt lgkmcnt(7)
    v_mfma_f32_32x32x16_bf16 v[96:111], v[44:47], v[200:203], v[96:111]
    ds_read_b128 v[44:47], v8 offset:33792
    s_waitcnt lgkmcnt(7)
    v_mfma_f32_32x32x16_bf16 v[112:127], v[48:51], v[200:203], v[112:127]
    ds_read_b128 v[48:51], v8 offset:41984
    s_cmp_lt_u32 s38, 2
    s_cbranch_scc1 L_nd_352
    s_add_u32 m0, s34, 0
    s_nop 0
    buffer_load_dwordx4 v23, s[8:11], s32 offen offset:1024 lds
L_nd_352:
    s_waitcnt lgkmcnt(7)
    v_mfma_f32_32x32x16_bf16 v[64:79], v[52:55], v[204:207], v[64:79]
    ds_read_b128 v[52:55], v8 offset:34816
    s_waitcnt lgkmcnt(7)
    v_mfma_f32_32x32x16_bf16 v[80:95], v[56:59], v[204:207], v[80:95]
    ds_read_b128 v[56:59], v8 offset:43008
    s_cmp_lt_u32 s38, 2
    s_cbranch_scc1 L_nd_353
    s_add_u32 m0, s34, 0
    s_nop 0
    buffer_load_dwordx4 v23, s[8:11], s32 offen offset:2048 lds
L_nd_353:
    s_waitcnt lgkmcnt(7)
    v_mfma_f32_32x32x16_bf16 v[96:111], v[60:63], v[204:207], v[96:111]
    ds_read_b128 v[60:63], v8 offset:35840
    s_waitcnt lgkmcnt(7)
    v_mfma_f32_32x32x16_bf16 v[112:127], v[240:243], v[204:207], v[112:127]
    ds_read_b128 v[240:243], v8 offset:44032
    s_cmp_lt_u32 s38, 2
    s_cbranch_scc1 L_nd_354
    s_add_u32 m0, s34, 0
    s_nop 0
    buffer_load_dwordx4 v23, s[8:11], s32 offen offset:3072 lds
L_nd_354:
L_k2_g1qk0:
    v_max3_f32 v24, v128, v129, v130
    v_max3_f32 v25, v144, v145, v146
    v_max3_f32 v24, v24, v131, v132
    v_max3_f32 v25, v25, v147, v148
    v_max3_f32 v24, v24, v133, v134
    v_max3_f32 v25, v25, v149, v150
    v_max3_f32 v24, v24, v135, v136
    v_max3_f32 v25, v25, v151, v152
    s_waitcnt lgkmcnt(7)
    v_mfma_f32_32x32x16_bf16 v[160:175], v[36:39], v[208:211], 0
    ds_read_b128 v[36:39], v8 offset:36864
    v_max3_f32 v24, v24, v137, v138
    v_max3_f32 v25, v25, v153, v154
    v_max3_f32 v24, v24, v139, v140
    v_max3_f32 v25, v25, v155, v156
    s_waitcnt lgkmcnt(7)
    v_mfma_f32_32x32x16_bf16 v[176:191], v[40:43], v[208:211], 0
    ds_read_b128 v[40:43], v8 offset:45056
    v_max3_f32 v24, v24, v141, v142
    v_max3_f32 v25, v25, v157, v158
    v_max3_f32 v24, v24, v143, v25
    v_max_f32 v24, v24, v159
    v_mov_b32 v25, v24
    s_nop 1
    v_permlane32_swap_b32 v24, v25
    s_nop 1
    v_max_f32 v24, v24, v25
    v_mul_f32 v24, s35, v24
    v_max_f32 v25, v20, v24
    v_sub_f32 v26, v25, v20
    v_cmp_lt_f32 vcc, 0x41000000, v26
    s_cbranch_vccz L_noresc_350
    v_sub_f32 v26, 0, v26
    v_exp_f32 v26, v26
    v_mov_b32 v20, v25
    s_nop 0
    v_mov_b32 v27, v26
    v_mul_f32 v21, v21, v26
    v_pk_mul_f32 v[64:65], v[64:65], v[26:27]
    v_pk_mul_f32 v[66:67], v[66:67], v[26:27]
    v_pk_mul_f32 v[68:69], v[68:69], v[26:27]
    v_pk_mul_f32 v[70:71], v[70:71], v[26:27]
    v_pk_mul_f32 v[72:73], v[72:73], v[26:27]
    v_pk_mul_f32 v[74:75], v[74:75], v[26:27]
    v_pk_mul_f32 v[76:77], v[76:77], v[26:27]
    v_pk_mul_f32 v[78:79], v[78:79], v[26:27]
    v_pk_mul_f32 v[80:81], v[80:81], v[26:27]
    v_pk_mul_f32 v[82:83], v[82:83], v[26:27]
    v_pk_mul_f32 v[84:85], v[84:85], v[26:27]
    v_pk_mul_f32 v[86:87], v[86:87], v[26:27]
    v_pk_mul_f32 v[88:89], v[88:89], v[26:27]
    v_pk_mul_f32 v[90:91], v[90:91], v[26:27]
    v_pk_mul_f32 v[92:93], v[92:93], v[26:27]
    v_pk_mul_f32 v[94:95], v[94:95], v[26:27]
    v_pk_mul_f32 v[96:97], v[96:97], v[26:27]
    v_pk_mul_f32 v[98:99], v[98:99], v[26:27]
    v_pk_mul_f32 v[100:101], v[100:101], v[26:27]
    v_pk_mul_f32 v[102:103], v[102:103], v[26:27]
    v_pk_mul_f32 v[104:105], v[104:105], v[26:27]
    v_pk_mul_f32 v[106:107], v[106:107], v[26:27]
    v_pk_mul_f32 v[108:109], v[108:109], v[26:27]
    v_pk_mul_f32 v[110:111], v[110:111], v[26:27]
    v_pk_mul_f32 v[112:113], v[112:113], v[26:27]
    v_pk_mul_f32 v[114:115], v[114:115], v[26:27]
    v_pk_mul_f32 v[116:117], v[116:117], v[26:27]
    v_pk_mul_f32 v[118:119], v[118:119], v[26:27]
    v_pk_mul_f32 v[120:121], v[120:121], v[26:27]
    v_pk_mul_f32 v[122:123], v[122:123], v[26:27]
    v_pk_mul_f32 v[124:125], v[124:125], v[26:27]
    v_pk_mul_f32 v[126:127], v[126:127], v[26:27]
L_noresc_350:
    v_sub_f32 v28, 0, v20
    s_waitcnt lgkmcnt(7)
    v_mfma_f32_32x32x16_bf16 v[160:175], v[44:47], v[212:215], v[160:175]
    ds_read_b128 v[44:47], v8 offset:37888
    v_fma_f32 v128, v128, s35, v28
    v_fma_f32 v129, v129, s35, v28
    v_fma_f32 v130, v130, s35, v28
    v_fma_f32 v131, v131, s35, v28
    v_exp_f32 v128, v128
    v_exp_f32 v129, v129
    v_fma_f32 v132, v132, s35, v28
    v_fma_f32 v133, v133, s35, v28
    v_exp_f32 v130, v130
    s_waitcnt lgkmcnt(7)
    v_mfma_f32_32x32x16_bf16 v[176:191], v[48:51], v[212:215], v[176:191]
    ds_read_b128 v[48:51], v8 offset:46080
    v_exp_f32 v131, v131
    v_add_f32 v21, v21, v128
    v_mov_b32 v29, v129
    v_cvt_pk_bf16_f32 v192, v128, v129
    v_fma_f32 v134, v134, s35, v28
    v_fma_f32 v135, v135, s35, v28
    v_exp_f32 v132, v132
    v_exp_f32 v133, v133
    v_add_f32 v21, v21, v130
    s_waitcnt lgkmcnt(7)
    v_mfma_f32_32x32x16_bf16 v[160:175], v[52:55], v[216:219], v[160:175]
    ds_read_b128 v[52:55], v8 offset:38912
    v_add_f32 v29, v29, v131
    v_cvt_pk_bf16_f32 v193, v130, v131
    v_fma_f32 v136, v136, s35, v28
    v_fma_f32 v137, v137, s35, v28
    v_exp_f32 v134, v134
    v_exp_f32 v135, v135
    v_add_f32 v21, v21, v132
    v_add_f32 v29, v29, v133
    v_cvt_pk_bf16_f32 v194, v132, v133
    s_waitcnt lgkmcnt(7)
    v_mfma_f32_32x32x16_bf16 v[176:191], v[56:59], v[216:219], v[176:191]
    ds_read_b128 v[56:59], v8 offset:47104
    v_fma_f32 v138, v138, s35, v28
    v_fma_f32 v139, v139, s35, v28
    v_exp_f32 v136, v136
    v_exp_f32 v137, v137
    v_add_f32 v21, v21, v134
    v_add_f32 v29, v29, v135
    v_cvt_pk_bf16_f32 v195, v134, v135
    v_fma_f32 v140, v140, s35, v28
    v_fma_f32 v141, v141, s35, v28
    s_waitcnt lgkmcnt(7)
    v_mfma_f32_32x32x16_bf16 v[160:175], v[60:63], v[220:223], v[160:175]
    ds_read_b128 v[60:63], v8 offset:39936
    v_exp_f32 v138, v138
    v_exp_f32 v139, v139
    v_add_f32 v21, v21, v136
    v_add_f32 v29, v29, v137
    v_cvt_pk_bf16_f32 v196, v136, v137
    v_fma_f32 v142, v142, s35, v28
    v_fma_f32 v143, v143, s35, v28
    v_exp_f32 v140, v140
    v_exp_f32 v141, v141
    s_waitcnt lgkmcnt(7)
    v_mfma_f32_32x32x16_bf16 v[176:191], v[240:243], v[220:223], v[176:191]
    ds_read_b128 v[240:243], v8 offset:48128
    v_add_f32 v21, v21, v138
    v_add_f32 v29, v29, v139
    v_cvt_pk_bf16_f32 v197, v138, v139
    v_fma_f32 v144, v144, s35, v28
    v_fma_f32 v145, v145, s35, v28
    v_exp_f32 v142, v142
    v_exp_f32 v143, v143
    v_add_f32 v21, v21, v140
    v_add_f32 v29, v29, v141
    s_waitcnt lgkmcnt(7)
    v_mfma_f32_32x32x16_bf16 v[160:175], v[36:39], v[224:227], v[160:175]
    v_cvt_pk_bf16_f32 v198, v140, v141
    v_fma_f32 v146, v146, s35, v28
    v_fma_f32 v147, v147, s35, v28
    v_exp_f32 v144, v144
    v_exp_f32 v145, v145
    v_add_f32 v21, v21, v142
    v_add_f32 v29, v29, v143
    v_cvt_pk_bf16_f32 v199, v142, v143
    v_fma_f32 v148, v148, s35, v28
    s_waitcnt lgkmcnt(6)
    v_mfma_f32_32x32x16_bf16 v[176:191], v[40:43], v[224:227], v[176:191]
    v_fma_f32 v149, v149, s35, v28
    v_exp_f32 v146, v146
    v_exp_f32 v147, v147
    v_add_f32 v21, v21, v144
    v_add_f32 v29, v29, v145
    v_cvt_pk_bf16_f32 v200, v144, v145
    v_fma_f32 v150, v150, s35, v28
    v_fma_f32 v151, v151, s35, v28
    v_exp_f32 v148, v148
    s_waitcnt lgkmcnt(5)
    v_mfma_f32_32x32x16_bf16 v[160:175], v[44:47], v[228:231], v[160:175]
    v_exp_f32 v149, v149
    v_add_f32 v21, v21, v146
    v_add_f32 v29, v29, v147
    v_cvt_pk_bf16_f32 v201, v146, v147
    v_fma_f32 v152, v152, s35, v28
    v_fma_f32 v153, v153, s35, v28
    v_exp_f32 v150, v150
    v_exp_f32 v151, v151
    v_add_f32 v21, v21, v148
    s_waitcnt lgkmcnt(4)
    v_mfma_f32_32x32x16_bf16 v[176:191], v[48:51], v[228:231], v[176:191]
    v_add_f32 v29, v29, v149
    v_cvt_pk_bf16_f32 v202, v148, v149
    v_fma_f32 v154, v154, s35, v28
    v_fma_f32 v155, v155, s35, v28
    v_exp_f32 v152, v152
    v_exp_f32 v153, v153
    v_add_f32 v21, v21, v150
    v_add_f32 v29, v29, v151
    v_cvt_pk_bf16_f32 v203, v150, v151
    s_waitcnt lgkmcnt(3)
    v_mfma_f32_32x32x16_bf16 v[160:175], v[52:55], v[232:235], v[160:175]
    v_fma_f32 v156, v156, s35, v28
    v_fma_f32 v157, v157, s35, v28
    v_exp_f32 v154, v154
    v_exp_f32 v155, v155
    v_add_f32 v21, v21, v152
    v_add_f32 v29, v29, v153
    v_cvt_pk_bf16_f32 v204, v152, v153
    v_fma_f32 v158, v158, s35, v28
    v_fma_f32 v159, v159, s35, v28
    s_waitcnt lgkmcnt(2)
    v_mfma_f32_32x32x16_bf16 v[176:191], v[56:59], v[232:235], v[176:191]
    v_exp_f32 v156, v156
    v_exp_f32 v157, v157
    v_add_f32 v21, v21, v154
    v_add_f32 v29, v29, v155
    v_cvt_pk_bf16_f32 v205, v154, v155
    v_exp_f32 v158, v158
    v_exp_f32 v159, v159
    v_add_f32 v21, v21, v156
    v_add_f32 v29, v29, v157
    s_waitcnt lgkmcnt(1)
    v_mfma_f32_32x32x16_bf16 v[160:175], v[60:63], v[236:239], v[160:175]
    v_cvt_pk_bf16_f32 v206, v156, v157
    s_nop 0
    v_add_f32 v21, v21, v158
    v_add_f32 v29, v29, v159
    v_cvt_pk_bf16_f32 v207, v158, v159
    v_add_f32 v21, v21, v29
    s_waitcnt lgkmcnt(0)
    v_mfma_f32_32x32x16_bf16 v[176:191], v[240:243], v[236:239], v[176:191]
    s_add_u32 s31, s31, 1
    s_waitcnt vmcnt(0)
    s_barrier
    s_add_u32 s3, s31, 1
    s_lshl_b32 s33, s3, 15
    s_sub_u32 s38, s30, s3
    s_add_u32 s3, s31, 2
    s_lshl_b32 s32, s3, 15
    s_lshl_b32 s39, s31, 15
    s_cmp_eq_u32 s38, 0

    s_cbranch_scc1 L_k2_g1tail1
    ds_read_b128 v[36:39], v16 offset:0
    ds_read_b128 v[40:43], v16 offset:1024
    ds_read_b128 v[44:47], v16 offset:2048
    ds_read_b128 v[48:51], v16 offset:3072
    ds_read_b128 v[52:55], v16 offset:4096
    ds_read_b128 v[56:59], v16 offset:5120
    ds_read_b128 v[60:63], v16 offset:6144
    ds_read_b128 v[240:243], v16 offset:7168
    s_waitcnt lgkmcnt(7)
    v_mfma_f32_32x32x16_bf16 v[64:79], v[36:39], v[192:195], v[64:79]
    ds_read_b128 v[36:39], v16 offset:8192
    s_waitcnt lgkmcnt(7)
    v_mfma_f32_32x32x16_bf16 v[80:95], v[40:43], v[192:195], v[80:95]
    ds_read_b128 v[40:43], v16 offset:9216
    s_add_u32 m0, s34, 98304
    s_nop 0
    buffer_load_dwordx4 v23, s[12:15], s39 offen offset:0 lds
    s_waitcnt lgkmcnt(7)
    v_mfma_f32_32x32x16_bf16 v[96:111], v[44:47], v[192:195], v[96:111]
    ds_read_b128 v[44:47], v16 offset:10240
    s_waitcnt lgkmcnt(7)
    v_mfma_f32_32x32x16_bf16 v[112:127], v[48:51], v[192:195], v[112:127]
    ds_read_b128 v[48:51], v16 offset:11264
    s_add_u32 m0, s34, 98304
    s_nop 0
    buffer_load_dwordx4 v23, s[12:15], s39 offen offset:1024 lds
    s_waitcnt lgkmcnt(7)
    v_mfma_f32_32x32x16_bf16 v[64:79], v[52:55], v[196:199], v[64:79]
    ds_read_b128 v[52:55], v16 offset:12288
    s_waitcnt lgkmcnt(7)
    v_mfma_f32_32x32x16_bf16 v[80:95], v[56:59], v[196:199], v[80:95]
    ds_read_b128 v[56:59], v16 offset:13312
    s_add_u32 m0, s34, 98304
    s_nop 0
    buffer_load_dwordx4 v23, s[12:15], s39 offen offset:2048 lds
    s_waitcnt lgkmcnt(7)
    v_mfma_f32_32x32x16_bf16 v[96:111], v[60:63], v[196:199], v[96:111]
    ds_read_b128 v[60:63], v16 offset:14336
    s_waitcnt lgkmcnt(7)
    v_mfma_f32_32x32x16_bf16 v[112:127], v[240:243], v[196:199], v[112:127]
    ds_read_b128 v[240:243], v16 offset:15360
    s_add_u32 m0, s34, 98304
    s_nop 0
    buffer_load_dwordx4 v23, s[12:15], s39 offen offset:3072 lds
    s_waitcnt lgkmcnt(7)
    v_mfma_f32_32x32x16_bf16 v[64:79], v[36:39], v[200:203], v[64:79]
    ds_read_b128 v[36:39], v8 offset:0
    s_waitcnt lgkmcnt(7)
    v_mfma_f32_32x32x16_bf16 v[80:95], v[40:43], v[200:203], v[80:95]
    ds_read_b128 v[40:43], v8 offset:8192
    s_cmp_lt_u32 s38, 2
    s_cbranch_scc1 L_nd_356
    s_add_u32 m0, s34, 32768
    s_nop 0
    buffer_load_dwordx4 v23, s[8:11], s32 offen offset:0 lds
L_nd_356:
    s_waitcnt lgkmcnt(7)
    v_mfma_f32_32x32x16_bf16 v[96:111], v[44:47], v[200:203], v[96:111]
    ds_read_b128 v[44:47], v8 offset:1024
    s_waitcnt lgkmcnt(7)
    v_mfma_f32_32x32x16_bf16 v[112:127], v[48:51], v[200:203], v[112:127]
    ds_read_b128 v[48:51], v8 offset:9216
    s_cmp_lt_u32 s38, 2
    s_cbranch_scc1 L_nd_357
    s_add_u32 m0, s34, 32768
    s_nop 0
    buffer_load_dwordx4 v23, s[8:11], s32 offen offset:1024 lds
L_nd_357:
    s_waitcnt lgkmcnt(7)
    v_mfma_f32_32x32x16_bf16 v[64:79], v[52:55], v[204:207], v[64:79]
    ds_read_b128 v[52:55], v8 offset:2048
    s_waitcnt lgkmcnt(7)
    v_mfma_f32_32x32x16_bf16 v[80:95], v[56:59], v[204:207], v[80:95]
    ds_read_b128 v[56:59], v8 offset:10240
    s_cmp_lt_u32 s38, 2
    s_cbranch_scc1 L_nd_358
    s_add_u32 m0, s34, 32768
    s_nop 0
    buffer_load_dwordx4 v23, s[8:11], s32 offen offset:2048 lds
L_nd_358:
    s_waitcnt lgkmcnt(7)
    v_mfma_f32_32x32x16_bf16 v[96:111], v[60:63], v[204:207], v[96:111]
    ds_read_b128 v[60:63], v8 offset:3072
    s_waitcnt lgkmcnt(7)
    v_mfma_f32_32x32x16_bf16 v[112:127], v[240:243], v[204:207], v[112:127]
    ds_read_b128 v[240:243], v8 offset:11264
    s_cmp_lt_u32 s38, 2
    s_cbranch_scc1 L_nd_359
    s_add_u32 m0, s34, 32768
    s_nop 0
    buffer_load_dwordx4 v23, s[8:11], s32 offen offset:3072 lds
L_nd_359:
L_k2_g1qk1:
    v_max3_f32 v24, v160, v161, v162
    v_max3_f32 v25, v176, v177, v178
    v_max3_f32 v24, v24, v163, v164
    v_max3_f32 v25, v25, v179, v180
    v_max3_f32 v24, v24, v165, v166
    v_max3_f32 v25, v25, v181, v182
    v_max3_f32 v24, v24, v167, v168
    v_max3_f32 v25, v25, v183, v184
    s_waitcnt lgkmcnt(7)
    v_mfma_f32_32x32x16_bf16 v[128:143], v[36:39], v[208:211], 0
    ds_read_b128 v[36:39], v8 offset:4096
    v_max3_f32 v24, v24, v169, v170
    v_max3_f32 v25, v25, v185, v186
    v_max3_f32 v24, v24, v171, v172
    v_max3_f32 v25, v25, v187, v188
    s_waitcnt lgkmcnt(7)
    v_mfma_f32_32x32x16_bf16 v[144:159], v[40:43], v[208:211], 0
    ds_read_b128 v[40:43], v8 offset:12288
    v_max3_f32 v24, v24, v173, v174
    v_max3_f32 v25, v25, v189, v190
    v_max3_f32 v24, v24, v175, v25
    v_max_f32 v24, v24, v191
    v_mov_b32 v25, v24
    s_nop 1
    v_permlane32_swap_b32 v24, v25
    s_nop 1
    v_max_f32 v24, v24, v25
    v_mul_f32 v24, s35, v24
    v_max_f32 v25, v20, v24
    v_sub_f32 v26, v25, v20
    v_cmp_lt_f32 vcc, 0x41000000, v26
    s_cbranch_vccz L_noresc_355
    v_sub_f32 v26, 0, v26
    v_exp_f32 v26, v26
    v_mov_b32 v20, v25
    s_nop 0
    v_mov_b32 v27, v26
    v_mul_f32 v21, v21, v26
    v_pk_mul_f32 v[64:65], v[64:65], v[26:27]
    v_pk_mul_f32 v[66:67], v[66:67], v[26:27]
    v_pk_mul_f32 v[68:69], v[68:69], v[26:27]
    v_pk_mul_f32 v[70:71], v[70:71], v[26:27]
    v_pk_mul_f32 v[72:73], v[72:73], v[26:27]
    v_pk_mul_f32 v[74:75], v[74:75], v[26:27]
    v_pk_mul_f32 v[76:77], v[76:77], v[26:27]
    v_pk_mul_f32 v[78:79], v[78:79], v[26:27]
    v_pk_mul_f32 v[80:81], v[80:81], v[26:27]
    v_pk_mul_f32 v[82:83], v[82:83], v[26:27]
    v_pk_mul_f32 v[84:85], v[84:85], v[26:27]
    v_pk_mul_f32 v[86:87], v[86:87], v[26:27]
    v_pk_mul_f32 v[88:89], v[88:89], v[26:27]
    v_pk_mul_f32 v[90:91], v[90:91], v[26:27]
    v_pk_mul_f32 v[92:93], v[92:93], v[26:27]
    v_pk_mul_f32 v[94:95], v[94:95], v[26:27]
    v_pk_mul_f32 v[96:97], v[96:97], v[26:27]
    v_pk_mul_f32 v[98:99], v[98:99], v[26:27]
    v_pk_mul_f32 v[100:101], v[100:101], v[26:27]
    v_pk_mul_f32 v[102:103], v[102:103], v[26:27]
    v_pk_mul_f32 v[104:105], v[104:105], v[26:27]
    v_pk_mul_f32 v[106:107], v[106:107], v[26:27]
    v_pk_mul_f32 v[108:109], v[108:109], v[26:27]
    v_pk_mul_f32 v[110:111], v[110:111], v[26:27]
    v_pk_mul_f32 v[112:113], v[112:113], v[26:27]
    v_pk_mul_f32 v[114:115], v[114:115], v[26:27]
    v_pk_mul_f32 v[116:117], v[116:117], v[26:27]
    v_pk_mul_f32 v[118:119], v[118:119], v[26:27]
    v_pk_mul_f32 v[120:121], v[120:121], v[26:27]
    v_pk_mul_f32 v[122:123], v[122:123], v[26:27]
    v_pk_mul_f32 v[124:125], v[124:125], v[26:27]
    v_pk_mul_f32 v[126:127], v[126:127], v[26:27]
L_noresc_355:
    v_sub_f32 v28, 0, v20
    s_waitcnt lgkmcnt(7)
    v_mfma_f32_32x32x16_bf16 v[128:143], v[44:47], v[212:215], v[128:143]
    ds_read_b128 v[44:47], v8 offset:5120
    v_fma_f32 v160, v160, s35, v28
    v_fma_f32 v161, v161, s35, v28
    v_fma_f32 v162, v162, s35, v28
    v_fma_f32 v163, v163, s35, v28
    v_exp_f32 v160, v160
    v_exp_f32 v161, v161
    v_fma_f32 v164, v164, s35, v28
    v_fma_f32 v165, v165, s35, v28
    v_exp_f32 v162, v162
    s_waitcnt lgkmcnt(7)
    v_mfma_f32_32x32x16_bf16 v[144:159], v[48:51], v[212:215], v[144:159]
    ds_read_b128 v[48:51], v8 offset:13312
    v_exp_f32 v163, v163
    v_add_f32 v21, v21, v160
    v_mov_b32 v29, v161
    v_cvt_pk_bf16_f32 v192, v160, v161
    v_fma_f32 v166, v166, s35, v28
    v_fma_f32 v167, v167, s35, v28
    v_exp_f32 v164, v164
    v_exp_f32 v165, v165
    v_add_f32 v21, v21, v162
    s_waitcnt lgkmcnt(7)
    v_mfma_f32_32x32x16_bf16 v[128:143], v[52:55], v[216:219], v[128:143]
    ds_read_b128 v[52:55], v8 offset:6144
    v_add_f32 v29, v29, v163
    v_cvt_pk_bf16_f32 v193, v162, v163
    v_fma_f32 v168, v168, s35, v28
    v_fma_f32 v169, v169, s35, v28
    v_exp_f32 v166, v166
    v_exp_f32 v167, v167
    v_add_f32 v21, v21, v164
    v_add_f32 v29, v29, v165
    v_cvt_pk_bf16_f32 v194, v164, v165
    s_waitcnt lgkmcnt(7)
    v_mfma_f32_32x32x16_bf16 v[144:159], v[56:59], v[216:219], v[144:159]
    ds_read_b128 v[56:59], v8 offset:14336
    v_fma_f32 v170, v170, s35, v28
    v_fma_f32 v171, v171, s35, v28
    v_exp_f32 v168, v168
    v_exp_f32 v169, v169
    v_add_f32 v21, v21, v166
    v_add_f32 v29, v29, v167
    v_cvt_pk_bf16_f32 v195, v166, v167
    v_fma_f32 v172, v172, s35, v28
    v_fma_f32 v173, v173, s35, v28
    s_waitcnt lgkmcnt(7)
    v_mfma_f32_32x32x16_bf16 v[128:143], v[60:63], v[220:223], v[128:143]
    ds_read_b128 v[60:63], v8 offset:7168
    v_exp_f32 v170, v170
    v_exp_f32 v171, v171
    v_add_f32 v21, v21, v168
    v_add_f32 v29, v29, v169
    v_cvt_pk_bf16_f32 v196, v168, v169
    v_fma_f32 v174, v174, s35, v28
    v_fma_f32 v175, v175, s35, v28
    v_exp_f32 v172, v172
    v_exp_f32 v173, v173
    s_waitcnt lgkmcnt(7)
    v_mfma_f32_32x32x16_bf16 v[144:159], v[240:243], v[220:223], v[144:159]
    ds_read_b128 v[240:243], v8 offset:15360
    v_add_f32 v21, v21, v170
    v_add_f32 v29, v29, v171
    v_cvt_pk_bf16_f32 v197, v170, v171
    v_fma_f32 v176, v176, s35, v28
    v_fma_f32 v177, v177, s35, v28
    v_exp_f32 v174, v174
    v_exp_f32 v175, v175
    v_add_f32 v21, v21, v172
    v_add_f32 v29, v29, v173
    s_waitcnt lgkmcnt(7)
    v_mfma_f32_32x32x16_bf16 v[128:143], v[36:39], v[224:227], v[128:143]
    v_cvt_pk_bf16_f32 v198, v172, v173
    v_fma_f32 v178, v178, s35, v28
    v_fma_f32 v179, v179, s35, v28
    v_exp_f32 v176, v176
    v_exp_f32 v177, v177
    v_add_f32 v21, v21, v174
    v_add_f32 v29, v29, v175
    v_cvt_pk_bf16_f32 v199, v174, v175
    v_fma_f32 v180, v180, s35, v28
    s_waitcnt lgkmcnt(6)
    v_mfma_f32_32x32x16_bf16 v[144:159], v[40:43], v[224:227], v[144:159]
    v_fma_f32 v181, v181, s35, v28
    v_exp_f32 v178, v178
    v_exp_f32 v179, v179
    v_add_f32 v21, v21, v176
    v_add_f32 v29, v29, v177
    v_cvt_pk_bf16_f32 v200, v176, v177
    v_fma_f32 v182, v182, s35, v28
    v_fma_f32 v183, v183, s35, v28
    v_exp_f32 v180, v180
    s_waitcnt lgkmcnt(5)
    v_mfma_f32_32x32x16_bf16 v[128:143], v[44:47], v[228:231], v[128:143]
    v_exp_f32 v181, v181
    v_add_f32 v21, v21, v178
    v_add_f32 v29, v29, v179
    v_cvt_pk_bf16_f32 v201, v178, v179
    v_fma_f32 v184, v184, s35, v28
    v_fma_f32 v185, v185, s35, v28
    v_exp_f32 v182, v182
    v_exp_f32 v183, v183
    v_add_f32 v21, v21, v180
    s_waitcnt lgkmcnt(4)
    v_mfma_f32_32x32x16_bf16 v[144:159], v[48:51], v[228:231], v[144:159]
    v_add_f32 v29, v29, v181
    v_cvt_pk_bf16_f32 v202, v180, v181
    v_fma_f32 v186, v186, s35, v28
    v_fma_f32 v187, v187, s35, v28
    v_exp_f32 v184, v184
    v_exp_f32 v185, v185
    v_add_f32 v21, v21, v182
    v_add_f32 v29, v29, v183
    v_cvt_pk_bf16_f32 v203, v182, v183
    s_waitcnt lgkmcnt(3)
    v_mfma_f32_32x32x16_bf16 v[128:143], v[52:55], v[232:235], v[128:143]
    v_fma_f32 v188, v188, s35, v28
    v_fma_f32 v189, v189, s35, v28
    v_exp_f32 v186, v186
    v_exp_f32 v187, v187
    v_add_f32 v21, v21, v184
    v_add_f32 v29, v29, v185
    v_cvt_pk_bf16_f32 v204, v184, v185
    v_fma_f32 v190, v190, s35, v28
    v_fma_f32 v191, v191, s35, v28
    s_waitcnt lgkmcnt(2)
    v_mfma_f32_32x32x16_bf16 v[144:159], v[56:59], v[232:235], v[144:159]
    v_exp_f32 v188, v188
    v_exp_f32 v189, v189
    v_add_f32 v21, v21, v186
    v_add_f32 v29, v29, v187
    v_cvt_pk_bf16_f32 v205, v186, v187
    v_exp_f32 v190, v190
    v_exp_f32 v191, v191
    v_add_f32 v21, v21, v188
    v_add_f32 v29, v29, v189
    s_waitcnt lgkmcnt(1)
    v_mfma_f32_32x32x16_bf16 v[128:143], v[60:63], v[236:239], v[128:143]
    v_cvt_pk_bf16_f32 v206, v188, v189
    s_nop 0
    v_add_f32 v21, v21, v190
    v_add_f32 v29, v29, v191
    v_cvt_pk_bf16_f32 v207, v190, v191
    v_add_f32 v21, v21, v29
    s_waitcnt lgkmcnt(0)
    v_mfma_f32_32x32x16_bf16 v[144:159], v[240:243], v[236:239], v[144:159]
    s_add_u32 s31, s31, 1
    s_branch L_k2_g1loop
L_k2_g1tail0:
    s_add_u32 m0, s34, 65536
    s_nop 0
    buffer_load_dwordx4 v23, s[12:15], s39 offen offset:0 lds
    s_add_u32 m0, s34, 65536
    s_nop 0
    buffer_load_dwordx4 v23, s[12:15], s39 offen offset:1024 lds
    s_add_u32 m0, s34, 65536
    s_nop 0
    buffer_load_dwordx4 v23, s[12:15], s39 offen offset:2048 lds
    s_add_u32 m0, s34, 65536
    s_nop 0
    buffer_load_dwordx4 v23, s[12:15], s39 offen offset:3072 lds
    s_cmp_lg_u32 s36, 0
    s_cbranch_scc1 L_k0pf_360
    s_add_u32 m0, s34, 0
    s_nop 0
    buffer_load_dwordx4 v23, s[8:11], 0 offen offset:0 lds
    buffer_load_dwordx4 v23, s[8:11], 0 offen offset:1024 lds
    buffer_load_dwordx4 v23, s[8:11], 0 offen offset:2048 lds
    buffer_load_dwordx4 v23, s[8:11], 0 offen offset:3072 lds
L_k0pf_360:
    s_cmp_eq_u32 s31, 0
    s_cbranch_scc1 L_k2_g1t0
    ds_read_b128 v[36:39], v16 offset:32768
    ds_read_b128 v[40:43], v16 offset:33792
    ds_read_b128 v[44:47], v16 offset:34816
    ds_read_b128 v[48:51], v16 offset:35840
    ds_read_b128 v[52:55], v16 offset:36864
    ds_read_b128 v[56:59], v16 offset:37888
    ds_read_b128 v[60:63], v16 offset:38912
    ds_read_b128 v[240:243], v16 offset:39936
    s_waitcnt lgkmcnt(7)
    v_mfma_f32_32x32x16_bf16 v[64:79], v[36:39], v[192:195], v[64:79]
    ds_read_b128 v[36:39], v16 offset:40960
    s_waitcnt lgkmcnt(7)
    v_mfma_f32_32x32x16_bf16 v[80:95], v[40:43], v[192:195], v[80:95]
    ds_read_b128 v[40:43], v16 offset:41984
    s_waitcnt lgkmcnt(7)
    v_mfma_f32_32x32x16_bf16 v[96:111], v[44:47], v[192:195], v[96:111]
    ds_read_b128 v[44:47], v16 offset:43008
    s_waitcnt lgkmcnt(7)
    v_mfma_f32_32x32x16_bf16 v[112:127], v[48:51], v[192:195], v[112:127]
    ds_read_b128 v[48:51], v16 offset:44032
    s_waitcnt lgkmcnt(7)
    v_mfma_f32_32x32x16_bf16 v[64:79], v[52:55], v[196:199], v[64:79]
    ds_read_b128 v[52:55], v16 offset:45056
    s_waitcnt lgkmcnt(7)
    v_mfma_f32_32x32x16_bf16 v[80:95], v[56:59], v[196:199], v[80:95]
    ds_read_b128 v[56:59], v16 offset:46080
    s_waitcnt lgkmcnt(7)
    v_mfma_f32_32x32x16_bf16 v[96:111], v[60:63], v[196:199], v[96:111]
    ds_read_b128 v[60:63], v16 offset:47104
    s_waitcnt lgkmcnt(7)
    v_mfma_f32_32x32x16_bf16 v[112:127], v[240:243], v[196:199], v[112:127]
    ds_read_b128 v[240:243], v16 offset:48128
    s_waitcnt lgkmcnt(7)
    v_mfma_f32_32x32x16_bf16 v[64:79], v[36:39], v[200:203], v[64:79]
    s_waitcnt lgkmcnt(6)
    v_mfma_f32_32x32x16_bf16 v[80:95], v[40:43], v[200:203], v[80:95]
    s_waitcnt lgkmcnt(5)
    v_mfma_f32_32x32x16_bf16 v[96:111], v[44:47], v[200:203], v[96:111]
    s_waitcnt lgkmcnt(4)
    v_mfma_f32_32x32x16_bf16 v[112:127], v[48:51], v[200:203], v[112:127]
    s_waitcnt lgkmcnt(3)
    v_mfma_f32_32x32x16_bf16 v[64:79], v[52:55], v[204:207], v[64:79]
    s_waitcnt lgkmcnt(2)
    v_mfma_f32_32x32x16_bf16 v[80:95], v[56:59], v[204:207], v[80:95]
    s_waitcnt lgkmcnt(1)
    v_mfma_f32_32x32x16_bf16 v[96:111], v[60:63], v[204:207], v[96:111]
    s_waitcnt lgkmcnt(0)
    v_mfma_f32_32x32x16_bf16 v[112:127], v[240:243], v[204:207], v[112:127]
L_k2_g1t0:
    s_nop 7
    v_mov_b32 v24, 0xf149f2ca
    v_cmp_gt_i32 vcc, 0, v22
    s_nop 1
    v_cndmask_b32 v128, v128, v24, vcc
    v_cmp_gt_i32 vcc, 1, v22
    s_nop 1
    v_cndmask_b32 v129, v129, v24, vcc
    v_cmp_gt_i32 vcc, 2, v22
    s_nop 1
    v_cndmask_b32 v130, v130, v24, vcc
    v_cmp_gt_i32 vcc, 3, v22
    s_nop 1
    v_cndmask_b32 v131, v131, v24, vcc
    v_cmp_gt_i32 vcc, 8, v22
    s_nop 1
    v_cndmask_b32 v132, v132, v24, vcc
    v_cmp_gt_i32 vcc, 9, v22
    s_nop 1
    v_cndmask_b32 v133, v133, v24, vcc
    v_cmp_gt_i32 vcc, 10, v22
    s_nop 1
    v_cndmask_b32 v134, v134, v24, vcc
    v_cmp_gt_i32 vcc, 11, v22
    s_nop 1
    v_cndmask_b32 v135, v135, v24, vcc
    v_cmp_gt_i32 vcc, 16, v22
    s_nop 1
    v_cndmask_b32 v136, v136, v24, vcc
    v_cmp_gt_i32 vcc, 17, v22
    s_nop 1
    v_cndmask_b32 v137, v137, v24, vcc
    v_cmp_gt_i32 vcc, 18, v22
    s_nop 1
    v_cndmask_b32 v138, v138, v24, vcc
    v_cmp_gt_i32 vcc, 19, v22
    s_nop 1
    v_cndmask_b32 v139, v139, v24, vcc
    v_cmp_gt_i32 vcc, 24, v22
    s_nop 1
    v_cndmask_b32 v140, v140, v24, vcc
    v_cmp_gt_i32 vcc, 25, v22
    s_nop 1
    v_cndmask_b32 v141, v141, v24, vcc
    v_cmp_gt_i32 vcc, 26, v22
    s_nop 1
    v_cndmask_b32 v142, v142, v24, vcc
    v_cmp_gt_i32 vcc, 27, v22
    s_nop 1
    v_cndmask_b32 v143, v143, v24, vcc
    v_cmp_gt_i32 vcc, 32, v22
    s_nop 1
    v_cndmask_b32 v144, v144, v24, vcc
    v_cmp_gt_i32 vcc, 33, v22
    s_nop 1
    v_cndmask_b32 v145, v145, v24, vcc
    v_cmp_gt_i32 vcc, 34, v22
    s_nop 1
    v_cndmask_b32 v146, v146, v24, vcc
    v_cmp_gt_i32 vcc, 35, v22
    s_nop 1
    v_cndmask_b32 v147, v147, v24, vcc
    v_cmp_gt_i32 vcc, 40, v22
    s_nop 1
    v_cndmask_b32 v148, v148, v24, vcc
    v_cmp_gt_i32 vcc, 41, v22
    s_nop 1
    v_cndmask_b32 v149, v149, v24, vcc
    v_cmp_gt_i32 vcc, 42, v22
    s_nop 1
    v_cndmask_b32 v150, v150, v24, vcc
    v_cmp_gt_i32 vcc, 43, v22
    s_nop 1
    v_cndmask_b32 v151, v151, v24, vcc
    v_cmp_gt_i32 vcc, 48, v22
    s_nop 1
    v_cndmask_b32 v152, v152, v24, vcc
    v_cmp_gt_i32 vcc, 49, v22
    s_nop 1
    v_cndmask_b32 v153, v153, v24, vcc
    v_cmp_gt_i32 vcc, 50, v22
    s_nop 1
    v_cndmask_b32 v154, v154, v24, vcc
    v_cmp_gt_i32 vcc, 51, v22
    s_nop 1
    v_cndmask_b32 v155, v155, v24, vcc
    v_cmp_gt_i32 vcc, 56, v22
    s_nop 1
    v_cndmask_b32 v156, v156, v24, vcc
    v_cmp_gt_i32 vcc, 57, v22
    s_nop 1
    v_cndmask_b32 v157, v157, v24, vcc
    v_cmp_gt_i32 vcc, 58, v22
    s_nop 1
    v_cndmask_b32 v158, v158, v24, vcc
    v_cmp_gt_i32 vcc, 59, v22
    s_nop 1
    v_cndmask_b32 v159, v159, v24, vcc
    v_max3_f32 v24, v128, v129, v130
    v_max3_f32 v25, v144, v145, v146
    v_max3_f32 v24, v24, v131, v132
    v_max3_f32 v25, v25, v147, v148
    v_max3_f32 v24, v24, v133, v134
    v_max3_f32 v25, v25, v149, v150
    v_max3_f32 v24, v24, v135, v136
    v_max3_f32 v25, v25, v151, v152
    v_max3_f32 v24, v24, v137, v138
    v_max3_f32 v25, v25, v153, v154
    v_max3_f32 v24, v24, v139, v140
    v_max3_f32 v25, v25, v155, v156
    v_max3_f32 v24, v24, v141, v142
    v_max3_f32 v25, v25, v157, v158
    v_max3_f32 v24, v24, v143, v25
    v_max_f32 v24, v24, v159
    v_mov_b32 v25, v24
    s_nop 1
    v_permlane32_swap_b32 v24, v25
    s_nop 1
    v_max_f32 v24, v24, v25
    v_mul_f32 v24, s35, v24
    v_max_f32 v25, v20, v24
    v_sub_f32 v26, v25, v20
    v_cmp_lt_f32 vcc, 0x41000000, v26
    s_cbranch_vccz L_noresc_361
    v_sub_f32 v26, 0, v26
    v_exp_f32 v26, v26
    v_mov_b32 v20, v25
    s_nop 0
    v_mov_b32 v27, v26
    v_mul_f32 v21, v21, v26
    v_pk_mul_f32 v[64:65], v[64:65], v[26:27]
    v_pk_mul_f32 v[66:67], v[66:67], v[26:27]
    v_pk_mul_f32 v[68:69], v[68:69], v[26:27]
    v_pk_mul_f32 v[70:71], v[70:71], v[26:27]
    v_pk_mul_f32 v[72:73], v[72:73], v[26:27]
    v_pk_mul_f32 v[74:75], v[74:75], v[26:27]
    v_pk_mul_f32 v[76:77], v[76:77], v[26:27]
    v_pk_mul_f32 v[78:79], v[78:79], v[26:27]
    v_pk_mul_f32 v[80:81], v[80:81], v[26:27]
    v_pk_mul_f32 v[82:83], v[82:83], v[26:27]
    v_pk_mul_f32 v[84:85], v[84:85], v[26:27]
    v_pk_mul_f32 v[86:87], v[86:87], v[26:27]
    v_pk_mul_f32 v[88:89], v[88:89], v[26:27]
    v_pk_mul_f32 v[90:91], v[90:91], v[26:27]
    v_pk_mul_f32 v[92:93], v[92:93], v[26:27]
    v_pk_mul_f32 v[94:95], v[94:95], v[26:27]
    v_pk_mul_f32 v[96:97], v[96:97], v[26:27]
    v_pk_mul_f32 v[98:99], v[98:99], v[26:27]
    v_pk_mul_f32 v[100:101], v[100:101], v[26:27]
    v_pk_mul_f32 v[102:103], v[102:103], v[26:27]
    v_pk_mul_f32 v[104:105], v[104:105], v[26:27]
    v_pk_mul_f32 v[106:107], v[106:107], v[26:27]
    v_pk_mul_f32 v[108:109], v[108:109], v[26:27]
    v_pk_mul_f32 v[110:111], v[110:111], v[26:27]
    v_pk_mul_f32 v[112:113], v[112:113], v[26:27]
    v_pk_mul_f32 v[114:115], v[114:115], v[26:27]
    v_pk_mul_f32 v[116:117], v[116:117], v[26:27]
    v_pk_mul_f32 v[118:119], v[118:119], v[26:27]
    v_pk_mul_f32 v[120:121], v[120:121], v[26:27]
    v_pk_mul_f32 v[122:123], v[122:123], v[26:27]
    v_pk_mul_f32 v[124:125], v[124:125], v[26:27]
    v_pk_mul_f32 v[126:127], v[126:127], v[26:27]
L_noresc_361:
    v_sub_f32 v28, 0, v20
    v_fma_f32 v128, v128, s35, v28
    v_fma_f32 v129, v129, s35, v28
    v_fma_f32 v130, v130, s35, v28
    v_fma_f32 v131, v131, s35, v28
    v_exp_f32 v128, v128
    v_exp_f32 v129, v129
    v_fma_f32 v132, v132, s35, v28
    v_fma_f32 v133, v133, s35, v28
    v_exp_f32 v130, v130
    v_exp_f32 v131, v131
    v_add_f32 v21, v21, v128
    v_mov_b32 v29, v129
    v_cvt_pk_bf16_f32 v192, v128, v129
    v_fma_f32 v134, v134, s35, v28
    v_fma_f32 v135, v135, s35, v28
    v_exp_f32 v132, v132
    v_exp_f32 v133, v133
    v_add_f32 v21, v21, v130
    v_add_f32 v29, v29, v131
    v_cvt_pk_bf16_f32 v193, v130, v131
    v_fma_f32 v136, v136, s35, v28
    v_fma_f32 v137, v137, s35, v28
    v_exp_f32 v134, v134
    v_exp_f32 v135, v135
    v_add_f32 v21, v21, v132
    v_add_f32 v29, v29, v133
    v_cvt_pk_bf16_f32 v194, v132, v133
    v_fma_f32 v138, v138, s35, v28
    v_fma_f32 v139, v139, s35, v28
    v_exp_f32 v136, v136
    v_exp_f32 v137, v137
    v_add_f32 v21, v21, v134
    v_add_f32 v29, v29, v135
    v_cvt_pk_bf16_f32 v195, v134, v135
    v_fma_f32 v140, v140, s35, v28
    v_fma_f32 v141, v141, s35, v28
    v_exp_f32 v138, v138
    v_exp_f32 v139, v139
    v_add_f32 v21, v21, v136
    v_add_f32 v29, v29, v137
    v_cvt_pk_bf16_f32 v196, v136, v137
    v_fma_f32 v142, v142, s35, v28
    v_fma_f32 v143, v143, s35, v28
    v_exp_f32 v140, v140
    v_exp_f32 v141, v141
    v_add_f32 v21, v21, v138
    v_add_f32 v29, v29, v139
    v_cvt_pk_bf16_f32 v197, v138, v139
    v_fma_f32 v144, v144, s35, v28
    v_fma_f32 v145, v145, s35, v28
    v_exp_f32 v142, v142
    v_exp_f32 v143, v143
    v_add_f32 v21, v21, v140
    v_add_f32 v29, v29, v141
    v_cvt_pk_bf16_f32 v198, v140, v141
    v_fma_f32 v146, v146, s35, v28
    v_fma_f32 v147, v147, s35, v28
    v_exp_f32 v144, v144
    v_exp_f32 v145, v145
    v_add_f32 v21, v21, v142
    v_add_f32 v29, v29, v143
    v_cvt_pk_bf16_f32 v199, v142, v143
    v_fma_f32 v148, v148, s35, v28
    v_fma_f32 v149, v149, s35, v28
    v_exp_f32 v146, v146
    v_exp_f32 v147, v147
    v_add_f32 v21, v21, v144
    v_add_f32 v29, v29, v145
    v_cvt_pk_bf16_f32 v200, v144, v145
    v_fma_f32 v150, v150, s35, v28
    v_fma_f32 v151, v151, s35, v28
    v_exp_f32 v148, v148
    v_exp_f32 v149, v149
    v_add_f32 v21, v21, v146
    v_add_f32 v29, v29, v147
    v_cvt_pk_bf16_f32 v201, v146, v147
    v_fma_f32 v152, v152, s35, v28
    v_fma_f32 v153, v153, s35, v28
    v_exp_f32 v150, v150
    v_exp_f32 v151, v151
    v_add_f32 v21, v21, v148
    v_add_f32 v29, v29, v149
    v_cvt_pk_bf16_f32 v202, v148, v149
    v_fma_f32 v154, v154, s35, v28
    v_fma_f32 v155, v155, s35, v28
    v_exp_f32 v152, v152
    v_exp_f32 v153, v153
    v_add_f32 v21, v21, v150
    v_add_f32 v29, v29, v151
    v_cvt_pk_bf16_f32 v203, v150, v151
    v_fma_f32 v156, v156, s35, v28
    v_fma_f32 v157, v157, s35, v28
    v_exp_f32 v154, v154
    v_exp_f32 v155, v155
    v_add_f32 v21, v21, v152
    v_add_f32 v29, v29, v153
    v_cvt_pk_bf16_f32 v204, v152, v153
    v_fma_f32 v158, v158, s35, v28
    v_fma_f32 v159, v159, s35, v28
    v_exp_f32 v156, v156
    v_exp_f32 v157, v157
    v_add_f32 v21, v21, v154
    v_add_f32 v29, v29, v155
    v_cvt_pk_bf16_f32 v205, v154, v155
    v_exp_f32 v158, v158
    v_exp_f32 v159, v159
    v_add_f32 v21, v21, v156
    v_add_f32 v29, v29, v157
    v_cvt_pk_bf16_f32 v206, v156, v157
    s_nop 0
    v_add_f32 v21, v21, v158
    v_add_f32 v29, v29, v159
    v_cvt_pk_bf16_f32 v207, v158, v159
    v_add_f32 v21, v21, v29
    s_waitcnt vmcnt(0)
    s_barrier
    ds_read_b128 v[36:39], v16 offset:0
    ds_read_b128 v[40:43], v16 offset:1024
    ds_read_b128 v[44:47], v16 offset:2048
    ds_read_b128 v[48:51], v16 offset:3072
    ds_read_b128 v[52:55], v16 offset:4096
    ds_read_b128 v[56:59], v16 offset:5120
    ds_read_b128 v[60:63], v16 offset:6144
    ds_read_b128 v[240:243], v16 offset:7168
    s_waitcnt lgkmcnt(7)
    v_mfma_f32_32x32x16_bf16 v[64:79], v[36:39], v[192:195], v[64:79]
    ds_read_b128 v[36:39], v16 offset:8192
    s_waitcnt lgkmcnt(7)
    v_mfma_f32_32x32x16_bf16 v[80:95], v[40:43], v[192:195], v[80:95]
    ds_read_b128 v[40:43], v16 offset:9216
    s_waitcnt lgkmcnt(7)
    v_mfma_f32_32x32x16_bf16 v[96:111], v[44:47], v[192:195], v[96:111]
    ds_read_b128 v[44:47], v16 offset:10240
    s_waitcnt lgkmcnt(7)
    v_mfma_f32_32x32x16_bf16 v[112:127], v[48:51], v[192:195], v[112:127]
    ds_read_b128 v[48:51], v16 offset:11264
    s_waitcnt lgkmcnt(7)
    v_mfma_f32_32x32x16_bf16 v[64:79], v[52:55], v[196:199], v[64:79]
    ds_read_b128 v[52:55], v16 offset:12288
    s_waitcnt lgkmcnt(7)
    v_mfma_f32_32x32x16_bf16 v[80:95], v[56:59], v[196:199], v[80:95]
    ds_read_b128 v[56:59], v16 offset:13312
    s_waitcnt lgkmcnt(7)
    v_mfma_f32_32x32x16_bf16 v[96:111], v[60:63], v[196:199], v[96:111]
    ds_read_b128 v[60:63], v16 offset:14336
    s_waitcnt lgkmcnt(7)
    v_mfma_f32_32x32x16_bf16 v[112:127], v[240:243], v[196:199], v[112:127]
    ds_read_b128 v[240:243], v16 offset:15360
    s_waitcnt lgkmcnt(7)
    v_mfma_f32_32x32x16_bf16 v[64:79], v[36:39], v[200:203], v[64:79]
    s_waitcnt lgkmcnt(6)
    v_mfma_f32_32x32x16_bf16 v[80:95], v[40:43], v[200:203], v[80:95]
    s_waitcnt lgkmcnt(5)
    v_mfma_f32_32x32x16_bf16 v[96:111], v[44:47], v[200:203], v[96:111]
    s_waitcnt lgkmcnt(4)
    v_mfma_f32_32x32x16_bf16 v[112:127], v[48:51], v[200:203], v[112:127]
    s_waitcnt lgkmcnt(3)
    v_mfma_f32_32x32x16_bf16 v[64:79], v[52:55], v[204:207], v[64:79]
    s_waitcnt lgkmcnt(2)
    v_mfma_f32_32x32x16_bf16 v[80:95], v[56:59], v[204:207], v[80:95]
    s_waitcnt lgkmcnt(1)
    v_mfma_f32_32x32x16_bf16 v[96:111], v[60:63], v[204:207], v[96:111]
    s_waitcnt lgkmcnt(0)
    v_mfma_f32_32x32x16_bf16 v[112:127], v[240:243], v[204:207], v[112:127]
    s_branch L_k2_merge
L_k2_g1tail1:
    s_add_u32 m0, s34, 98304
    s_nop 0
    buffer_load_dwordx4 v23, s[12:15], s39 offen offset:0 lds
    s_add_u32 m0, s34, 98304
    s_nop 0
    buffer_load_dwordx4 v23, s[12:15], s39 offen offset:1024 lds
    s_add_u32 m0, s34, 98304
    s_nop 0
    buffer_load_dwordx4 v23, s[12:15], s39 offen offset:2048 lds
    s_add_u32 m0, s34, 98304
    s_nop 0
    buffer_load_dwordx4 v23, s[12:15], s39 offen offset:3072 lds
    s_cmp_lg_u32 s36, 0
    s_cbranch_scc1 L_k0pf_362
    s_add_u32 m0, s34, 0
    s_nop 0
    buffer_load_dwordx4 v23, s[8:11], 0 offen offset:0 lds
    buffer_load_dwordx4 v23, s[8:11], 0 offen offset:1024 lds
    buffer_load_dwordx4 v23, s[8:11], 0 offen offset:2048 lds
    buffer_load_dwordx4 v23, s[8:11], 0 offen offset:3072 lds
L_k0pf_362:
    ds_read_b128 v[36:39], v16 offset:0
    ds_read_b128 v[40:43], v16 offset:1024
    ds_read_b128 v[44:47], v16 offset:2048
    ds_read_b128 v[48:51], v16 offset:3072
    ds_read_b128 v[52:55], v16 offset:4096
    ds_read_b128 v[56:59], v16 offset:5120
    ds_read_b128 v[60:63], v16 offset:6144
    ds_read_b128 v[240:243], v16 offset:7168
    s_waitcnt lgkmcnt(7)
    v_mfma_f32_32x32x16_bf16 v[64:79], v[36:39], v[192:195], v[64:79]
    ds_read_b128 v[36:39], v16 offset:8192
    s_waitcnt lgkmcnt(7)
    v_mfma_f32_32x32x16_bf16 v[80:95], v[40:43], v[192:195], v[80:95]
    ds_read_b128 v[40:43], v16 offset:9216
    s_waitcnt lgkmcnt(7)
    v_mfma_f32_32x32x16_bf16 v[96:111], v[44:47], v[192:195], v[96:111]
    ds_read_b128 v[44:47], v16 offset:10240
    s_waitcnt lgkmcnt(7)
    v_mfma_f32_32x32x16_bf16 v[112:127], v[48:51], v[192:195], v[112:127]
    ds_read_b128 v[48:51], v16 offset:11264
    s_waitcnt lgkmcnt(7)
    v_mfma_f32_32x32x16_bf16 v[64:79], v[52:55], v[196:199], v[64:79]
    ds_read_b128 v[52:55], v16 offset:12288
    s_waitcnt lgkmcnt(7)
    v_mfma_f32_32x32x16_bf16 v[80:95], v[56:59], v[196:199], v[80:95]
    ds_read_b128 v[56:59], v16 offset:13312
    s_waitcnt lgkmcnt(7)
    v_mfma_f32_32x32x16_bf16 v[96:111], v[60:63], v[196:199], v[96:111]
    ds_read_b128 v[60:63], v16 offset:14336
    s_waitcnt lgkmcnt(7)
    v_mfma_f32_32x32x16_bf16 v[112:127], v[240:243], v[196:199], v[112:127]
    ds_read_b128 v[240:243], v16 offset:15360
    s_waitcnt lgkmcnt(7)
    v_mfma_f32_32x32x16_bf16 v[64:79], v[36:39], v[200:203], v[64:79]
    s_waitcnt lgkmcnt(6)
    v_mfma_f32_32x32x16_bf16 v[80:95], v[40:43], v[200:203], v[80:95]
    s_waitcnt lgkmcnt(5)
    v_mfma_f32_32x32x16_bf16 v[96:111], v[44:47], v[200:203], v[96:111]
    s_waitcnt lgkmcnt(4)
    v_mfma_f32_32x32x16_bf16 v[112:127], v[48:51], v[200:203], v[112:127]
    s_waitcnt lgkmcnt(3)
    v_mfma_f32_32x32x16_bf16 v[64:79], v[52:55], v[204:207], v[64:79]
    s_waitcnt lgkmcnt(2)
    v_mfma_f32_32x32x16_bf16 v[80:95], v[56:59], v[204:207], v[80:95]
    s_waitcnt lgkmcnt(1)
    v_mfma_f32_32x32x16_bf16 v[96:111], v[60:63], v[204:207], v[96:111]
    s_waitcnt lgkmcnt(0)
    v_mfma_f32_32x32x16_bf16 v[112:127], v[240:243], v[204:207], v[112:127]
    s_nop 7
    v_mov_b32 v24, 0xf149f2ca
    v_cmp_gt_i32 vcc, 0, v22
    s_nop 1
    v_cndmask_b32 v160, v160, v24, vcc
    v_cmp_gt_i32 vcc, 1, v22
    s_nop 1
    v_cndmask_b32 v161, v161, v24, vcc
    v_cmp_gt_i32 vcc, 2, v22
    s_nop 1
    v_cndmask_b32 v162, v162, v24, vcc
    v_cmp_gt_i32 vcc, 3, v22
    s_nop 1
    v_cndmask_b32 v163, v163, v24, vcc
    v_cmp_gt_i32 vcc, 8, v22
    s_nop 1
    v_cndmask_b32 v164, v164, v24, vcc
    v_cmp_gt_i32 vcc, 9, v22
    s_nop 1
    v_cndmask_b32 v165, v165, v24, vcc
    v_cmp_gt_i32 vcc, 10, v22
    s_nop 1
    v_cndmask_b32 v166, v166, v24, vcc
    v_cmp_gt_i32 vcc, 11, v22
    s_nop 1
    v_cndmask_b32 v167, v167, v24, vcc
    v_cmp_gt_i32 vcc, 16, v22
    s_nop 1
    v_cndmask_b32 v168, v168, v24, vcc
    v_cmp_gt_i32 vcc, 17, v22
    s_nop 1
    v_cndmask_b32 v169, v169, v24, vcc
    v_cmp_gt_i32 vcc, 18, v22
    s_nop 1
    v_cndmask_b32 v170, v170, v24, vcc
    v_cmp_gt_i32 vcc, 19, v22
    s_nop 1
    v_cndmask_b32 v171, v171, v24, vcc
    v_cmp_gt_i32 vcc, 24, v22
    s_nop 1
    v_cndmask_b32 v172, v172, v24, vcc
    v_cmp_gt_i32 vcc, 25, v22
    s_nop 1
    v_cndmask_b32 v173, v173, v24, vcc
    v_cmp_gt_i32 vcc, 26, v22
    s_nop 1
    v_cndmask_b32 v174, v174, v24, vcc
    v_cmp_gt_i32 vcc, 27, v22
    s_nop 1
    v_cndmask_b32 v175, v175, v24, vcc
    v_cmp_gt_i32 vcc, 32, v22
    s_nop 1
    v_cndmask_b32 v176, v176, v24, vcc
    v_cmp_gt_i32 vcc, 33, v22
    s_nop 1
    v_cndmask_b32 v177, v177, v24, vcc
    v_cmp_gt_i32 vcc, 34, v22
    s_nop 1
    v_cndmask_b32 v178, v178, v24, vcc
    v_cmp_gt_i32 vcc, 35, v22
    s_nop 1
    v_cndmask_b32 v179, v179, v24, vcc
    v_cmp_gt_i32 vcc, 40, v22
    s_nop 1
    v_cndmask_b32 v180, v180, v24, vcc
    v_cmp_gt_i32 vcc, 41, v22
    s_nop 1
    v_cndmask_b32 v181, v181, v24, vcc
    v_cmp_gt_i32 vcc, 42, v22
    s_nop 1
    v_cndmask_b32 v182, v182, v24, vcc
    v_cmp_gt_i32 vcc, 43, v22
    s_nop 1
    v_cndmask_b32 v183, v183, v24, vcc
    v_cmp_gt_i32 vcc, 48, v22
    s_nop 1
    v_cndmask_b32 v184, v184, v24, vcc
    v_cmp_gt_i32 vcc, 49, v22
    s_nop 1
    v_cndmask_b32 v185, v185, v24, vcc
    v_cmp_gt_i32 vcc, 50, v22
    s_nop 1
    v_cndmask_b32 v186, v186, v24, vcc
    v_cmp_gt_i32 vcc, 51, v22
    s_nop 1
    v_cndmask_b32 v187, v187, v24, vcc
    v_cmp_gt_i32 vcc, 56, v22
    s_nop 1
    v_cndmask_b32 v188, v188, v24, vcc
    v_cmp_gt_i32 vcc, 57, v22
    s_nop 1
    v_cndmask_b32 v189, v189, v24, vcc
    v_cmp_gt_i32 vcc, 58, v22
    s_nop 1
    v_cndmask_b32 v190, v190, v24, vcc
    v_cmp_gt_i32 vcc, 59, v22
    s_nop 1
    v_cndmask_b32 v191, v191, v24, vcc
    v_max3_f32 v24, v160, v161, v162
    v_max3_f32 v25, v176, v177, v178
    v_max3_f32 v24, v24, v163, v164
    v_max3_f32 v25, v25, v179, v180
    v_max3_f32 v24, v24, v165, v166
    v_max3_f32 v25, v25, v181, v182
    v_max3_f32 v24, v24, v167, v168
    v_max3_f32 v25, v25, v183, v184
    v_max3_f32 v24, v24, v169, v170
    v_max3_f32 v25, v25, v185, v186
    v_max3_f32 v24, v24, v171, v172
    v_max3_f32 v25, v25, v187, v188
    v_max3_f32 v24, v24, v173, v174
    v_max3_f32 v25, v25, v189, v190
    v_max3_f32 v24, v24, v175, v25
    v_max_f32 v24, v24, v191
    v_mov_b32 v25, v24
    s_nop 1
    v_permlane32_swap_b32 v24, v25
    s_nop 1
    v_max_f32 v24, v24, v25
    v_mul_f32 v24, s35, v24
    v_max_f32 v25, v20, v24
    v_sub_f32 v26, v25, v20
    v_cmp_lt_f32 vcc, 0x41000000, v26
    s_cbranch_vccz L_noresc_363
    v_sub_f32 v26, 0, v26
    v_exp_f32 v26, v26
    v_mov_b32 v20, v25
    s_nop 0
    v_mov_b32 v27, v26
    v_mul_f32 v21, v21, v26
    v_pk_mul_f32 v[64:65], v[64:65], v[26:27]
    v_pk_mul_f32 v[66:67], v[66:67], v[26:27]
    v_pk_mul_f32 v[68:69], v[68:69], v[26:27]
    v_pk_mul_f32 v[70:71], v[70:71], v[26:27]
    v_pk_mul_f32 v[72:73], v[72:73], v[26:27]
    v_pk_mul_f32 v[74:75], v[74:75], v[26:27]
    v_pk_mul_f32 v[76:77], v[76:77], v[26:27]
    v_pk_mul_f32 v[78:79], v[78:79], v[26:27]
    v_pk_mul_f32 v[80:81], v[80:81], v[26:27]
    v_pk_mul_f32 v[82:83], v[82:83], v[26:27]
    v_pk_mul_f32 v[84:85], v[84:85], v[26:27]
    v_pk_mul_f32 v[86:87], v[86:87], v[26:27]
    v_pk_mul_f32 v[88:89], v[88:89], v[26:27]
    v_pk_mul_f32 v[90:91], v[90:91], v[26:27]
    v_pk_mul_f32 v[92:93], v[92:93], v[26:27]
    v_pk_mul_f32 v[94:95], v[94:95], v[26:27]
    v_pk_mul_f32 v[96:97], v[96:97], v[26:27]
    v_pk_mul_f32 v[98:99], v[98:99], v[26:27]
    v_pk_mul_f32 v[100:101], v[100:101], v[26:27]
    v_pk_mul_f32 v[102:103], v[102:103], v[26:27]
    v_pk_mul_f32 v[104:105], v[104:105], v[26:27]
    v_pk_mul_f32 v[106:107], v[106:107], v[26:27]
    v_pk_mul_f32 v[108:109], v[108:109], v[26:27]
    v_pk_mul_f32 v[110:111], v[110:111], v[26:27]
    v_pk_mul_f32 v[112:113], v[112:113], v[26:27]
    v_pk_mul_f32 v[114:115], v[114:115], v[26:27]
    v_pk_mul_f32 v[116:117], v[116:117], v[26:27]
    v_pk_mul_f32 v[118:119], v[118:119], v[26:27]
    v_pk_mul_f32 v[120:121], v[120:121], v[26:27]
    v_pk_mul_f32 v[122:123], v[122:123], v[26:27]
    v_pk_mul_f32 v[124:125], v[124:125], v[26:27]
    v_pk_mul_f32 v[126:127], v[126:127], v[26:27]
L_noresc_363:
    v_sub_f32 v28, 0, v20
    v_fma_f32 v160, v160, s35, v28
    v_fma_f32 v161, v161, s35, v28
    v_fma_f32 v162, v162, s35, v28
    v_fma_f32 v163, v163, s35, v28
    v_exp_f32 v160, v160
    v_exp_f32 v161, v161
    v_fma_f32 v164, v164, s35, v28
    v_fma_f32 v165, v165, s35, v28
    v_exp_f32 v162, v162
    v_exp_f32 v163, v163
    v_add_f32 v21, v21, v160
    v_mov_b32 v29, v161
    v_cvt_pk_bf16_f32 v192, v160, v161
    v_fma_f32 v166, v166, s35, v28
    v_fma_f32 v167, v167, s35, v28
    v_exp_f32 v164, v164
    v_exp_f32 v165, v165
    v_add_f32 v21, v21, v162
    v_add_f32 v29, v29, v163
    v_cvt_pk_bf16_f32 v193, v162, v163
    v_fma_f32 v168, v168, s35, v28
    v_fma_f32 v169, v169, s35, v28
    v_exp_f32 v166, v166
    v_exp_f32 v167, v167
    v_add_f32 v21, v21, v164
    v_add_f32 v29, v29, v165
    v_cvt_pk_bf16_f32 v194, v164, v165
    v_fma_f32 v170, v170, s35, v28
    v_fma_f32 v171, v171, s35, v28
    v_exp_f32 v168, v168
    v_exp_f32 v169, v169
    v_add_f32 v21, v21, v166
    v_add_f32 v29, v29, v167
    v_cvt_pk_bf16_f32 v195, v166, v167
    v_fma_f32 v172, v172, s35, v28
    v_fma_f32 v173, v173, s35, v28
    v_exp_f32 v170, v170
    v_exp_f32 v171, v171
    v_add_f32 v21, v21, v168
    v_add_f32 v29, v29, v169
    v_cvt_pk_bf16_f32 v196, v168, v169
    v_fma_f32 v174, v174, s35, v28
    v_fma_f32 v175, v175, s35, v28
    v_exp_f32 v172, v172
    v_exp_f32 v173, v173
    v_add_f32 v21, v21, v170
    v_add_f32 v29, v29, v171
    v_cvt_pk_bf16_f32 v197, v170, v171
    v_fma_f32 v176, v176, s35, v28
    v_fma_f32 v177, v177, s35, v28
    v_exp_f32 v174, v174
    v_exp_f32 v175, v175
    v_add_f32 v21, v21, v172
    v_add_f32 v29, v29, v173
    v_cvt_pk_bf16_f32 v198, v172, v173
    v_fma_f32 v178, v178, s35, v28
    v_fma_f32 v179, v179, s35, v28
    v_exp_f32 v176, v176
    v_exp_f32 v177, v177
    v_add_f32 v21, v21, v174
    v_add_f32 v29, v29, v175
    v_cvt_pk_bf16_f32 v199, v174, v175
    v_fma_f32 v180, v180, s35, v28
    v_fma_f32 v181, v181, s35, v28
    v_exp_f32 v178, v178
    v_exp_f32 v179, v179
    v_add_f32 v21, v21, v176
    v_add_f32 v29, v29, v177
    v_cvt_pk_bf16_f32 v200, v176, v177
    v_fma_f32 v182, v182, s35, v28
    v_fma_f32 v183, v183, s35, v28
    v_exp_f32 v180, v180
    v_exp_f32 v181, v181
    v_add_f32 v21, v21, v178
    v_add_f32 v29, v29, v179
    v_cvt_pk_bf16_f32 v201, v178, v179
    v_fma_f32 v184, v184, s35, v28
    v_fma_f32 v185, v185, s35, v28
    v_exp_f32 v182, v182
    v_exp_f32 v183, v183
    v_add_f32 v21, v21, v180
    v_add_f32 v29, v29, v181
    v_cvt_pk_bf16_f32 v202, v180, v181
    v_fma_f32 v186, v186, s35, v28
    v_fma_f32 v187, v187, s35, v28
    v_exp_f32 v184, v184
    v_exp_f32 v185, v185
    v_add_f32 v21, v21, v182
    v_add_f32 v29, v29, v183
    v_cvt_pk_bf16_f32 v203, v182, v183
    v_fma_f32 v188, v188, s35, v28
    v_fma_f32 v189, v189, s35, v28
    v_exp_f32 v186, v186
    v_exp_f32 v187, v187
    v_add_f32 v21, v21, v184
    v_add_f32 v29, v29, v185
    v_cvt_pk_bf16_f32 v204, v184, v185
    v_fma_f32 v190, v190, s35, v28
    v_fma_f32 v191, v191, s35, v28
    v_exp_f32 v188, v188
    v_exp_f32 v189, v189
    v_add_f32 v21, v21, v186
    v_add_f32 v29, v29, v187
    v_cvt_pk_bf16_f32 v205, v186, v187
    v_exp_f32 v190, v190
    v_exp_f32 v191, v191
    v_add_f32 v21, v21, v188
    v_add_f32 v29, v29, v189
    v_cvt_pk_bf16_f32 v206, v188, v189
    s_nop 0
    v_add_f32 v21, v21, v190
    v_add_f32 v29, v29, v191
    v_cvt_pk_bf16_f32 v207, v190, v191
    v_add_f32 v21, v21, v29
    s_waitcnt vmcnt(0)
    s_barrier
    ds_read_b128 v[36:39], v16 offset:32768
    ds_read_b128 v[40:43], v16 offset:33792
    ds_read_b128 v[44:47], v16 offset:34816
    ds_read_b128 v[48:51], v16 offset:35840
    ds_read_b128 v[52:55], v16 offset:36864
    ds_read_b128 v[56:59], v16 offset:37888
    ds_read_b128 v[60:63], v16 offset:38912
    ds_read_b128 v[240:243], v16 offset:39936
    s_waitcnt lgkmcnt(7)
    v_mfma_f32_32x32x16_bf16 v[64:79], v[36:39], v[192:195], v[64:79]
    ds_read_b128 v[36:39], v16 offset:40960
    s_waitcnt lgkmcnt(7)
    v_mfma_f32_32x32x16_bf16 v[80:95], v[40:43], v[192:195], v[80:95]
    ds_read_b128 v[40:43], v16 offset:41984
    s_waitcnt lgkmcnt(7)
    v_mfma_f32_32x32x16_bf16 v[96:111], v[44:47], v[192:195], v[96:111]
    ds_read_b128 v[44:47], v16 offset:43008
    s_waitcnt lgkmcnt(7)
    v_mfma_f32_32x32x16_bf16 v[112:127], v[48:51], v[192:195], v[112:127]
    ds_read_b128 v[48:51], v16 offset:44032
    s_waitcnt lgkmcnt(7)
    v_mfma_f32_32x32x16_bf16 v[64:79], v[52:55], v[196:199], v[64:79]
    ds_read_b128 v[52:55], v16 offset:45056
    s_waitcnt lgkmcnt(7)
    v_mfma_f32_32x32x16_bf16 v[80:95], v[56:59], v[196:199], v[80:95]
    ds_read_b128 v[56:59], v16 offset:46080
    s_waitcnt lgkmcnt(7)
    v_mfma_f32_32x32x16_bf16 v[96:111], v[60:63], v[196:199], v[96:111]
    ds_read_b128 v[60:63], v16 offset:47104
    s_waitcnt lgkmcnt(7)
    v_mfma_f32_32x32x16_bf16 v[112:127], v[240:243], v[196:199], v[112:127]
    ds_read_b128 v[240:243], v16 offset:48128
    s_waitcnt lgkmcnt(7)
    v_mfma_f32_32x32x16_bf16 v[64:79], v[36:39], v[200:203], v[64:79]
    s_waitcnt lgkmcnt(6)
    v_mfma_f32_32x32x16_bf16 v[80:95], v[40:43], v[200:203], v[80:95]
    s_waitcnt lgkmcnt(5)
    v_mfma_f32_32x32x16_bf16 v[96:111], v[44:47], v[200:203], v[96:111]
    s_waitcnt lgkmcnt(4)
    v_mfma_f32_32x32x16_bf16 v[112:127], v[48:51], v[200:203], v[112:127]
    s_waitcnt lgkmcnt(3)
    v_mfma_f32_32x32x16_bf16 v[64:79], v[52:55], v[204:207], v[64:79]
    s_waitcnt lgkmcnt(2)
    v_mfma_f32_32x32x16_bf16 v[80:95], v[56:59], v[204:207], v[80:95]
    s_waitcnt lgkmcnt(1)
    v_mfma_f32_32x32x16_bf16 v[96:111], v[60:63], v[204:207], v[96:111]
    s_waitcnt lgkmcnt(0)
    v_mfma_f32_32x32x16_bf16 v[112:127], v[240:243], v[204:207], v[112:127]
L_k2_merge:
    s_nop 15
    v_mov_b32 v25, v21
    s_nop 1
    v_permlane32_swap_b32 v21, v25
    s_nop 1
    v_add_f32 v21, v21, v25
    s_lshl_b32 s3, s26, 13
    s_add_u32 s3, s3, 65536
    v_lshlrev_b32 v5, 4, v2
    v_add_u32 v5, s3, v5
    s_lshl_b32 s3, s26, 9
    v_lshlrev_b32 v6, 2, v2
    v_add_u32 v6, s3, v6
    s_xor_b32 s37, s26, 4
    s_barrier
    ds_write_b32 v6, v20 offset:32768
    ds_write_b32 v6, v21 offset:33024
    s_cmp_eq_u32 s27, 0
    s_cbranch_scc1 L_k2_m0

    ds_write_b128 v5, v[64:67] offset:0
    ds_write_b128 v5, v[68:71] offset:1024
    ds_write_b128 v5, v[72:75] offset:2048
    ds_write_b128 v5, v[76:79] offset:3072
    ds_write_b128 v5, v[80:83] offset:4096
    ds_write_b128 v5, v[84:87] offset:5120
    ds_write_b128 v5, v[88:91] offset:6144
    ds_write_b128 v5, v[92:95] offset:7168
    v_xor_b32 v5, 0x8000, v5
    v_xor_b32 v6, 0x800, v6
    s_waitcnt lgkmcnt(0)
    s_barrier
    ds_read_b32 v24, v6 offset:32768
    ds_read_b32 v25, v6 offset:33024

    ds_read_b128 v[128:131], v5 offset:0
    ds_read_b128 v[132:135], v5 offset:1024
    ds_read_b128 v[136:139], v5 offset:2048
    ds_read_b128 v[140:143], v5 offset:3072
    ds_read_b128 v[144:147], v5 offset:4096
    ds_read_b128 v[148:151], v5 offset:5120
    ds_read_b128 v[152:155], v5 offset:6144
    ds_read_b128 v[156:159], v5 offset:7168
    s_waitcnt lgkmcnt(8)
    v_max_f32 v26, v20, v24
    v_sub_f32 v27, v20, v26
    v_sub_f32 v28, v24, v26
    v_exp_f32 v27, v27
    v_exp_f32 v28, v28
    s_nop 0
    v_mul_f32 v29, v27, v21
    v_fma_f32 v29, v28, v25, v29
    v_rcp_f32 v29, v29
    s_nop 0
    v_mul_f32 v27, v27, v29
    v_mul_f32 v28, v28, v29
    s_lshl_b32 s3, s29, 2
    s_add_u32 s3, s3, s28
    s_mul_i32 s3, s3, 294912
    s_lshl_b32 s37, s24, 13
    s_add_u32 s3, s3, s37
    s_add_u32 s3, s3, 4096
    v_lshlrev_b32 v5, 4, v2
    s_waitcnt lgkmcnt(0)
    s_cmp_eq_u32 s36, 0
    s_cbranch_scc1 L_mw_364
    s_waitcnt vmcnt(0)
L_mw_364:

    v_mul_f32 v96, v27, v96
    v_fma_f32 v96, v28, v128, v96
    v_mul_f32 v97, v27, v97
    v_fma_f32 v97, v28, v129, v97
    v_mul_f32 v98, v27, v98
    v_fma_f32 v98, v28, v130, v98
    v_mul_f32 v99, v27, v99
    v_fma_f32 v99, v28, v131, v99
    v_mul_f32 v100, v27, v100
    v_fma_f32 v100, v28, v132, v100
    v_mul_f32 v101, v27, v101
    v_fma_f32 v101, v28, v133, v101
    v_mul_f32 v102, v27, v102
    v_fma_f32 v102, v28, v134, v102
    v_mul_f32 v103, v27, v103
    v_fma_f32 v103, v28, v135, v103
    v_mul_f32 v104, v27, v104
    v_fma_f32 v104, v28, v136, v104
    v_mul_f32 v105, v27, v105
    v_fma_f32 v105, v28, v137, v105
    v_mul_f32 v106, v27, v106
    v_fma_f32 v106, v28, v138, v106
    v_mul_f32 v107, v27, v107
    v_fma_f32 v107, v28, v139, v107
    v_mul_f32 v108, v27, v108
    v_fma_f32 v108, v28, v140, v108
    v_mul_f32 v109, v27, v109
    v_fma_f32 v109, v28, v141, v109
    v_mul_f32 v110, v27, v110
    v_fma_f32 v110, v28, v142, v110
    v_mul_f32 v111, v27, v111
    v_fma_f32 v111, v28, v143, v111
    v_mul_f32 v112, v27, v112
    v_fma_f32 v112, v28, v144, v112
    v_mul_f32 v113, v27, v113
    v_fma_f32 v113, v28, v145, v113
    v_mul_f32 v114, v27, v114
    v_fma_f32 v114, v28, v146, v114
    v_mul_f32 v115, v27, v115
    v_fma_f32 v115, v28, v147, v115
    v_mul_f32 v116, v27, v116
    v_fma_f32 v116, v28, v148, v116
    v_mul_f32 v117, v27, v117
    v_fma_f32 v117, v28, v149, v117
    v_mul_f32 v118, v27, v118
    v_fma_f32 v118, v28, v150, v118
    v_mul_f32 v119, v27, v119
    v_fma_f32 v119, v28, v151, v119
    v_mul_f32 v120, v27, v120
    v_fma_f32 v120, v28, v152, v120
    v_mul_f32 v121, v27, v121
    v_fma_f32 v121, v28, v153, v121
    v_mul_f32 v122, v27, v122
    v_fma_f32 v122, v28, v154, v122
    v_mul_f32 v123, v27, v123
    v_fma_f32 v123, v28, v155, v123
    v_mul_f32 v124, v27, v124
    v_fma_f32 v124, v28, v156, v124
    v_mul_f32 v125, v27, v125
    v_fma_f32 v125, v28, v157, v125
    v_mul_f32 v126, v27, v126
    v_fma_f32 v126, v28, v158, v126
    v_mul_f32 v127, v27, v127
    v_fma_f32 v127, v28, v159, v127
    v_cvt_pk_bf16_f32 v192, v96, v97
    v_cvt_pk_bf16_f32 v193, v98, v99
    v_cvt_pk_bf16_f32 v194, v100, v101
    v_cvt_pk_bf16_f32 v195, v102, v103
    buffer_store_dwordx4 v[192:195], v5, s[20:23], s3 offen offset:0
    v_cvt_pk_bf16_f32 v196, v104, v105
    v_cvt_pk_bf16_f32 v197, v106, v107
    v_cvt_pk_bf16_f32 v198, v108, v109
    v_cvt_pk_bf16_f32 v199, v110, v111
    buffer_store_dwordx4 v[196:199], v5, s[20:23], s3 offen offset:1024
    v_cvt_pk_bf16_f32 v200, v112, v113
    v_cvt_pk_bf16_f32 v201, v114, v115
    v_cvt_pk_bf16_f32 v202, v116, v117
    v_cvt_pk_bf16_f32 v203, v118, v119
    buffer_store_dwordx4 v[200:203], v5, s[20:23], s3 offen offset:2048
    v_cvt_pk_bf16_f32 v204, v120, v121
    v_cvt_pk_bf16_f32 v205, v122, v123
    v_cvt_pk_bf16_f32 v206, v124, v125
    v_cvt_pk_bf16_f32 v207, v126, v127
    buffer_store_dwordx4 v[204:207], v5, s[20:23], s3 offen offset:3072
    s_branch L_k2_mdone
L_k2_m0:
    ds_write_b128 v5, v[96:99] offset:0
    ds_write_b128 v5, v[100:103] offset:1024
    ds_write_b128 v5, v[104:107] offset:2048
    ds_write_b128 v5, v[108:111] offset:3072
    ds_write_b128 v5, v[112:115] offset:4096
    ds_write_b128 v5, v[116:119] offset:5120
    ds_write_b128 v5, v[120:123] offset:6144
    ds_write_b128 v5, v[124:127] offset:7168
    v_xor_b32 v5, 0x8000, v5
    v_xor_b32 v6, 0x800, v6
    s_waitcnt lgkmcnt(0)
    s_barrier
    ds_read_b32 v24, v6 offset:32768
    ds_read_b32 v25, v6 offset:33024

    ds_read_b128 v[128:131], v5 offset:0
    ds_read_b128 v[132:135], v5 offset:1024
    ds_read_b128 v[136:139], v5 offset:2048
    ds_read_b128 v[140:143], v5 offset:3072
    ds_read_b128 v[144:147], v5 offset:4096
    ds_read_b128 v[148:151], v5 offset:5120
    ds_read_b128 v[152:155], v5 offset:6144
    ds_read_b128 v[156:159], v5 offset:7168
    s_waitcnt lgkmcnt(8)
    v_max_f32 v26, v20, v24
    v_sub_f32 v27, v20, v26
    v_sub_f32 v28, v24, v26
    v_exp_f32 v27, v27
    v_exp_f32 v28, v28
    s_nop 0
    v_mul_f32 v29, v27, v21
    v_fma_f32 v29, v28, v25, v29
    v_rcp_f32 v29, v29
    s_nop 0
    v_mul_f32 v27, v27, v29
    v_mul_f32 v28, v28, v29
    s_lshl_b32 s3, s29, 2
    s_add_u32 s3, s3, s28
    s_mul_i32 s3, s3, 294912
    s_lshl_b32 s37, s24, 13
    s_add_u32 s3, s3, s37
    s_add_u32 s3, s3, 0
    v_lshlrev_b32 v5, 4, v2
    s_waitcnt lgkmcnt(0)
    s_cmp_eq_u32 s36, 0
    s_cbranch_scc1 L_mw_365
    s_waitcnt vmcnt(0)
L_mw_365:

    v_mul_f32 v64, v27, v64
    v_fma_f32 v64, v28, v128, v64
    v_mul_f32 v65, v27, v65
    v_fma_f32 v65, v28, v129, v65
    v_mul_f32 v66, v27, v66
    v_fma_f32 v66, v28, v130, v66
    v_mul_f32 v67, v27, v67
    v_fma_f32 v67, v28, v131, v67
    v_mul_f32 v68, v27, v68
    v_fma_f32 v68, v28, v132, v68
    v_mul_f32 v69, v27, v69
    v_fma_f32 v69, v28, v133, v69
    v_mul_f32 v70, v27, v70
    v_fma_f32 v70, v28, v134, v70
    v_mul_f32 v71, v27, v71
    v_fma_f32 v71, v28, v135, v71
    v_mul_f32 v72, v27, v72
    v_fma_f32 v72, v28, v136, v72
    v_mul_f32 v73, v27, v73
    v_fma_f32 v73, v28, v137, v73
    v_mul_f32 v74, v27, v74
    v_fma_f32 v74, v28, v138, v74
    v_mul_f32 v75, v27, v75
    v_fma_f32 v75, v28, v139, v75
    v_mul_f32 v76, v27, v76
    v_fma_f32 v76, v28, v140, v76
    v_mul_f32 v77, v27, v77
    v_fma_f32 v77, v28, v141, v77
    v_mul_f32 v78, v27, v78
    v_fma_f32 v78, v28, v142, v78
    v_mul_f32 v79, v27, v79
    v_fma_f32 v79, v28, v143, v79
    v_mul_f32 v80, v27, v80
    v_fma_f32 v80, v28, v144, v80
    v_mul_f32 v81, v27, v81
    v_fma_f32 v81, v28, v145, v81
    v_mul_f32 v82, v27, v82
    v_fma_f32 v82, v28, v146, v82
    v_mul_f32 v83, v27, v83
    v_fma_f32 v83, v28, v147, v83
    v_mul_f32 v84, v27, v84
    v_fma_f32 v84, v28, v148, v84
    v_mul_f32 v85, v27, v85
    v_fma_f32 v85, v28, v149, v85
    v_mul_f32 v86, v27, v86
    v_fma_f32 v86, v28, v150, v86
    v_mul_f32 v87, v27, v87
    v_fma_f32 v87, v28, v151, v87
    v_mul_f32 v88, v27, v88
    v_fma_f32 v88, v28, v152, v88
    v_mul_f32 v89, v27, v89
    v_fma_f32 v89, v28, v153, v89
    v_mul_f32 v90, v27, v90
    v_fma_f32 v90, v28, v154, v90
    v_mul_f32 v91, v27, v91
    v_fma_f32 v91, v28, v155, v91
    v_mul_f32 v92, v27, v92
    v_fma_f32 v92, v28, v156, v92
    v_mul_f32 v93, v27, v93
    v_fma_f32 v93, v28, v157, v93
    v_mul_f32 v94, v27, v94
    v_fma_f32 v94, v28, v158, v94
    v_mul_f32 v95, v27, v95
    v_fma_f32 v95, v28, v159, v95
    v_cvt_pk_bf16_f32 v192, v64, v65
    v_cvt_pk_bf16_f32 v193, v66, v67
    v_cvt_pk_bf16_f32 v194, v68, v69
    v_cvt_pk_bf16_f32 v195, v70, v71
    buffer_store_dwordx4 v[192:195], v5, s[20:23], s3 offen offset:0
    v_cvt_pk_bf16_f32 v196, v72, v73
    v_cvt_pk_bf16_f32 v197, v74, v75
    v_cvt_pk_bf16_f32 v198, v76, v77
    v_cvt_pk_bf16_f32 v199, v78, v79
    buffer_store_dwordx4 v[196:199], v5, s[20:23], s3 offen offset:1024
    v_cvt_pk_bf16_f32 v200, v80, v81
    v_cvt_pk_bf16_f32 v201, v82, v83
    v_cvt_pk_bf16_f32 v202, v84, v85
    v_cvt_pk_bf16_f32 v203, v86, v87
    buffer_store_dwordx4 v[200:203], v5, s[20:23], s3 offen offset:2048
    v_cvt_pk_bf16_f32 v204, v88, v89
    v_cvt_pk_bf16_f32 v205, v90, v91
    v_cvt_pk_bf16_f32 v206, v92, v93
    v_cvt_pk_bf16_f32 v207, v94, v95
    buffer_store_dwordx4 v[204:207], v5, s[20:23], s3 offen offset:3072
L_k2_mdone:
    s_barrier
    s_add_u32 s36, s36, 1
    s_cmp_lt_u32 s36, 2
    s_cbranch_scc1 L_k2_pass

L_k2_end:
    s_endpgm
.globl oproj_kernel
.p2align 8
.type oproj_kernel,@function
oproj_kernel:
    s_cmp_ge_u32 s2, 256
    s_cbranch_scc1 L_k4_end
    s_load_dwordx2 s[4:5], s[0:1], 104
    s_load_dwordx2 s[6:7], s[0:1], 40
    s_load_dwordx2 s[36:37], s[0:1], 72
    s_load_dwordx2 s[38:39], s[0:1], 88
    s_and_b32 s41, s2, 7
    s_lshl_b32 s41, s41, 2
    s_bfe_u32 s3, s2, 0x20003
    s_add_u32 s41, s41, s3
    s_lshr_b32 s40, s2, 5

    v_lshrrev_b32 v1, 6, v0
    s_nop 0
    v_readfirstlane_b32 s42, v1
    v_and_b32 v2, 63, v0
    s_waitcnt lgkmcnt(0)

    s_add_u32 s8, s4, 0x3000000
    s_addc_u32 s9, s5, 0
    s_mov_b32 s10, 0x1200000
    s_mov_b32 s11, 0x00020000
    s_mov_b32 s12, s6
    s_mov_b32 s13, s7
    s_mov_b32 s14, 0x400000
    s_mov_b32 s15, 0x00020000
    s_mov_b32 s16, s36
    s_mov_b32 s17, s37
    s_mov_b32 s18, 0x80000
    s_mov_b32 s19, 0x00020000
    s_mov_b32 s20, s38
    s_mov_b32 s21, s39
    s_mov_b32 s22, 0x200000
    s_mov_b32 s23, 0x00020000
    s_add_u32 s24, s4, 0x4e00000
    s_addc_u32 s25, s5, 0
    s_mov_b32 s26, 0x2000
    s_mov_b32 s27, 0x00020000
    s_lshl_b32 s46, s41, 1
    s_lshr_b32 s47, s42, 1
    s_add_u32 s46, s46, s47
    s_mul_i32 s46, s46, 294912
    s_and_b32 s47, s42, 1
    s_lshl_b32 s47, s47, 12
    s_add_u32 s46, s46, s47
    v_lshlrev_b32 v5, 4, v2
    v_add_u32 v8, s46, v5

    v_and_b32 v5, 7, v2
    v_bfe_u32 v6, v2, 4, 1
    v_lshlrev_b32 v6, 2, v6
    v_xor_b32 v5, v5, v6
    v_lshlrev_b32 v5, 4, v5
    s_lshl_b32 s46, s40, 7
    v_add_u32 v5, s46, v5
    v_lshrrev_b32 v6, 3, v2
    s_lshl_b32 s46, s42, 5
    v_add_u32 v6, s46, v6

    v_add_u32 v7, 0, v6
    v_lshl_add_u32 v12, v7, 10, v5
    v_add_u32 v7, 8, v6
    v_lshl_add_u32 v13, v7, 10, v5
    v_add_u32 v7, 16, v6
    v_lshl_add_u32 v14, v7, 10, v5
    v_add_u32 v7, 24, v6
    v_lshl_add_u32 v15, v7, 10, v5
    s_lshr_b32 s48, s42, 1
    s_and_b32 s49, s42, 1
    v_and_b32 v3, 31, v2
    v_lshrrev_b32 v4, 5, v2
    s_lshl_b32 s46, s48, 13
    v_lshlrev_b32 v5, 4, v2
    v_add_u32 v16, s46, v5

    v_bfe_u32 v5, v2, 2, 2
    v_lshrrev_b32 v6, 1, v5
    v_xor_b32 v6, s49, v6
    v_lshlrev_b32 v6, 6, v6
    v_and_b32 v7, 3, v2
    v_lshl_add_u32 v6, v7, 3, v6
    v_bfe_u32 v7, v2, 4, 1
    v_lshl_add_u32 v6, v7, 5, v6
    v_add_u32 v6, 16384, v6
    v_lshl_add_u32 v7, v4, 2, v5
    v_lshl_add_u32 v24, v7, 7, v6
    v_lshl_add_u32 v7, v4, 3, v5
    v_lshl_add_u32 v25, v7, 7, v6
    s_mov_b32 s50, 0
    s_mov_b32 s51, 0
    s_lshl_b32 s53, s42, 12

    v_add_u32 v34, 0x10000, v16
    v_add_u32 v52, 0x20000, v16
    v_add_u32 v35, 0x10000, v17
    v_add_u32 v53, 0x20000, v17
    v_add_u32 v36, 0x10000, v18
    v_add_u32 v54, 0x20000, v18
    v_add_u32 v37, 0x10000, v19
    v_add_u32 v55, 0x20000, v19
    v_add_u32 v38, 0x10000, v20
    v_add_u32 v56, 0x20000, v20
    v_add_u32 v39, 0x10000, v21
    v_add_u32 v57, 0x20000, v21
    v_add_u32 v40, 0x10000, v22
    v_add_u32 v58, 0x20000, v22
    v_add_u32 v41, 0x10000, v23
    v_add_u32 v59, 0x20000, v23
    v_add_u32 v42, 0x10000, v24
    v_add_u32 v60, 0x20000, v24
    v_add_u32 v43, 0x10000, v25
    v_add_u32 v61, 0x20000, v25
    s_lshl_b32 s46, s41, 6
    s_lshl_b32 s47, s48, 5
    s_add_u32 s46, s46, s47
    v_add_u32 v5, s46, v3
    v_lshlrev_b32 v6, 2, v5
    buffer_load_dword v62, v6, s[24:27], 0 offen

    s_add_u32 m0, s53, 0
    s_nop 0
    buffer_load_dwordx4 v8, s[8:11], s50 offen offset:0 lds
    buffer_load_dwordx4 v8, s[8:11], s50 offen offset:1024 lds
    buffer_load_dwordx4 v8, s[8:11], s50 offen offset:2048 lds
    buffer_load_dwordx4 v8, s[8:11], s50 offen offset:3072 lds
    s_add_u32 m0, s53, 16384
    s_nop 0
    buffer_load_dwordx4 v12, s[12:15], s51 offen lds
    s_add_u32 m0, s53, 17408
    s_nop 0
    buffer_load_dwordx4 v13, s[12:15], s51 offen lds
    s_add_u32 m0, s53, 18432
    s_nop 0
    buffer_load_dwordx4 v14, s[12:15], s51 offen lds
    s_add_u32 m0, s53, 19456
    s_nop 0
    buffer_load_dwordx4 v15, s[12:15], s51 offen lds
    s_add_u32 s50, s50, 8192
    s_add_u32 s51, s51, 0x20000
    s_add_u32 m0, s53, 32768
    s_nop 0
    buffer_load_dwordx4 v8, s[8:11], s50 offen offset:0 lds
    buffer_load_dwordx4 v8, s[8:11], s50 offen offset:1024 lds
    buffer_load_dwordx4 v8, s[8:11], s50 offen offset:2048 lds
    buffer_load_dwordx4 v8, s[8:11], s50 offen offset:3072 lds
    s_add_u32 m0, s53, 49152
    s_nop 0
    buffer_load_dwordx4 v12, s[12:15], s51 offen lds
    s_add_u32 m0, s53, 50176
    s_nop 0
    buffer_load_dwordx4 v13, s[12:15], s51 offen lds
    s_add_u32 m0, s53, 51200
    s_nop 0
    buffer_load_dwordx4 v14, s[12:15], s51 offen lds
    s_add_u32 m0, s53, 52224
    s_nop 0
    buffer_load_dwordx4 v15, s[12:15], s51 offen lds
    s_add_u32 s50, s50, 8192
    s_add_u32 s51, s51, 0x20000
    s_add_u32 m0, s53, 65536
    s_nop 0
    buffer_load_dwordx4 v8, s[8:11], s50 offen offset:0 lds
    buffer_load_dwordx4 v8, s[8:11], s50 offen offset:1024 lds
    buffer_load_dwordx4 v8, s[8:11], s50 offen offset:2048 lds
    buffer_load_dwordx4 v8, s[8:11], s50 offen offset:3072 lds
    s_add_u32 m0, s53, 81920
    s_nop 0
    buffer_load_dwordx4 v12, s[12:15], s51 offen lds
    s_add_u32 m0, s53, 82944
    s_nop 0
    buffer_load_dwordx4 v13, s[12:15], s51 offen lds
    s_add_u32 m0, s53, 83968
    s_nop 0
    buffer_load_dwordx4 v14, s[12:15], s51 offen lds
    s_add_u32 m0, s53, 84992
    s_nop 0
    buffer_load_dwordx4 v15, s[12:15], s51 offen lds
    s_add_u32 s50, s50, 8192
    s_add_u32 s51, s51, 0x20000
    s_add_u32 m0, s53, 98304
    s_nop 0
    buffer_load_dwordx4 v8, s[8:11], s50 offen offset:0 lds
    buffer_load_dwordx4 v8, s[8:11], s50 offen offset:1024 lds
    buffer_load_dwordx4 v8, s[8:11], s50 offen offset:2048 lds
    buffer_load_dwordx4 v8, s[8:11], s50 offen offset:3072 lds
    s_add_u32 m0, s53, 114688
    s_nop 0
    buffer_load_dwordx4 v12, s[12:15], s51 offen lds
    s_add_u32 m0, s53, 115712
    s_nop 0
    buffer_load_dwordx4 v13, s[12:15], s51 offen lds
    s_add_u32 m0, s53, 116736
    s_nop 0
    buffer_load_dwordx4 v14, s[12:15], s51 offen lds
    s_add_u32 m0, s53, 117760
    s_nop 0
    buffer_load_dwordx4 v15, s[12:15], s51 offen lds
    s_add_u32 s50, s50, 8192
    s_add_u32 s51, s51, 0x20000
    s_waitcnt vmcnt(24)
    s_barrier
    s_add_u32 m0, s53, 131072
    s_nop 0
    buffer_load_dwordx4 v8, s[8:11], s50 offen offset:0 lds
    buffer_load_dwordx4 v8, s[8:11], s50 offen offset:1024 lds
    buffer_load_dwordx4 v8, s[8:11], s50 offen offset:2048 lds
    buffer_load_dwordx4 v8, s[8:11], s50 offen offset:3072 lds
    s_add_u32 m0, s53, 147456
    s_nop 0
    buffer_load_dwordx4 v12, s[12:15], s51 offen lds
    s_add_u32 m0, s53, 148480
    s_nop 0
    buffer_load_dwordx4 v13, s[12:15], s51 offen lds
    s_add_u32 m0, s53, 149504
    s_nop 0
    buffer_load_dwordx4 v14, s[12:15], s51 offen lds
    s_add_u32 m0, s53, 150528
    s_nop 0
    buffer_load_dwordx4 v15, s[12:15], s51 offen lds
    s_add_u32 s50, s50, 8192
    s_add_u32 s51, s51, 0x20000
    ds_read_b128 v[96:99], v16 offset:0
    ds_read_b64_tr_b16 v[128:129], v24 offset:0
    ds_read_b64_tr_b16 v[130:131], v24 offset:1024
    ds_read_b128 v[100:103], v16 offset:1024
    ds_read_b64_tr_b16 v[132:133], v24 offset:2048
    ds_read_b64_tr_b16 v[134:135], v24 offset:3072
    ds_read_b128 v[104:107], v16 offset:2048
    ds_read_b64_tr_b16 v[136:137], v24 offset:4096
    ds_read_b64_tr_b16 v[138:139], v24 offset:5120
    ds_read_b128 v[108:111], v16 offset:3072
    ds_read_b64_tr_b16 v[140:141], v24 offset:6144
    ds_read_b64_tr_b16 v[142:143], v24 offset:7168
    ds_read_b128 v[112:115], v16 offset:4096
    ds_read_b64_tr_b16 v[144:145], v24 offset:8192
    ds_read_b64_tr_b16 v[146:147], v24 offset:9216
    s_waitcnt lgkmcnt(12)
    v_mfma_f32_32x32x16_bf16 v[64:79], v[128:131], v[96:99], 0
    ds_read_b128 v[116:119], v16 offset:5120
    ds_read_b64_tr_b16 v[148:149], v24 offset:10240
    ds_read_b64_tr_b16 v[150:151], v24 offset:11264
    s_waitcnt lgkmcnt(12)
    v_mfma_f32_32x32x16_bf16 v[64:79], v[132:135], v[100:103], v[64:79]
    ds_read_b128 v[120:123], v16 offset:6144
    ds_read_b64_tr_b16 v[152:153], v24 offset:12288
    ds_read_b64_tr_b16 v[154:155], v24 offset:13312
    s_waitcnt lgkmcnt(12)
    v_mfma_f32_32x32x16_bf16 v[64:79], v[136:139], v[104:107], v[64:79]
    ds_read_b128 v[124:127], v16 offset:7168
    ds_read_b64_tr_b16 v[156:157], v24 offset:14336
    ds_read_b64_tr_b16 v[158:159], v24 offset:15360
    s_waitcnt lgkmcnt(12)
    v_mfma_f32_32x32x16_bf16 v[64:79], v[140:143], v[108:111], v[64:79]
    s_waitcnt lgkmcnt(9)
    v_mfma_f32_32x32x16_bf16 v[64:79], v[144:147], v[112:115], v[64:79]
    s_waitcnt lgkmcnt(6)
    v_mfma_f32_32x32x16_bf16 v[64:79], v[148:151], v[116:119], v[64:79]
    s_waitcnt lgkmcnt(3)
    v_mfma_f32_32x32x16_bf16 v[64:79], v[152:155], v[120:123], v[64:79]
    s_waitcnt lgkmcnt(0)
    v_mfma_f32_32x32x16_bf16 v[64:79], v[156:159], v[124:127], v[64:79]
    s_waitcnt vmcnt(24)
    s_barrier
    s_add_u32 m0, s53, 0
    s_nop 0
    buffer_load_dwordx4 v8, s[8:11], s50 offen offset:0 lds
    buffer_load_dwordx4 v8, s[8:11], s50 offen offset:1024 lds
    buffer_load_dwordx4 v8, s[8:11], s50 offen offset:2048 lds
    buffer_load_dwordx4 v8, s[8:11], s50 offen offset:3072 lds
    s_add_u32 m0, s53, 16384
    s_nop 0
    buffer_load_dwordx4 v12, s[12:15], s51 offen lds
    s_add_u32 m0, s53, 17408
    s_nop 0
    buffer_load_dwordx4 v13, s[12:15], s51 offen lds
    s_add_u32 m0, s53, 18432
    s_nop 0
    buffer_load_dwordx4 v14, s[12:15], s51 offen lds
    s_add_u32 m0, s53, 19456
    s_nop 0
    buffer_load_dwordx4 v15, s[12:15], s51 offen lds
    s_add_u32 s50, s50, 8192
    s_add_u32 s51, s51, 0x20000
    ds_read_b128 v[96:99], v16 offset:32768
    ds_read_b64_tr_b16 v[128:129], v24 offset:32768
    ds_read_b64_tr_b16 v[130:131], v24 offset:33792
    ds_read_b128 v[100:103], v16 offset:33792
    ds_read_b64_tr_b16 v[132:133], v24 offset:34816
    ds_read_b64_tr_b16 v[134:135], v24 offset:35840
    ds_read_b128 v[104:107], v16 offset:34816
    ds_read_b64_tr_b16 v[136:137], v24 offset:36864
    ds_read_b64_tr_b16 v[138:139], v24 offset:37888
    ds_read_b128 v[108:111], v16 offset:35840
    ds_read_b64_tr_b16 v[140:141], v24 offset:38912
    ds_read_b64_tr_b16 v[142:143], v24 offset:39936
    ds_read_b128 v[112:115], v16 offset:36864
    ds_read_b64_tr_b16 v[144:145], v24 offset:40960
    ds_read_b64_tr_b16 v[146:147], v24 offset:41984
    s_waitcnt lgkmcnt(12)
    v_mfma_f32_32x32x16_bf16 v[64:79], v[128:131], v[96:99], v[64:79]
    ds_read_b128 v[116:119], v16 offset:37888
    ds_read_b64_tr_b16 v[148:149], v24 offset:43008
    ds_read_b64_tr_b16 v[150:151], v24 offset:44032
    s_waitcnt lgkmcnt(12)
    v_mfma_f32_32x32x16_bf16 v[64:79], v[132:135], v[100:103], v[64:79]
    ds_read_b128 v[120:123], v16 offset:38912
    ds_read_b64_tr_b16 v[152:153], v24 offset:45056
    ds_read_b64_tr_b16 v[154:155], v24 offset:46080
    s_waitcnt lgkmcnt(12)
    v_mfma_f32_32x32x16_bf16 v[64:79], v[136:139], v[104:107], v[64:79]
    ds_read_b128 v[124:127], v16 offset:39936
    ds_read_b64_tr_b16 v[156:157], v24 offset:47104
    ds_read_b64_tr_b16 v[158:159], v24 offset:48128
    s_waitcnt lgkmcnt(12)
    v_mfma_f32_32x32x16_bf16 v[64:79], v[140:143], v[108:111], v[64:79]
    s_waitcnt lgkmcnt(9)
    v_mfma_f32_32x32x16_bf16 v[64:79], v[144:147], v[112:115], v[64:79]
    s_waitcnt lgkmcnt(6)
    v_mfma_f32_32x32x16_bf16 v[64:79], v[148:151], v[116:119], v[64:79]
    s_waitcnt lgkmcnt(3)
    v_mfma_f32_32x32x16_bf16 v[64:79], v[152:155], v[120:123], v[64:79]
    s_waitcnt lgkmcnt(0)
    v_mfma_f32_32x32x16_bf16 v[64:79], v[156:159], v[124:127], v[64:79]
    s_waitcnt vmcnt(24)
    s_barrier
    s_add_u32 m0, s53, 32768
    s_nop 0
    buffer_load_dwordx4 v8, s[8:11], s50 offen offset:0 lds
    buffer_load_dwordx4 v8, s[8:11], s50 offen offset:1024 lds
    buffer_load_dwordx4 v8, s[8:11], s50 offen offset:2048 lds
    buffer_load_dwordx4 v8, s[8:11], s50 offen offset:3072 lds
    s_add_u32 m0, s53, 49152
    s_nop 0
    buffer_load_dwordx4 v12, s[12:15], s51 offen lds
    s_add_u32 m0, s53, 50176
    s_nop 0
    buffer_load_dwordx4 v13, s[12:15], s51 offen lds
    s_add_u32 m0, s53, 51200
    s_nop 0
    buffer_load_dwordx4 v14, s[12:15], s51 offen lds
    s_add_u32 m0, s53, 52224
    s_nop 0
    buffer_load_dwordx4 v15, s[12:15], s51 offen lds
    s_add_u32 s50, s50, 8192
    s_add_u32 s51, s51, 0x20000
    ds_read_b128 v[96:99], v34 offset:0
    ds_read_b64_tr_b16 v[128:129], v42 offset:0
    ds_read_b64_tr_b16 v[130:131], v42 offset:1024
    ds_read_b128 v[100:103], v34 offset:1024
    ds_read_b64_tr_b16 v[132:133], v42 offset:2048
    ds_read_b64_tr_b16 v[134:135], v42 offset:3072
    ds_read_b128 v[104:107], v34 offset:2048
    ds_read_b64_tr_b16 v[136:137], v42 offset:4096
    ds_read_b64_tr_b16 v[138:139], v42 offset:5120
    ds_read_b128 v[108:111], v34 offset:3072
    ds_read_b64_tr_b16 v[140:141], v42 offset:6144
    ds_read_b64_tr_b16 v[142:143], v42 offset:7168
    ds_read_b128 v[112:115], v34 offset:4096
    ds_read_b64_tr_b16 v[144:145], v42 offset:8192
    ds_read_b64_tr_b16 v[146:147], v42 offset:9216
    s_waitcnt lgkmcnt(12)
    v_mfma_f32_32x32x16_bf16 v[64:79], v[128:131], v[96:99], v[64:79]
    ds_read_b128 v[116:119], v34 offset:5120
    ds_read_b64_tr_b16 v[148:149], v42 offset:10240
    ds_read_b64_tr_b16 v[150:151], v42 offset:11264
    s_waitcnt lgkmcnt(12)
    v_mfma_f32_32x32x16_bf16 v[64:79], v[132:135], v[100:103], v[64:79]
    ds_read_b128 v[120:123], v34 offset:6144
    ds_read_b64_tr_b16 v[152:153], v42 offset:12288
    ds_read_b64_tr_b16 v[154:155], v42 offset:13312
    s_waitcnt lgkmcnt(12)
    v_mfma_f32_32x32x16_bf16 v[64:79], v[136:139], v[104:107], v[64:79]
    ds_read_b128 v[124:127], v34 offset:7168
    ds_read_b64_tr_b16 v[156:157], v42 offset:14336
    ds_read_b64_tr_b16 v[158:159], v42 offset:15360
    s_waitcnt lgkmcnt(12)
    v_mfma_f32_32x32x16_bf16 v[64:79], v[140:143], v[108:111], v[64:79]
    s_waitcnt lgkmcnt(9)
    v_mfma_f32_32x32x16_bf16 v[64:79], v[144:147], v[112:115], v[64:79]
    s_waitcnt lgkmcnt(6)
    v_mfma_f32_32x32x16_bf16 v[64:79], v[148:151], v[116:119], v[64:79]
    s_waitcnt lgkmcnt(3)
    v_mfma_f32_32x32x16_bf16 v[64:79], v[152:155], v[120:123], v[64:79]
    s_waitcnt lgkmcnt(0)
    v_mfma_f32_32x32x16_bf16 v[64:79], v[156:159], v[124:127], v[64:79]
    s_waitcnt vmcnt(24)
    s_barrier
    s_add_u32 m0, s53, 65536
    s_nop 0
    buffer_load_dwordx4 v8, s[8:11], s50 offen offset:0 lds
    buffer_load_dwordx4 v8, s[8:11], s50 offen offset:1024 lds
    buffer_load_dwordx4 v8, s[8:11], s50 offen offset:2048 lds
    buffer_load_dwordx4 v8, s[8:11], s50 offen offset:3072 lds
    s_add_u32 m0, s53, 81920
    s_nop 0
    buffer_load_dwordx4 v12, s[12:15], s51 offen lds
    s_add_u32 m0, s53, 82944
    s_nop 0
    buffer_load_dwordx4 v13, s[12:15], s51 offen lds
    s_add_u32 m0, s53, 83968
    s_nop 0
    buffer_load_dwordx4 v14, s[12:15], s51 offen lds
    s_add_u32 m0, s53, 84992
    s_nop 0
    buffer_load_dwordx4 v15, s[12:15], s51 offen lds
    s_add_u32 s50, s50, 8192
    s_add_u32 s51, s51, 0x20000
    ds_read_b128 v[96:99], v34 offset:32768
    ds_read_b64_tr_b16 v[128:129], v42 offset:32768
    ds_read_b64_tr_b16 v[130:131], v42 offset:33792
    ds_read_b128 v[100:103], v34 offset:33792
    ds_read_b64_tr_b16 v[132:133], v42 offset:34816
    ds_read_b64_tr_b16 v[134:135], v42 offset:35840
    ds_read_b128 v[104:107], v34 offset:34816
    ds_read_b64_tr_b16 v[136:137], v42 offset:36864
    ds_read_b64_tr_b16 v[138:139], v42 offset:37888
    ds_read_b128 v[108:111], v34 offset:35840
    ds_read_b64_tr_b16 v[140:141], v42 offset:38912
    ds_read_b64_tr_b16 v[142:143], v42 offset:39936
    ds_read_b128 v[112:115], v34 offset:36864
    ds_read_b64_tr_b16 v[144:145], v42 offset:40960
    ds_read_b64_tr_b16 v[146:147], v42 offset:41984
    s_waitcnt lgkmcnt(12)
    v_mfma_f32_32x32x16_bf16 v[64:79], v[128:131], v[96:99], v[64:79]
    ds_read_b128 v[116:119], v34 offset:37888
    ds_read_b64_tr_b16 v[148:149], v42 offset:43008
    ds_read_b64_tr_b16 v[150:151], v42 offset:44032
    s_waitcnt lgkmcnt(12)
    v_mfma_f32_32x32x16_bf16 v[64:79], v[132:135], v[100:103], v[64:79]
    ds_read_b128 v[120:123], v34 offset:38912
    ds_read_b64_tr_b16 v[152:153], v42 offset:45056
    ds_read_b64_tr_b16 v[154:155], v42 offset:46080
    s_waitcnt lgkmcnt(12)
    v_mfma_f32_32x32x16_bf16 v[64:79], v[136:139], v[104:107], v[64:79]
    ds_read_b128 v[124:127], v34 offset:39936
    ds_read_b64_tr_b16 v[156:157], v42 offset:47104
    ds_read_b64_tr_b16 v[158:159], v42 offset:48128
    s_waitcnt lgkmcnt(12)
    v_mfma_f32_32x32x16_bf16 v[64:79], v[140:143], v[108:111], v[64:79]
    s_waitcnt lgkmcnt(9)
    v_mfma_f32_32x32x16_bf16 v[64:79], v[144:147], v[112:115], v[64:79]
    s_waitcnt lgkmcnt(6)
    v_mfma_f32_32x32x16_bf16 v[64:79], v[148:151], v[116:119], v[64:79]
    s_waitcnt lgkmcnt(3)
    v_mfma_f32_32x32x16_bf16 v[64:79], v[152:155], v[120:123], v[64:79]
    s_waitcnt lgkmcnt(0)
    v_mfma_f32_32x32x16_bf16 v[64:79], v[156:159], v[124:127], v[64:79]
    s_waitcnt vmcnt(24)
    s_barrier
    s_add_u32 m0, s53, 98304
    s_nop 0
    buffer_load_dwordx4 v8, s[8:11], s50 offen offset:0 lds
    buffer_load_dwordx4 v8, s[8:11], s50 offen offset:1024 lds
    buffer_load_dwordx4 v8, s[8:11], s50 offen offset:2048 lds
    buffer_load_dwordx4 v8, s[8:11], s50 offen offset:3072 lds
    s_add_u32 m0, s53, 114688
    s_nop 0
    buffer_load_dwordx4 v12, s[12:15], s51 offen lds
    s_add_u32 m0, s53, 115712
    s_nop 0
    buffer_load_dwordx4 v13, s[12:15], s51 offen lds
    s_add_u32 m0, s53, 116736
    s_nop 0
    buffer_load_dwordx4 v14, s[12:15], s51 offen lds
    s_add_u32 m0, s53, 117760
    s_nop 0
    buffer_load_dwordx4 v15, s[12:15], s51 offen lds
    s_add_u32 s50, s50, 8192
    s_add_u32 s51, s51, 0x20000
    ds_read_b128 v[96:99], v52 offset:0
    ds_read_b64_tr_b16 v[128:129], v60 offset:0
    ds_read_b64_tr_b16 v[130:131], v60 offset:1024
    ds_read_b128 v[100:103], v52 offset:1024
    ds_read_b64_tr_b16 v[132:133], v60 offset:2048
    ds_read_b64_tr_b16 v[134:135], v60 offset:3072
    ds_read_b128 v[104:107], v52 offset:2048
    ds_read_b64_tr_b16 v[136:137], v60 offset:4096
    ds_read_b64_tr_b16 v[138:139], v60 offset:5120
    ds_read_b128 v[108:111], v52 offset:3072
    ds_read_b64_tr_b16 v[140:141], v60 offset:6144
    ds_read_b64_tr_b16 v[142:143], v60 offset:7168
    ds_read_b128 v[112:115], v52 offset:4096
    ds_read_b64_tr_b16 v[144:145], v60 offset:8192
    ds_read_b64_tr_b16 v[146:147], v60 offset:9216
    s_waitcnt lgkmcnt(12)
    v_mfma_f32_32x32x16_bf16 v[64:79], v[128:131], v[96:99], v[64:79]
    ds_read_b128 v[116:119], v52 offset:5120
    ds_read_b64_tr_b16 v[148:149], v60 offset:10240
    ds_read_b64_tr_b16 v[150:151], v60 offset:11264
    s_waitcnt lgkmcnt(12)
    v_mfma_f32_32x32x16_bf16 v[64:79], v[132:135], v[100:103], v[64:79]
    ds_read_b128 v[120:123], v52 offset:6144
    ds_read_b64_tr_b16 v[152:153], v60 offset:12288
    ds_read_b64_tr_b16 v[154:155], v60 offset:13312
    s_waitcnt lgkmcnt(12)
    v_mfma_f32_32x32x16_bf16 v[64:79], v[136:139], v[104:107], v[64:79]
    ds_read_b128 v[124:127], v52 offset:7168
    ds_read_b64_tr_b16 v[156:157], v60 offset:14336
    ds_read_b64_tr_b16 v[158:159], v60 offset:15360
    s_waitcnt lgkmcnt(12)
    v_mfma_f32_32x32x16_bf16 v[64:79], v[140:143], v[108:111], v[64:79]
    s_waitcnt lgkmcnt(9)
    v_mfma_f32_32x32x16_bf16 v[64:79], v[144:147], v[112:115], v[64:79]
    s_waitcnt lgkmcnt(6)
    v_mfma_f32_32x32x16_bf16 v[64:79], v[148:151], v[116:119], v[64:79]
    s_waitcnt lgkmcnt(3)
    v_mfma_f32_32x32x16_bf16 v[64:79], v[152:155], v[120:123], v[64:79]
    s_waitcnt lgkmcnt(0)
    v_mfma_f32_32x32x16_bf16 v[64:79], v[156:159], v[124:127], v[64:79]
    s_waitcnt vmcnt(24)
    s_barrier
    s_add_u32 m0, s53, 131072
    s_nop 0
    buffer_load_dwordx4 v8, s[8:11], s50 offen offset:0 lds
    buffer_load_dwordx4 v8, s[8:11], s50 offen offset:1024 lds
    buffer_load_dwordx4 v8, s[8:11], s50 offen offset:2048 lds
    buffer_load_dwordx4 v8, s[8:11], s50 offen offset:3072 lds
    s_add_u32 m0, s53, 147456
    s_nop 0
    buffer_load_dwordx4 v12, s[12:15], s51 offen lds
    s_add_u32 m0, s53, 148480
    s_nop 0
    buffer_load_dwordx4 v13, s[12:15], s51 offen lds
    s_add_u32 m0, s53, 149504
    s_nop 0
    buffer_load_dwordx4 v14, s[12:15], s51 offen lds
    s_add_u32 m0, s53, 150528
    s_nop 0
    buffer_load_dwordx4 v15, s[12:15], s51 offen lds
    s_add_u32 s50, s50, 8192
    s_add_u32 s51, s51, 0x20000
    ds_read_b128 v[96:99], v16 offset:0
    ds_read_b64_tr_b16 v[128:129], v24 offset:0
    ds_read_b64_tr_b16 v[130:131], v24 offset:1024
    ds_read_b128 v[100:103], v16 offset:1024
    ds_read_b64_tr_b16 v[132:133], v24 offset:2048
    ds_read_b64_tr_b16 v[134:135], v24 offset:3072
    ds_read_b128 v[104:107], v16 offset:2048
    ds_read_b64_tr_b16 v[136:137], v24 offset:4096
    ds_read_b64_tr_b16 v[138:139], v24 offset:5120
    ds_read_b128 v[108:111], v16 offset:3072
    ds_read_b64_tr_b16 v[140:141], v24 offset:6144
    ds_read_b64_tr_b16 v[142:143], v24 offset:7168
    ds_read_b128 v[112:115], v16 offset:4096
    ds_read_b64_tr_b16 v[144:145], v24 offset:8192
    ds_read_b64_tr_b16 v[146:147], v24 offset:9216
    s_waitcnt lgkmcnt(12)
    v_mfma_f32_32x32x16_bf16 v[64:79], v[128:131], v[96:99], v[64:79]
    ds_read_b128 v[116:119], v16 offset:5120
    ds_read_b64_tr_b16 v[148:149], v24 offset:10240
    ds_read_b64_tr_b16 v[150:151], v24 offset:11264
    s_waitcnt lgkmcnt(12)
    v_mfma_f32_32x32x16_bf16 v[64:79], v[132:135], v[100:103], v[64:79]
    ds_read_b128 v[120:123], v16 offset:6144
    ds_read_b64_tr_b16 v[152:153], v24 offset:12288
    ds_read_b64_tr_b16 v[154:155], v24 offset:13312
    s_waitcnt lgkmcnt(12)
    v_mfma_f32_32x32x16_bf16 v[64:79], v[136:139], v[104:107], v[64:79]
    ds_read_b128 v[124:127], v16 offset:7168
    ds_read_b64_tr_b16 v[156:157], v24 offset:14336
    ds_read_b64_tr_b16 v[158:159], v24 offset:15360
    s_waitcnt lgkmcnt(12)
    v_mfma_f32_32x32x16_bf16 v[64:79], v[140:143], v[108:111], v[64:79]
    s_waitcnt lgkmcnt(9)
    v_mfma_f32_32x32x16_bf16 v[64:79], v[144:147], v[112:115], v[64:79]
    s_waitcnt lgkmcnt(6)
    v_mfma_f32_32x32x16_bf16 v[64:79], v[148:151], v[116:119], v[64:79]
    s_waitcnt lgkmcnt(3)
    v_mfma_f32_32x32x16_bf16 v[64:79], v[152:155], v[120:123], v[64:79]
    s_waitcnt lgkmcnt(0)
    v_mfma_f32_32x32x16_bf16 v[64:79], v[156:159], v[124:127], v[64:79]
    s_waitcnt vmcnt(24)
    s_barrier
    s_add_u32 m0, s53, 0
    s_nop 0
    buffer_load_dwordx4 v8, s[8:11], s50 offen offset:0 lds
    buffer_load_dwordx4 v8, s[8:11], s50 offen offset:1024 lds
    buffer_load_dwordx4 v8, s[8:11], s50 offen offset:2048 lds
    buffer_load_dwordx4 v8, s[8:11], s50 offen offset:3072 lds
    s_add_u32 m0, s53, 16384
    s_nop 0
    buffer_load_dwordx4 v12, s[12:15], s51 offen lds
    s_add_u32 m0, s53, 17408
    s_nop 0
    buffer_load_dwordx4 v13, s[12:15], s51 offen lds
    s_add_u32 m0, s53, 18432
    s_nop 0
    buffer_load_dwordx4 v14, s[12:15], s51 offen lds
    s_add_u32 m0, s53, 19456
    s_nop 0
    buffer_load_dwordx4 v15, s[12:15], s51 offen lds
    s_add_u32 s50, s50, 8192
    s_add_u32 s51, s51, 0x20000
    ds_read_b128 v[96:99], v16 offset:32768
    ds_read_b64_tr_b16 v[128:129], v24 offset:32768
    ds_read_b64_tr_b16 v[130:131], v24 offset:33792
    ds_read_b128 v[100:103], v16 offset:33792
    ds_read_b64_tr_b16 v[132:133], v24 offset:34816
    ds_read_b64_tr_b16 v[134:135], v24 offset:35840
    ds_read_b128 v[104:107], v16 offset:34816
    ds_read_b64_tr_b16 v[136:137], v24 offset:36864
    ds_read_b64_tr_b16 v[138:139], v24 offset:37888
    ds_read_b128 v[108:111], v16 offset:35840
    ds_read_b64_tr_b16 v[140:141], v24 offset:38912
    ds_read_b64_tr_b16 v[142:143], v24 offset:39936
    ds_read_b128 v[112:115], v16 offset:36864
    ds_read_b64_tr_b16 v[144:145], v24 offset:40960
    ds_read_b64_tr_b16 v[146:147], v24 offset:41984
    s_waitcnt lgkmcnt(12)
    v_mfma_f32_32x32x16_bf16 v[64:79], v[128:131], v[96:99], v[64:79]
    ds_read_b128 v[116:119], v16 offset:37888
    ds_read_b64_tr_b16 v[148:149], v24 offset:43008
    ds_read_b64_tr_b16 v[150:151], v24 offset:44032
    s_waitcnt lgkmcnt(12)
    v_mfma_f32_32x32x16_bf16 v[64:79], v[132:135], v[100:103], v[64:79]
    ds_read_b128 v[120:123], v16 offset:38912
    ds_read_b64_tr_b16 v[152:153], v24 offset:45056
    ds_read_b64_tr_b16 v[154:155], v24 offset:46080
    s_waitcnt lgkmcnt(12)
    v_mfma_f32_32x32x16_bf16 v[64:79], v[136:139], v[104:107], v[64:79]
    ds_read_b128 v[124:127], v16 offset:39936
    ds_read_b64_tr_b16 v[156:157], v24 offset:47104
    ds_read_b64_tr_b16 v[158:159], v24 offset:48128
    s_waitcnt lgkmcnt(12)
    v_mfma_f32_32x32x16_bf16 v[64:79], v[140:143], v[108:111], v[64:79]
    s_waitcnt lgkmcnt(9)
    v_mfma_f32_32x32x16_bf16 v[64:79], v[144:147], v[112:115], v[64:79]
    s_waitcnt lgkmcnt(6)
    v_mfma_f32_32x32x16_bf16 v[64:79], v[148:151], v[116:119], v[64:79]
    s_waitcnt lgkmcnt(3)
    v_mfma_f32_32x32x16_bf16 v[64:79], v[152:155], v[120:123], v[64:79]
    s_waitcnt lgkmcnt(0)
    v_mfma_f32_32x32x16_bf16 v[64:79], v[156:159], v[124:127], v[64:79]
    s_waitcnt vmcnt(24)
    s_barrier
    s_add_u32 m0, s53, 32768
    s_nop 0
    buffer_load_dwordx4 v8, s[8:11], s50 offen offset:0 lds
    buffer_load_dwordx4 v8, s[8:11], s50 offen offset:1024 lds
    buffer_load_dwordx4 v8, s[8:11], s50 offen offset:2048 lds
    buffer_load_dwordx4 v8, s[8:11], s50 offen offset:3072 lds
    s_add_u32 m0, s53, 49152
    s_nop 0
    buffer_load_dwordx4 v12, s[12:15], s51 offen lds
    s_add_u32 m0, s53, 50176
    s_nop 0
    buffer_load_dwordx4 v13, s[12:15], s51 offen lds
    s_add_u32 m0, s53, 51200
    s_nop 0
    buffer_load_dwordx4 v14, s[12:15], s51 offen lds
    s_add_u32 m0, s53, 52224
    s_nop 0
    buffer_load_dwordx4 v15, s[12:15], s51 offen lds
    s_add_u32 s50, s50, 8192
    s_add_u32 s51, s51, 0x20000
    ds_read_b128 v[96:99], v34 offset:0
    ds_read_b64_tr_b16 v[128:129], v42 offset:0
    ds_read_b64_tr_b16 v[130:131], v42 offset:1024
    ds_read_b128 v[100:103], v34 offset:1024
    ds_read_b64_tr_b16 v[132:133], v42 offset:2048
    ds_read_b64_tr_b16 v[134:135], v42 offset:3072
    ds_read_b128 v[104:107], v34 offset:2048
    ds_read_b64_tr_b16 v[136:137], v42 offset:4096
    ds_read_b64_tr_b16 v[138:139], v42 offset:5120
    ds_read_b128 v[108:111], v34 offset:3072
    ds_read_b64_tr_b16 v[140:141], v42 offset:6144
    ds_read_b64_tr_b16 v[142:143], v42 offset:7168
    ds_read_b128 v[112:115], v34 offset:4096
    ds_read_b64_tr_b16 v[144:145], v42 offset:8192
    ds_read_b64_tr_b16 v[146:147], v42 offset:9216
    s_waitcnt lgkmcnt(12)
    v_mfma_f32_32x32x16_bf16 v[64:79], v[128:131], v[96:99], v[64:79]
    ds_read_b128 v[116:119], v34 offset:5120
    ds_read_b64_tr_b16 v[148:149], v42 offset:10240
    ds_read_b64_tr_b16 v[150:151], v42 offset:11264
    s_waitcnt lgkmcnt(12)
    v_mfma_f32_32x32x16_bf16 v[64:79], v[132:135], v[100:103], v[64:79]
    ds_read_b128 v[120:123], v34 offset:6144
    ds_read_b64_tr_b16 v[152:153], v42 offset:12288
    ds_read_b64_tr_b16 v[154:155], v42 offset:13312
    s_waitcnt lgkmcnt(12)
    v_mfma_f32_32x32x16_bf16 v[64:79], v[136:139], v[104:107], v[64:79]
    ds_read_b128 v[124:127], v34 offset:7168
    ds_read_b64_tr_b16 v[156:157], v42 offset:14336
    ds_read_b64_tr_b16 v[158:159], v42 offset:15360
    s_waitcnt lgkmcnt(12)
    v_mfma_f32_32x32x16_bf16 v[64:79], v[140:143], v[108:111], v[64:79]
    s_waitcnt lgkmcnt(9)
    v_mfma_f32_32x32x16_bf16 v[64:79], v[144:147], v[112:115], v[64:79]
    s_waitcnt lgkmcnt(6)
    v_mfma_f32_32x32x16_bf16 v[64:79], v[148:151], v[116:119], v[64:79]
    s_waitcnt lgkmcnt(3)
    v_mfma_f32_32x32x16_bf16 v[64:79], v[152:155], v[120:123], v[64:79]
    s_waitcnt lgkmcnt(0)
    v_mfma_f32_32x32x16_bf16 v[64:79], v[156:159], v[124:127], v[64:79]
    s_waitcnt vmcnt(24)
    s_barrier
    s_add_u32 m0, s53, 65536
    s_nop 0
    buffer_load_dwordx4 v8, s[8:11], s50 offen offset:0 lds
    buffer_load_dwordx4 v8, s[8:11], s50 offen offset:1024 lds
    buffer_load_dwordx4 v8, s[8:11], s50 offen offset:2048 lds
    buffer_load_dwordx4 v8, s[8:11], s50 offen offset:3072 lds
    s_add_u32 m0, s53, 81920
    s_nop 0
    buffer_load_dwordx4 v12, s[12:15], s51 offen lds
    s_add_u32 m0, s53, 82944
    s_nop 0
    buffer_load_dwordx4 v13, s[12:15], s51 offen lds
    s_add_u32 m0, s53, 83968
    s_nop 0
    buffer_load_dwordx4 v14, s[12:15], s51 offen lds
    s_add_u32 m0, s53, 84992
    s_nop 0
    buffer_load_dwordx4 v15, s[12:15], s51 offen lds
    s_add_u32 s50, s50, 8192
    s_add_u32 s51, s51, 0x20000
    ds_read_b128 v[96:99], v34 offset:32768
    ds_read_b64_tr_b16 v[128:129], v42 offset:32768
    ds_read_b64_tr_b16 v[130:131], v42 offset:33792
    ds_read_b128 v[100:103], v34 offset:33792
    ds_read_b64_tr_b16 v[132:133], v42 offset:34816
    ds_read_b64_tr_b16 v[134:135], v42 offset:35840
    ds_read_b128 v[104:107], v34 offset:34816
    ds_read_b64_tr_b16 v[136:137], v42 offset:36864
    ds_read_b64_tr_b16 v[138:139], v42 offset:37888
    ds_read_b128 v[108:111], v34 offset:35840
    ds_read_b64_tr_b16 v[140:141], v42 offset:38912
    ds_read_b64_tr_b16 v[142:143], v42 offset:39936
    ds_read_b128 v[112:115], v34 offset:36864
    ds_read_b64_tr_b16 v[144:145], v42 offset:40960
    ds_read_b64_tr_b16 v[146:147], v42 offset:41984
    s_waitcnt lgkmcnt(12)
    v_mfma_f32_32x32x16_bf16 v[64:79], v[128:131], v[96:99], v[64:79]
    ds_read_b128 v[116:119], v34 offset:37888
    ds_read_b64_tr_b16 v[148:149], v42 offset:43008
    ds_read_b64_tr_b16 v[150:151], v42 offset:44032
    s_waitcnt lgkmcnt(12)
    v_mfma_f32_32x32x16_bf16 v[64:79], v[132:135], v[100:103], v[64:79]
    ds_read_b128 v[120:123], v34 offset:38912
    ds_read_b64_tr_b16 v[152:153], v42 offset:45056
    ds_read_b64_tr_b16 v[154:155], v42 offset:46080
    s_waitcnt lgkmcnt(12)
    v_mfma_f32_32x32x16_bf16 v[64:79], v[136:139], v[104:107], v[64:79]
    ds_read_b128 v[124:127], v34 offset:39936
    ds_read_b64_tr_b16 v[156:157], v42 offset:47104
    ds_read_b64_tr_b16 v[158:159], v42 offset:48128
    s_waitcnt lgkmcnt(12)
    v_mfma_f32_32x32x16_bf16 v[64:79], v[140:143], v[108:111], v[64:79]
    s_waitcnt lgkmcnt(9)
    v_mfma_f32_32x32x16_bf16 v[64:79], v[144:147], v[112:115], v[64:79]
    s_waitcnt lgkmcnt(6)
    v_mfma_f32_32x32x16_bf16 v[64:79], v[148:151], v[116:119], v[64:79]
    s_waitcnt lgkmcnt(3)
    v_mfma_f32_32x32x16_bf16 v[64:79], v[152:155], v[120:123], v[64:79]
    s_waitcnt lgkmcnt(0)
    v_mfma_f32_32x32x16_bf16 v[64:79], v[156:159], v[124:127], v[64:79]
    s_waitcnt vmcnt(24)
    s_barrier
    s_add_u32 m0, s53, 98304
    s_nop 0
    buffer_load_dwordx4 v8, s[8:11], s50 offen offset:0 lds
    buffer_load_dwordx4 v8, s[8:11], s50 offen offset:1024 lds
    buffer_load_dwordx4 v8, s[8:11], s50 offen offset:2048 lds
    buffer_load_dwordx4 v8, s[8:11], s50 offen offset:3072 lds
    s_add_u32 m0, s53, 114688
    s_nop 0
    buffer_load_dwordx4 v12, s[12:15], s51 offen lds
    s_add_u32 m0, s53, 115712
    s_nop 0
    buffer_load_dwordx4 v13, s[12:15], s51 offen lds
    s_add_u32 m0, s53, 116736
    s_nop 0
    buffer_load_dwordx4 v14, s[12:15], s51 offen lds
    s_add_u32 m0, s53, 117760
    s_nop 0
    buffer_load_dwordx4 v15, s[12:15], s51 offen lds
    s_add_u32 s50, s50, 8192
    s_add_u32 s51, s51, 0x20000
    ds_read_b128 v[96:99], v52 offset:0
    ds_read_b64_tr_b16 v[128:129], v60 offset:0
    ds_read_b64_tr_b16 v[130:131], v60 offset:1024
    ds_read_b128 v[100:103], v52 offset:1024
    ds_read_b64_tr_b16 v[132:133], v60 offset:2048
    ds_read_b64_tr_b16 v[134:135], v60 offset:3072
    ds_read_b128 v[104:107], v52 offset:2048
    ds_read_b64_tr_b16 v[136:137], v60 offset:4096
    ds_read_b64_tr_b16 v[138:139], v60 offset:5120
    ds_read_b128 v[108:111], v52 offset:3072
    ds_read_b64_tr_b16 v[140:141], v60 offset:6144
    ds_read_b64_tr_b16 v[142:143], v60 offset:7168
    ds_read_b128 v[112:115], v52 offset:4096
    ds_read_b64_tr_b16 v[144:145], v60 offset:8192
    ds_read_b64_tr_b16 v[146:147], v60 offset:9216
    s_waitcnt lgkmcnt(12)
    v_mfma_f32_32x32x16_bf16 v[64:79], v[128:131], v[96:99], v[64:79]
    ds_read_b128 v[116:119], v52 offset:5120
    ds_read_b64_tr_b16 v[148:149], v60 offset:10240
    ds_read_b64_tr_b16 v[150:151], v60 offset:11264
    s_waitcnt lgkmcnt(12)
    v_mfma_f32_32x32x16_bf16 v[64:79], v[132:135], v[100:103], v[64:79]
    ds_read_b128 v[120:123], v52 offset:6144
    ds_read_b64_tr_b16 v[152:153], v60 offset:12288
    ds_read_b64_tr_b16 v[154:155], v60 offset:13312
    s_waitcnt lgkmcnt(12)
    v_mfma_f32_32x32x16_bf16 v[64:79], v[136:139], v[104:107], v[64:79]
    ds_read_b128 v[124:127], v52 offset:7168
    ds_read_b64_tr_b16 v[156:157], v60 offset:14336
    ds_read_b64_tr_b16 v[158:159], v60 offset:15360
    s_waitcnt lgkmcnt(12)
    v_mfma_f32_32x32x16_bf16 v[64:79], v[140:143], v[108:111], v[64:79]
    s_waitcnt lgkmcnt(9)
    v_mfma_f32_32x32x16_bf16 v[64:79], v[144:147], v[112:115], v[64:79]
    s_waitcnt lgkmcnt(6)
    v_mfma_f32_32x32x16_bf16 v[64:79], v[148:151], v[116:119], v[64:79]
    s_waitcnt lgkmcnt(3)
    v_mfma_f32_32x32x16_bf16 v[64:79], v[152:155], v[120:123], v[64:79]
    s_waitcnt lgkmcnt(0)
    v_mfma_f32_32x32x16_bf16 v[64:79], v[156:159], v[124:127], v[64:79]
    s_waitcnt vmcnt(24)
    s_barrier
    s_add_u32 m0, s53, 131072
    s_nop 0
    buffer_load_dwordx4 v8, s[8:11], s50 offen offset:0 lds
    buffer_load_dwordx4 v8, s[8:11], s50 offen offset:1024 lds
    buffer_load_dwordx4 v8, s[8:11], s50 offen offset:2048 lds
    buffer_load_dwordx4 v8, s[8:11], s50 offen offset:3072 lds
    s_add_u32 m0, s53, 147456
    s_nop 0
    buffer_load_dwordx4 v12, s[12:15], s51 offen lds
    s_add_u32 m0, s53, 148480
    s_nop 0
    buffer_load_dwordx4 v13, s[12:15], s51 offen lds
    s_add_u32 m0, s53, 149504
    s_nop 0
    buffer_load_dwordx4 v14, s[12:15], s51 offen lds
    s_add_u32 m0, s53, 150528
    s_nop 0
    buffer_load_dwordx4 v15, s[12:15], s51 offen lds
    s_add_u32 s50, s50, 8192
    s_add_u32 s51, s51, 0x20000
    ds_read_b128 v[96:99], v16 offset:0
    ds_read_b64_tr_b16 v[128:129], v24 offset:0
    ds_read_b64_tr_b16 v[130:131], v24 offset:1024
    ds_read_b128 v[100:103], v16 offset:1024
    ds_read_b64_tr_b16 v[132:133], v24 offset:2048
    ds_read_b64_tr_b16 v[134:135], v24 offset:3072
    ds_read_b128 v[104:107], v16 offset:2048
    ds_read_b64_tr_b16 v[136:137], v24 offset:4096
    ds_read_b64_tr_b16 v[138:139], v24 offset:5120
    ds_read_b128 v[108:111], v16 offset:3072
    ds_read_b64_tr_b16 v[140:141], v24 offset:6144
    ds_read_b64_tr_b16 v[142:143], v24 offset:7168
    ds_read_b128 v[112:115], v16 offset:4096
    ds_read_b64_tr_b16 v[144:145], v24 offset:8192
    ds_read_b64_tr_b16 v[146:147], v24 offset:9216
    s_waitcnt lgkmcnt(12)
    v_mfma_f32_32x32x16_bf16 v[64:79], v[128:131], v[96:99], v[64:79]
    ds_read_b128 v[116:119], v16 offset:5120
    ds_read_b64_tr_b16 v[148:149], v24 offset:10240
    ds_read_b64_tr_b16 v[150:151], v24 offset:11264
    s_waitcnt lgkmcnt(12)
    v_mfma_f32_32x32x16_bf16 v[64:79], v[132:135], v[100:103], v[64:79]
    ds_read_b128 v[120:123], v16 offset:6144
    ds_read_b64_tr_b16 v[152:153], v24 offset:12288
    ds_read_b64_tr_b16 v[154:155], v24 offset:13312
    s_waitcnt lgkmcnt(12)
    v_mfma_f32_32x32x16_bf16 v[64:79], v[136:139], v[104:107], v[64:79]
    ds_read_b128 v[124:127], v16 offset:7168
    ds_read_b64_tr_b16 v[156:157], v24 offset:14336
    ds_read_b64_tr_b16 v[158:159], v24 offset:15360
    s_waitcnt lgkmcnt(12)
    v_mfma_f32_32x32x16_bf16 v[64:79], v[140:143], v[108:111], v[64:79]
    s_waitcnt lgkmcnt(9)
    v_mfma_f32_32x32x16_bf16 v[64:79], v[144:147], v[112:115], v[64:79]
    s_waitcnt lgkmcnt(6)
    v_mfma_f32_32x32x16_bf16 v[64:79], v[148:151], v[116:119], v[64:79]
    s_waitcnt lgkmcnt(3)
    v_mfma_f32_32x32x16_bf16 v[64:79], v[152:155], v[120:123], v[64:79]
    s_waitcnt lgkmcnt(0)
    v_mfma_f32_32x32x16_bf16 v[64:79], v[156:159], v[124:127], v[64:79]
    s_waitcnt vmcnt(24)
    s_barrier
    s_add_u32 m0, s53, 0
    s_nop 0
    buffer_load_dwordx4 v8, s[8:11], s50 offen offset:0 lds
    buffer_load_dwordx4 v8, s[8:11], s50 offen offset:1024 lds
    buffer_load_dwordx4 v8, s[8:11], s50 offen offset:2048 lds
    buffer_load_dwordx4 v8, s[8:11], s50 offen offset:3072 lds
    s_add_u32 m0, s53, 16384
    s_nop 0
    buffer_load_dwordx4 v12, s[12:15], s51 offen lds
    s_add_u32 m0, s53, 17408
    s_nop 0
    buffer_load_dwordx4 v13, s[12:15], s51 offen lds
    s_add_u32 m0, s53, 18432
    s_nop 0
    buffer_load_dwordx4 v14, s[12:15], s51 offen lds
    s_add_u32 m0, s53, 19456
    s_nop 0
    buffer_load_dwordx4 v15, s[12:15], s51 offen lds
    s_add_u32 s50, s50, 8192
    s_add_u32 s51, s51, 0x20000
    ds_read_b128 v[96:99], v16 offset:32768
    ds_read_b64_tr_b16 v[128:129], v24 offset:32768
    ds_read_b64_tr_b16 v[130:131], v24 offset:33792
    ds_read_b128 v[100:103], v16 offset:33792
    ds_read_b64_tr_b16 v[132:133], v24 offset:34816
    ds_read_b64_tr_b16 v[134:135], v24 offset:35840
    ds_read_b128 v[104:107], v16 offset:34816
    ds_read_b64_tr_b16 v[136:137], v24 offset:36864
    ds_read_b64_tr_b16 v[138:139], v24 offset:37888
    ds_read_b128 v[108:111], v16 offset:35840
    ds_read_b64_tr_b16 v[140:141], v24 offset:38912
    ds_read_b64_tr_b16 v[142:143], v24 offset:39936
    ds_read_b128 v[112:115], v16 offset:36864
    ds_read_b64_tr_b16 v[144:145], v24 offset:40960
    ds_read_b64_tr_b16 v[146:147], v24 offset:41984
    s_waitcnt lgkmcnt(12)
    v_mfma_f32_32x32x16_bf16 v[64:79], v[128:131], v[96:99], v[64:79]
    ds_read_b128 v[116:119], v16 offset:37888
    ds_read_b64_tr_b16 v[148:149], v24 offset:43008
    ds_read_b64_tr_b16 v[150:151], v24 offset:44032
    s_waitcnt lgkmcnt(12)
    v_mfma_f32_32x32x16_bf16 v[64:79], v[132:135], v[100:103], v[64:79]
    ds_read_b128 v[120:123], v16 offset:38912
    ds_read_b64_tr_b16 v[152:153], v24 offset:45056
    ds_read_b64_tr_b16 v[154:155], v24 offset:46080
    s_waitcnt lgkmcnt(12)
    v_mfma_f32_32x32x16_bf16 v[64:79], v[136:139], v[104:107], v[64:79]
    ds_read_b128 v[124:127], v16 offset:39936
    ds_read_b64_tr_b16 v[156:157], v24 offset:47104
    ds_read_b64_tr_b16 v[158:159], v24 offset:48128
    s_waitcnt lgkmcnt(12)
    v_mfma_f32_32x32x16_bf16 v[64:79], v[140:143], v[108:111], v[64:79]
    s_waitcnt lgkmcnt(9)
    v_mfma_f32_32x32x16_bf16 v[64:79], v[144:147], v[112:115], v[64:79]
    s_waitcnt lgkmcnt(6)
    v_mfma_f32_32x32x16_bf16 v[64:79], v[148:151], v[116:119], v[64:79]
    s_waitcnt lgkmcnt(3)
    v_mfma_f32_32x32x16_bf16 v[64:79], v[152:155], v[120:123], v[64:79]
    s_waitcnt lgkmcnt(0)
    v_mfma_f32_32x32x16_bf16 v[64:79], v[156:159], v[124:127], v[64:79]
    s_waitcnt vmcnt(24)
    s_barrier
    s_add_u32 m0, s53, 32768
    s_nop 0
    buffer_load_dwordx4 v8, s[8:11], s50 offen offset:0 lds
    buffer_load_dwordx4 v8, s[8:11], s50 offen offset:1024 lds
    buffer_load_dwordx4 v8, s[8:11], s50 offen offset:2048 lds
    buffer_load_dwordx4 v8, s[8:11], s50 offen offset:3072 lds
    s_add_u32 m0, s53, 49152
    s_nop 0
    buffer_load_dwordx4 v12, s[12:15], s51 offen lds
    s_add_u32 m0, s53, 50176
    s_nop 0
    buffer_load_dwordx4 v13, s[12:15], s51 offen lds
    s_add_u32 m0, s53, 51200
    s_nop 0
    buffer_load_dwordx4 v14, s[12:15], s51 offen lds
    s_add_u32 m0, s53, 52224
    s_nop 0
    buffer_load_dwordx4 v15, s[12:15], s51 offen lds
    s_add_u32 s50, s50, 8192
    s_add_u32 s51, s51, 0x20000
    ds_read_b128 v[96:99], v34 offset:0
    ds_read_b64_tr_b16 v[128:129], v42 offset:0
    ds_read_b64_tr_b16 v[130:131], v42 offset:1024
    ds_read_b128 v[100:103], v34 offset:1024
    ds_read_b64_tr_b16 v[132:133], v42 offset:2048
    ds_read_b64_tr_b16 v[134:135], v42 offset:3072
    ds_read_b128 v[104:107], v34 offset:2048
    ds_read_b64_tr_b16 v[136:137], v42 offset:4096
    ds_read_b64_tr_b16 v[138:139], v42 offset:5120
    ds_read_b128 v[108:111], v34 offset:3072
    ds_read_b64_tr_b16 v[140:141], v42 offset:6144
    ds_read_b64_tr_b16 v[142:143], v42 offset:7168
    ds_read_b128 v[112:115], v34 offset:4096
    ds_read_b64_tr_b16 v[144:145], v42 offset:8192
    ds_read_b64_tr_b16 v[146:147], v42 offset:9216
    s_waitcnt lgkmcnt(12)
    v_mfma_f32_32x32x16_bf16 v[64:79], v[128:131], v[96:99], v[64:79]
    ds_read_b128 v[116:119], v34 offset:5120
    ds_read_b64_tr_b16 v[148:149], v42 offset:10240
    ds_read_b64_tr_b16 v[150:151], v42 offset:11264
    s_waitcnt lgkmcnt(12)
    v_mfma_f32_32x32x16_bf16 v[64:79], v[132:135], v[100:103], v[64:79]
    ds_read_b128 v[120:123], v34 offset:6144
    ds_read_b64_tr_b16 v[152:153], v42 offset:12288
    ds_read_b64_tr_b16 v[154:155], v42 offset:13312
    s_waitcnt lgkmcnt(12)
    v_mfma_f32_32x32x16_bf16 v[64:79], v[136:139], v[104:107], v[64:79]
    ds_read_b128 v[124:127], v34 offset:7168
    ds_read_b64_tr_b16 v[156:157], v42 offset:14336
    ds_read_b64_tr_b16 v[158:159], v42 offset:15360
    s_waitcnt lgkmcnt(12)
    v_mfma_f32_32x32x16_bf16 v[64:79], v[140:143], v[108:111], v[64:79]
    s_waitcnt lgkmcnt(9)
    v_mfma_f32_32x32x16_bf16 v[64:79], v[144:147], v[112:115], v[64:79]
    s_waitcnt lgkmcnt(6)
    v_mfma_f32_32x32x16_bf16 v[64:79], v[148:151], v[116:119], v[64:79]
    s_waitcnt lgkmcnt(3)
    v_mfma_f32_32x32x16_bf16 v[64:79], v[152:155], v[120:123], v[64:79]
    s_waitcnt lgkmcnt(0)
    v_mfma_f32_32x32x16_bf16 v[64:79], v[156:159], v[124:127], v[64:79]
    s_waitcnt vmcnt(24)
    s_barrier
    s_add_u32 m0, s53, 65536
    s_nop 0
    buffer_load_dwordx4 v8, s[8:11], s50 offen offset:0 lds
    buffer_load_dwordx4 v8, s[8:11], s50 offen offset:1024 lds
    buffer_load_dwordx4 v8, s[8:11], s50 offen offset:2048 lds
    buffer_load_dwordx4 v8, s[8:11], s50 offen offset:3072 lds
    s_add_u32 m0, s53, 81920
    s_nop 0
    buffer_load_dwordx4 v12, s[12:15], s51 offen lds
    s_add_u32 m0, s53, 82944
    s_nop 0
    buffer_load_dwordx4 v13, s[12:15], s51 offen lds
    s_add_u32 m0, s53, 83968
    s_nop 0
    buffer_load_dwordx4 v14, s[12:15], s51 offen lds
    s_add_u32 m0, s53, 84992
    s_nop 0
    buffer_load_dwordx4 v15, s[12:15], s51 offen lds
    s_add_u32 s50, s50, 8192
    s_add_u32 s51, s51, 0x20000
    ds_read_b128 v[96:99], v34 offset:32768
    ds_read_b64_tr_b16 v[128:129], v42 offset:32768
    ds_read_b64_tr_b16 v[130:131], v42 offset:33792
    ds_read_b128 v[100:103], v34 offset:33792
    ds_read_b64_tr_b16 v[132:133], v42 offset:34816
    ds_read_b64_tr_b16 v[134:135], v42 offset:35840
    ds_read_b128 v[104:107], v34 offset:34816
    ds_read_b64_tr_b16 v[136:137], v42 offset:36864
    ds_read_b64_tr_b16 v[138:139], v42 offset:37888
    ds_read_b128 v[108:111], v34 offset:35840
    ds_read_b64_tr_b16 v[140:141], v42 offset:38912
    ds_read_b64_tr_b16 v[142:143], v42 offset:39936
    ds_read_b128 v[112:115], v34 offset:36864
    ds_read_b64_tr_b16 v[144:145], v42 offset:40960
    ds_read_b64_tr_b16 v[146:147], v42 offset:41984
    s_waitcnt lgkmcnt(12)
    v_mfma_f32_32x32x16_bf16 v[64:79], v[128:131], v[96:99], v[64:79]
    ds_read_b128 v[116:119], v34 offset:37888
    ds_read_b64_tr_b16 v[148:149], v42 offset:43008
    ds_read_b64_tr_b16 v[150:151], v42 offset:44032
    s_waitcnt lgkmcnt(12)
    v_mfma_f32_32x32x16_bf16 v[64:79], v[132:135], v[100:103], v[64:79]
    ds_read_b128 v[120:123], v34 offset:38912
    ds_read_b64_tr_b16 v[152:153], v42 offset:45056
    ds_read_b64_tr_b16 v[154:155], v42 offset:46080
    s_waitcnt lgkmcnt(12)
    v_mfma_f32_32x32x16_bf16 v[64:79], v[136:139], v[104:107], v[64:79]
    ds_read_b128 v[124:127], v34 offset:39936
    ds_read_b64_tr_b16 v[156:157], v42 offset:47104
    ds_read_b64_tr_b16 v[158:159], v42 offset:48128
    s_waitcnt lgkmcnt(12)
    v_mfma_f32_32x32x16_bf16 v[64:79], v[140:143], v[108:111], v[64:79]
    s_waitcnt lgkmcnt(9)
    v_mfma_f32_32x32x16_bf16 v[64:79], v[144:147], v[112:115], v[64:79]
    s_waitcnt lgkmcnt(6)
    v_mfma_f32_32x32x16_bf16 v[64:79], v[148:151], v[116:119], v[64:79]
    s_waitcnt lgkmcnt(3)
    v_mfma_f32_32x32x16_bf16 v[64:79], v[152:155], v[120:123], v[64:79]
    s_waitcnt lgkmcnt(0)
    v_mfma_f32_32x32x16_bf16 v[64:79], v[156:159], v[124:127], v[64:79]
    s_waitcnt vmcnt(24)
    s_barrier
    s_add_u32 m0, s53, 98304
    s_nop 0
    buffer_load_dwordx4 v8, s[8:11], s50 offen offset:0 lds
    buffer_load_dwordx4 v8, s[8:11], s50 offen offset:1024 lds
    buffer_load_dwordx4 v8, s[8:11], s50 offen offset:2048 lds
    buffer_load_dwordx4 v8, s[8:11], s50 offen offset:3072 lds
    s_add_u32 m0, s53, 114688
    s_nop 0
    buffer_load_dwordx4 v12, s[12:15], s51 offen lds
    s_add_u32 m0, s53, 115712
    s_nop 0
    buffer_load_dwordx4 v13, s[12:15], s51 offen lds
    s_add_u32 m0, s53, 116736
    s_nop 0
    buffer_load_dwordx4 v14, s[12:15], s51 offen lds
    s_add_u32 m0, s53, 117760
    s_nop 0
    buffer_load_dwordx4 v15, s[12:15], s51 offen lds
    s_add_u32 s50, s50, 8192
    s_add_u32 s51, s51, 0x20000
    ds_read_b128 v[96:99], v52 offset:0
    ds_read_b64_tr_b16 v[128:129], v60 offset:0
    ds_read_b64_tr_b16 v[130:131], v60 offset:1024
    ds_read_b128 v[100:103], v52 offset:1024
    ds_read_b64_tr_b16 v[132:133], v60 offset:2048
    ds_read_b64_tr_b16 v[134:135], v60 offset:3072
    ds_read_b128 v[104:107], v52 offset:2048
    ds_read_b64_tr_b16 v[136:137], v60 offset:4096
    ds_read_b64_tr_b16 v[138:139], v60 offset:5120
    ds_read_b128 v[108:111], v52 offset:3072
    ds_read_b64_tr_b16 v[140:141], v60 offset:6144
    ds_read_b64_tr_b16 v[142:143], v60 offset:7168
    ds_read_b128 v[112:115], v52 offset:4096
    ds_read_b64_tr_b16 v[144:145], v60 offset:8192
    ds_read_b64_tr_b16 v[146:147], v60 offset:9216
    s_waitcnt lgkmcnt(12)
    v_mfma_f32_32x32x16_bf16 v[64:79], v[128:131], v[96:99], v[64:79]
    ds_read_b128 v[116:119], v52 offset:5120
    ds_read_b64_tr_b16 v[148:149], v60 offset:10240
    ds_read_b64_tr_b16 v[150:151], v60 offset:11264
    s_waitcnt lgkmcnt(12)
    v_mfma_f32_32x32x16_bf16 v[64:79], v[132:135], v[100:103], v[64:79]
    ds_read_b128 v[120:123], v52 offset:6144
    ds_read_b64_tr_b16 v[152:153], v60 offset:12288
    ds_read_b64_tr_b16 v[154:155], v60 offset:13312
    s_waitcnt lgkmcnt(12)
    v_mfma_f32_32x32x16_bf16 v[64:79], v[136:139], v[104:107], v[64:79]
    ds_read_b128 v[124:127], v52 offset:7168
    ds_read_b64_tr_b16 v[156:157], v60 offset:14336
    ds_read_b64_tr_b16 v[158:159], v60 offset:15360
    s_waitcnt lgkmcnt(12)
    v_mfma_f32_32x32x16_bf16 v[64:79], v[140:143], v[108:111], v[64:79]
    s_waitcnt lgkmcnt(9)
    v_mfma_f32_32x32x16_bf16 v[64:79], v[144:147], v[112:115], v[64:79]
    s_waitcnt lgkmcnt(6)
    v_mfma_f32_32x32x16_bf16 v[64:79], v[148:151], v[116:119], v[64:79]
    s_waitcnt lgkmcnt(3)
    v_mfma_f32_32x32x16_bf16 v[64:79], v[152:155], v[120:123], v[64:79]
    s_waitcnt lgkmcnt(0)
    v_mfma_f32_32x32x16_bf16 v[64:79], v[156:159], v[124:127], v[64:79]
    s_waitcnt vmcnt(24)
    s_barrier
    s_add_u32 m0, s53, 131072
    s_nop 0
    buffer_load_dwordx4 v8, s[8:11], s50 offen offset:0 lds
    buffer_load_dwordx4 v8, s[8:11], s50 offen offset:1024 lds
    buffer_load_dwordx4 v8, s[8:11], s50 offen offset:2048 lds
    buffer_load_dwordx4 v8, s[8:11], s50 offen offset:3072 lds
    s_add_u32 m0, s53, 147456
    s_nop 0
    buffer_load_dwordx4 v12, s[12:15], s51 offen lds
    s_add_u32 m0, s53, 148480
    s_nop 0
    buffer_load_dwordx4 v13, s[12:15], s51 offen lds
    s_add_u32 m0, s53, 149504
    s_nop 0
    buffer_load_dwordx4 v14, s[12:15], s51 offen lds
    s_add_u32 m0, s53, 150528
    s_nop 0
    buffer_load_dwordx4 v15, s[12:15], s51 offen lds
    s_add_u32 s50, s50, 8192
    s_add_u32 s51, s51, 0x20000
    ds_read_b128 v[96:99], v16 offset:0
    ds_read_b64_tr_b16 v[128:129], v24 offset:0
    ds_read_b64_tr_b16 v[130:131], v24 offset:1024
    ds_read_b128 v[100:103], v16 offset:1024
    ds_read_b64_tr_b16 v[132:133], v24 offset:2048
    ds_read_b64_tr_b16 v[134:135], v24 offset:3072
    ds_read_b128 v[104:107], v16 offset:2048
    ds_read_b64_tr_b16 v[136:137], v24 offset:4096
    ds_read_b64_tr_b16 v[138:139], v24 offset:5120
    ds_read_b128 v[108:111], v16 offset:3072
    ds_read_b64_tr_b16 v[140:141], v24 offset:6144
    ds_read_b64_tr_b16 v[142:143], v24 offset:7168
    ds_read_b128 v[112:115], v16 offset:4096
    ds_read_b64_tr_b16 v[144:145], v24 offset:8192
    ds_read_b64_tr_b16 v[146:147], v24 offset:9216
    s_waitcnt lgkmcnt(12)
    v_mfma_f32_32x32x16_bf16 v[64:79], v[128:131], v[96:99], v[64:79]
    ds_read_b128 v[116:119], v16 offset:5120
    ds_read_b64_tr_b16 v[148:149], v24 offset:10240
    ds_read_b64_tr_b16 v[150:151], v24 offset:11264
    s_waitcnt lgkmcnt(12)
    v_mfma_f32_32x32x16_bf16 v[64:79], v[132:135], v[100:103], v[64:79]
    ds_read_b128 v[120:123], v16 offset:6144
    ds_read_b64_tr_b16 v[152:153], v24 offset:12288
    ds_read_b64_tr_b16 v[154:155], v24 offset:13312
    s_waitcnt lgkmcnt(12)
    v_mfma_f32_32x32x16_bf16 v[64:79], v[136:139], v[104:107], v[64:79]
    ds_read_b128 v[124:127], v16 offset:7168
    ds_read_b64_tr_b16 v[156:157], v24 offset:14336
    ds_read_b64_tr_b16 v[158:159], v24 offset:15360
    s_waitcnt lgkmcnt(12)
    v_mfma_f32_32x32x16_bf16 v[64:79], v[140:143], v[108:111], v[64:79]
    s_waitcnt lgkmcnt(9)
    v_mfma_f32_32x32x16_bf16 v[64:79], v[144:147], v[112:115], v[64:79]
    s_waitcnt lgkmcnt(6)
    v_mfma_f32_32x32x16_bf16 v[64:79], v[148:151], v[116:119], v[64:79]
    s_waitcnt lgkmcnt(3)
    v_mfma_f32_32x32x16_bf16 v[64:79], v[152:155], v[120:123], v[64:79]
    s_waitcnt lgkmcnt(0)
    v_mfma_f32_32x32x16_bf16 v[64:79], v[156:159], v[124:127], v[64:79]
    s_waitcnt vmcnt(24)
    s_barrier
    s_add_u32 m0, s53, 0
    s_nop 0
    buffer_load_dwordx4 v8, s[8:11], s50 offen offset:0 lds
    buffer_load_dwordx4 v8, s[8:11], s50 offen offset:1024 lds
    buffer_load_dwordx4 v8, s[8:11], s50 offen offset:2048 lds
    buffer_load_dwordx4 v8, s[8:11], s50 offen offset:3072 lds
    s_add_u32 m0, s53, 16384
    s_nop 0
    buffer_load_dwordx4 v12, s[12:15], s51 offen lds
    s_add_u32 m0, s53, 17408
    s_nop 0
    buffer_load_dwordx4 v13, s[12:15], s51 offen lds
    s_add_u32 m0, s53, 18432
    s_nop 0
    buffer_load_dwordx4 v14, s[12:15], s51 offen lds
    s_add_u32 m0, s53, 19456
    s_nop 0
    buffer_load_dwordx4 v15, s[12:15], s51 offen lds
    s_add_u32 s50, s50, 8192
    s_add_u32 s51, s51, 0x20000
    ds_read_b128 v[96:99], v16 offset:32768
    ds_read_b64_tr_b16 v[128:129], v24 offset:32768
    ds_read_b64_tr_b16 v[130:131], v24 offset:33792
    ds_read_b128 v[100:103], v16 offset:33792
    ds_read_b64_tr_b16 v[132:133], v24 offset:34816
    ds_read_b64_tr_b16 v[134:135], v24 offset:35840
    ds_read_b128 v[104:107], v16 offset:34816
    ds_read_b64_tr_b16 v[136:137], v24 offset:36864
    ds_read_b64_tr_b16 v[138:139], v24 offset:37888
    ds_read_b128 v[108:111], v16 offset:35840
    ds_read_b64_tr_b16 v[140:141], v24 offset:38912
    ds_read_b64_tr_b16 v[142:143], v24 offset:39936
    ds_read_b128 v[112:115], v16 offset:36864
    ds_read_b64_tr_b16 v[144:145], v24 offset:40960
    ds_read_b64_tr_b16 v[146:147], v24 offset:41984
    s_waitcnt lgkmcnt(12)
    v_mfma_f32_32x32x16_bf16 v[64:79], v[128:131], v[96:99], v[64:79]
    ds_read_b128 v[116:119], v16 offset:37888
    ds_read_b64_tr_b16 v[148:149], v24 offset:43008
    ds_read_b64_tr_b16 v[150:151], v24 offset:44032
    s_waitcnt lgkmcnt(12)
    v_mfma_f32_32x32x16_bf16 v[64:79], v[132:135], v[100:103], v[64:79]
    ds_read_b128 v[120:123], v16 offset:38912
    ds_read_b64_tr_b16 v[152:153], v24 offset:45056
    ds_read_b64_tr_b16 v[154:155], v24 offset:46080
    s_waitcnt lgkmcnt(12)
    v_mfma_f32_32x32x16_bf16 v[64:79], v[136:139], v[104:107], v[64:79]
    ds_read_b128 v[124:127], v16 offset:39936
    ds_read_b64_tr_b16 v[156:157], v24 offset:47104
    ds_read_b64_tr_b16 v[158:159], v24 offset:48128
    s_waitcnt lgkmcnt(12)
    v_mfma_f32_32x32x16_bf16 v[64:79], v[140:143], v[108:111], v[64:79]
    s_waitcnt lgkmcnt(9)
    v_mfma_f32_32x32x16_bf16 v[64:79], v[144:147], v[112:115], v[64:79]
    s_waitcnt lgkmcnt(6)
    v_mfma_f32_32x32x16_bf16 v[64:79], v[148:151], v[116:119], v[64:79]
    s_waitcnt lgkmcnt(3)
    v_mfma_f32_32x32x16_bf16 v[64:79], v[152:155], v[120:123], v[64:79]
    s_waitcnt lgkmcnt(0)
    v_mfma_f32_32x32x16_bf16 v[64:79], v[156:159], v[124:127], v[64:79]
    s_waitcnt vmcnt(24)
    s_barrier
    s_add_u32 m0, s53, 32768
    s_nop 0
    buffer_load_dwordx4 v8, s[8:11], s50 offen offset:0 lds
    buffer_load_dwordx4 v8, s[8:11], s50 offen offset:1024 lds
    buffer_load_dwordx4 v8, s[8:11], s50 offen offset:2048 lds
    buffer_load_dwordx4 v8, s[8:11], s50 offen offset:3072 lds
    s_add_u32 m0, s53, 49152
    s_nop 0
    buffer_load_dwordx4 v12, s[12:15], s51 offen lds
    s_add_u32 m0, s53, 50176
    s_nop 0
    buffer_load_dwordx4 v13, s[12:15], s51 offen lds
    s_add_u32 m0, s53, 51200
    s_nop 0
    buffer_load_dwordx4 v14, s[12:15], s51 offen lds
    s_add_u32 m0, s53, 52224
    s_nop 0
    buffer_load_dwordx4 v15, s[12:15], s51 offen lds
    s_add_u32 s50, s50, 8192
    s_add_u32 s51, s51, 0x20000
    ds_read_b128 v[96:99], v34 offset:0
    ds_read_b64_tr_b16 v[128:129], v42 offset:0
    ds_read_b64_tr_b16 v[130:131], v42 offset:1024
    ds_read_b128 v[100:103], v34 offset:1024
    ds_read_b64_tr_b16 v[132:133], v42 offset:2048
    ds_read_b64_tr_b16 v[134:135], v42 offset:3072
    ds_read_b128 v[104:107], v34 offset:2048
    ds_read_b64_tr_b16 v[136:137], v42 offset:4096
    ds_read_b64_tr_b16 v[138:139], v42 offset:5120
    ds_read_b128 v[108:111], v34 offset:3072
    ds_read_b64_tr_b16 v[140:141], v42 offset:6144
    ds_read_b64_tr_b16 v[142:143], v42 offset:7168
    ds_read_b128 v[112:115], v34 offset:4096
    ds_read_b64_tr_b16 v[144:145], v42 offset:8192
    ds_read_b64_tr_b16 v[146:147], v42 offset:9216
    s_waitcnt lgkmcnt(12)
    v_mfma_f32_32x32x16_bf16 v[64:79], v[128:131], v[96:99], v[64:79]
    ds_read_b128 v[116:119], v34 offset:5120
    ds_read_b64_tr_b16 v[148:149], v42 offset:10240
    ds_read_b64_tr_b16 v[150:151], v42 offset:11264
    s_waitcnt lgkmcnt(12)
    v_mfma_f32_32x32x16_bf16 v[64:79], v[132:135], v[100:103], v[64:79]
    ds_read_b128 v[120:123], v34 offset:6144
    ds_read_b64_tr_b16 v[152:153], v42 offset:12288
    ds_read_b64_tr_b16 v[154:155], v42 offset:13312
    s_waitcnt lgkmcnt(12)
    v_mfma_f32_32x32x16_bf16 v[64:79], v[136:139], v[104:107], v[64:79]
    ds_read_b128 v[124:127], v34 offset:7168
    ds_read_b64_tr_b16 v[156:157], v42 offset:14336
    ds_read_b64_tr_b16 v[158:159], v42 offset:15360
    s_waitcnt lgkmcnt(12)
    v_mfma_f32_32x32x16_bf16 v[64:79], v[140:143], v[108:111], v[64:79]
    s_waitcnt lgkmcnt(9)
    v_mfma_f32_32x32x16_bf16 v[64:79], v[144:147], v[112:115], v[64:79]
    s_waitcnt lgkmcnt(6)
    v_mfma_f32_32x32x16_bf16 v[64:79], v[148:151], v[116:119], v[64:79]
    s_waitcnt lgkmcnt(3)
    v_mfma_f32_32x32x16_bf16 v[64:79], v[152:155], v[120:123], v[64:79]
    s_waitcnt lgkmcnt(0)
    v_mfma_f32_32x32x16_bf16 v[64:79], v[156:159], v[124:127], v[64:79]
    s_waitcnt vmcnt(24)
    s_barrier
    s_add_u32 m0, s53, 65536
    s_nop 0
    buffer_load_dwordx4 v8, s[8:11], s50 offen offset:0 lds
    buffer_load_dwordx4 v8, s[8:11], s50 offen offset:1024 lds
    buffer_load_dwordx4 v8, s[8:11], s50 offen offset:2048 lds
    buffer_load_dwordx4 v8, s[8:11], s50 offen offset:3072 lds
    s_add_u32 m0, s53, 81920
    s_nop 0
    buffer_load_dwordx4 v12, s[12:15], s51 offen lds
    s_add_u32 m0, s53, 82944
    s_nop 0
    buffer_load_dwordx4 v13, s[12:15], s51 offen lds
    s_add_u32 m0, s53, 83968
    s_nop 0
    buffer_load_dwordx4 v14, s[12:15], s51 offen lds
    s_add_u32 m0, s53, 84992
    s_nop 0
    buffer_load_dwordx4 v15, s[12:15], s51 offen lds
    s_add_u32 s50, s50, 8192
    s_add_u32 s51, s51, 0x20000
    ds_read_b128 v[96:99], v34 offset:32768
    ds_read_b64_tr_b16 v[128:129], v42 offset:32768
    ds_read_b64_tr_b16 v[130:131], v42 offset:33792
    ds_read_b128 v[100:103], v34 offset:33792
    ds_read_b64_tr_b16 v[132:133], v42 offset:34816
    ds_read_b64_tr_b16 v[134:135], v42 offset:35840
    ds_read_b128 v[104:107], v34 offset:34816
    ds_read_b64_tr_b16 v[136:137], v42 offset:36864
    ds_read_b64_tr_b16 v[138:139], v42 offset:37888
    ds_read_b128 v[108:111], v34 offset:35840
    ds_read_b64_tr_b16 v[140:141], v42 offset:38912
    ds_read_b64_tr_b16 v[142:143], v42 offset:39936
    ds_read_b128 v[112:115], v34 offset:36864
    ds_read_b64_tr_b16 v[144:145], v42 offset:40960
    ds_read_b64_tr_b16 v[146:147], v42 offset:41984
    s_waitcnt lgkmcnt(12)
    v_mfma_f32_32x32x16_bf16 v[64:79], v[128:131], v[96:99], v[64:79]
    ds_read_b128 v[116:119], v34 offset:37888
    ds_read_b64_tr_b16 v[148:149], v42 offset:43008
    ds_read_b64_tr_b16 v[150:151], v42 offset:44032
    s_waitcnt lgkmcnt(12)
    v_mfma_f32_32x32x16_bf16 v[64:79], v[132:135], v[100:103], v[64:79]
    ds_read_b128 v[120:123], v34 offset:38912
    ds_read_b64_tr_b16 v[152:153], v42 offset:45056
    ds_read_b64_tr_b16 v[154:155], v42 offset:46080
    s_waitcnt lgkmcnt(12)
    v_mfma_f32_32x32x16_bf16 v[64:79], v[136:139], v[104:107], v[64:79]
    ds_read_b128 v[124:127], v34 offset:39936
    ds_read_b64_tr_b16 v[156:157], v42 offset:47104
    ds_read_b64_tr_b16 v[158:159], v42 offset:48128
    s_waitcnt lgkmcnt(12)
    v_mfma_f32_32x32x16_bf16 v[64:79], v[140:143], v[108:111], v[64:79]
    s_waitcnt lgkmcnt(9)
    v_mfma_f32_32x32x16_bf16 v[64:79], v[144:147], v[112:115], v[64:79]
    s_waitcnt lgkmcnt(6)
    v_mfma_f32_32x32x16_bf16 v[64:79], v[148:151], v[116:119], v[64:79]
    s_waitcnt lgkmcnt(3)
    v_mfma_f32_32x32x16_bf16 v[64:79], v[152:155], v[120:123], v[64:79]
    s_waitcnt lgkmcnt(0)
    v_mfma_f32_32x32x16_bf16 v[64:79], v[156:159], v[124:127], v[64:79]
    s_waitcnt vmcnt(24)
    s_barrier
    s_add_u32 m0, s53, 98304
    s_nop 0
    buffer_load_dwordx4 v8, s[8:11], s50 offen offset:0 lds
    buffer_load_dwordx4 v8, s[8:11], s50 offen offset:1024 lds
    buffer_load_dwordx4 v8, s[8:11], s50 offen offset:2048 lds
    buffer_load_dwordx4 v8, s[8:11], s50 offen offset:3072 lds
    s_add_u32 m0, s53, 114688
    s_nop 0
    buffer_load_dwordx4 v12, s[12:15], s51 offen lds
    s_add_u32 m0, s53, 115712
    s_nop 0
    buffer_load_dwordx4 v13, s[12:15], s51 offen lds
    s_add_u32 m0, s53, 116736
    s_nop 0
    buffer_load_dwordx4 v14, s[12:15], s51 offen lds
    s_add_u32 m0, s53, 117760
    s_nop 0
    buffer_load_dwordx4 v15, s[12:15], s51 offen lds
    s_add_u32 s50, s50, 8192
    s_add_u32 s51, s51, 0x20000
    ds_read_b128 v[96:99], v52 offset:0
    ds_read_b64_tr_b16 v[128:129], v60 offset:0
    ds_read_b64_tr_b16 v[130:131], v60 offset:1024
    ds_read_b128 v[100:103], v52 offset:1024
    ds_read_b64_tr_b16 v[132:133], v60 offset:2048
    ds_read_b64_tr_b16 v[134:135], v60 offset:3072
    ds_read_b128 v[104:107], v52 offset:2048
    ds_read_b64_tr_b16 v[136:137], v60 offset:4096
    ds_read_b64_tr_b16 v[138:139], v60 offset:5120
    ds_read_b128 v[108:111], v52 offset:3072
    ds_read_b64_tr_b16 v[140:141], v60 offset:6144
    ds_read_b64_tr_b16 v[142:143], v60 offset:7168
    ds_read_b128 v[112:115], v52 offset:4096
    ds_read_b64_tr_b16 v[144:145], v60 offset:8192
    ds_read_b64_tr_b16 v[146:147], v60 offset:9216
    s_waitcnt lgkmcnt(12)
    v_mfma_f32_32x32x16_bf16 v[64:79], v[128:131], v[96:99], v[64:79]
    ds_read_b128 v[116:119], v52 offset:5120
    ds_read_b64_tr_b16 v[148:149], v60 offset:10240
    ds_read_b64_tr_b16 v[150:151], v60 offset:11264
    s_waitcnt lgkmcnt(12)
    v_mfma_f32_32x32x16_bf16 v[64:79], v[132:135], v[100:103], v[64:79]
    ds_read_b128 v[120:123], v52 offset:6144
    ds_read_b64_tr_b16 v[152:153], v60 offset:12288
    ds_read_b64_tr_b16 v[154:155], v60 offset:13312
    s_waitcnt lgkmcnt(12)
    v_mfma_f32_32x32x16_bf16 v[64:79], v[136:139], v[104:107], v[64:79]
    ds_read_b128 v[124:127], v52 offset:7168
    ds_read_b64_tr_b16 v[156:157], v60 offset:14336
    ds_read_b64_tr_b16 v[158:159], v60 offset:15360
    s_waitcnt lgkmcnt(12)
    v_mfma_f32_32x32x16_bf16 v[64:79], v[140:143], v[108:111], v[64:79]
    s_waitcnt lgkmcnt(9)
    v_mfma_f32_32x32x16_bf16 v[64:79], v[144:147], v[112:115], v[64:79]
    s_waitcnt lgkmcnt(6)
    v_mfma_f32_32x32x16_bf16 v[64:79], v[148:151], v[116:119], v[64:79]
    s_waitcnt lgkmcnt(3)
    v_mfma_f32_32x32x16_bf16 v[64:79], v[152:155], v[120:123], v[64:79]
    s_waitcnt lgkmcnt(0)
    v_mfma_f32_32x32x16_bf16 v[64:79], v[156:159], v[124:127], v[64:79]
    s_waitcnt vmcnt(24)
    s_barrier
    s_add_u32 m0, s53, 131072
    s_nop 0
    buffer_load_dwordx4 v8, s[8:11], s50 offen offset:0 lds
    buffer_load_dwordx4 v8, s[8:11], s50 offen offset:1024 lds
    buffer_load_dwordx4 v8, s[8:11], s50 offen offset:2048 lds
    buffer_load_dwordx4 v8, s[8:11], s50 offen offset:3072 lds
    s_add_u32 m0, s53, 147456
    s_nop 0
    buffer_load_dwordx4 v12, s[12:15], s51 offen lds
    s_add_u32 m0, s53, 148480
    s_nop 0
    buffer_load_dwordx4 v13, s[12:15], s51 offen lds
    s_add_u32 m0, s53, 149504
    s_nop 0
    buffer_load_dwordx4 v14, s[12:15], s51 offen lds
    s_add_u32 m0, s53, 150528
    s_nop 0
    buffer_load_dwordx4 v15, s[12:15], s51 offen lds
    s_add_u32 s50, s50, 8192
    s_add_u32 s51, s51, 0x20000
    ds_read_b128 v[96:99], v16 offset:0
    ds_read_b64_tr_b16 v[128:129], v24 offset:0
    ds_read_b64_tr_b16 v[130:131], v24 offset:1024
    ds_read_b128 v[100:103], v16 offset:1024
    ds_read_b64_tr_b16 v[132:133], v24 offset:2048
    ds_read_b64_tr_b16 v[134:135], v24 offset:3072
    ds_read_b128 v[104:107], v16 offset:2048
    ds_read_b64_tr_b16 v[136:137], v24 offset:4096
    ds_read_b64_tr_b16 v[138:139], v24 offset:5120
    ds_read_b128 v[108:111], v16 offset:3072
    ds_read_b64_tr_b16 v[140:141], v24 offset:6144
    ds_read_b64_tr_b16 v[142:143], v24 offset:7168
    ds_read_b128 v[112:115], v16 offset:4096
    ds_read_b64_tr_b16 v[144:145], v24 offset:8192
    ds_read_b64_tr_b16 v[146:147], v24 offset:9216
    s_waitcnt lgkmcnt(12)
    v_mfma_f32_32x32x16_bf16 v[64:79], v[128:131], v[96:99], v[64:79]
    ds_read_b128 v[116:119], v16 offset:5120
    ds_read_b64_tr_b16 v[148:149], v24 offset:10240
    ds_read_b64_tr_b16 v[150:151], v24 offset:11264
    s_waitcnt lgkmcnt(12)
    v_mfma_f32_32x32x16_bf16 v[64:79], v[132:135], v[100:103], v[64:79]
    ds_read_b128 v[120:123], v16 offset:6144
    ds_read_b64_tr_b16 v[152:153], v24 offset:12288
    ds_read_b64_tr_b16 v[154:155], v24 offset:13312
    s_waitcnt lgkmcnt(12)
    v_mfma_f32_32x32x16_bf16 v[64:79], v[136:139], v[104:107], v[64:79]
    ds_read_b128 v[124:127], v16 offset:7168
    ds_read_b64_tr_b16 v[156:157], v24 offset:14336
    ds_read_b64_tr_b16 v[158:159], v24 offset:15360
    s_waitcnt lgkmcnt(12)
    v_mfma_f32_32x32x16_bf16 v[64:79], v[140:143], v[108:111], v[64:79]
    s_waitcnt lgkmcnt(9)
    v_mfma_f32_32x32x16_bf16 v[64:79], v[144:147], v[112:115], v[64:79]
    s_waitcnt lgkmcnt(6)
    v_mfma_f32_32x32x16_bf16 v[64:79], v[148:151], v[116:119], v[64:79]
    s_waitcnt lgkmcnt(3)
    v_mfma_f32_32x32x16_bf16 v[64:79], v[152:155], v[120:123], v[64:79]
    s_waitcnt lgkmcnt(0)
    v_mfma_f32_32x32x16_bf16 v[64:79], v[156:159], v[124:127], v[64:79]
    s_waitcnt vmcnt(24)
    s_barrier
    s_add_u32 m0, s53, 0
    s_nop 0
    buffer_load_dwordx4 v8, s[8:11], s50 offen offset:0 lds
    buffer_load_dwordx4 v8, s[8:11], s50 offen offset:1024 lds
    buffer_load_dwordx4 v8, s[8:11], s50 offen offset:2048 lds
    buffer_load_dwordx4 v8, s[8:11], s50 offen offset:3072 lds
    s_add_u32 m0, s53, 16384
    s_nop 0
    buffer_load_dwordx4 v12, s[12:15], s51 offen lds
    s_add_u32 m0, s53, 17408
    s_nop 0
    buffer_load_dwordx4 v13, s[12:15], s51 offen lds
    s_add_u32 m0, s53, 18432
    s_nop 0
    buffer_load_dwordx4 v14, s[12:15], s51 offen lds
    s_add_u32 m0, s53, 19456
    s_nop 0
    buffer_load_dwordx4 v15, s[12:15], s51 offen lds
    s_add_u32 s50, s50, 8192
    s_add_u32 s51, s51, 0x20000
    ds_read_b128 v[96:99], v16 offset:32768
    ds_read_b64_tr_b16 v[128:129], v24 offset:32768
    ds_read_b64_tr_b16 v[130:131], v24 offset:33792
    ds_read_b128 v[100:103], v16 offset:33792
    ds_read_b64_tr_b16 v[132:133], v24 offset:34816
    ds_read_b64_tr_b16 v[134:135], v24 offset:35840
    ds_read_b128 v[104:107], v16 offset:34816
    ds_read_b64_tr_b16 v[136:137], v24 offset:36864
    ds_read_b64_tr_b16 v[138:139], v24 offset:37888
    ds_read_b128 v[108:111], v16 offset:35840
    ds_read_b64_tr_b16 v[140:141], v24 offset:38912
    ds_read_b64_tr_b16 v[142:143], v24 offset:39936
    ds_read_b128 v[112:115], v16 offset:36864
    ds_read_b64_tr_b16 v[144:145], v24 offset:40960
    ds_read_b64_tr_b16 v[146:147], v24 offset:41984
    s_waitcnt lgkmcnt(12)
    v_mfma_f32_32x32x16_bf16 v[64:79], v[128:131], v[96:99], v[64:79]
    ds_read_b128 v[116:119], v16 offset:37888
    ds_read_b64_tr_b16 v[148:149], v24 offset:43008
    ds_read_b64_tr_b16 v[150:151], v24 offset:44032
    s_waitcnt lgkmcnt(12)
    v_mfma_f32_32x32x16_bf16 v[64:79], v[132:135], v[100:103], v[64:79]
    ds_read_b128 v[120:123], v16 offset:38912
    ds_read_b64_tr_b16 v[152:153], v24 offset:45056
    ds_read_b64_tr_b16 v[154:155], v24 offset:46080
    s_waitcnt lgkmcnt(12)
    v_mfma_f32_32x32x16_bf16 v[64:79], v[136:139], v[104:107], v[64:79]
    ds_read_b128 v[124:127], v16 offset:39936
    ds_read_b64_tr_b16 v[156:157], v24 offset:47104
    ds_read_b64_tr_b16 v[158:159], v24 offset:48128
    s_waitcnt lgkmcnt(12)
    v_mfma_f32_32x32x16_bf16 v[64:79], v[140:143], v[108:111], v[64:79]
    s_waitcnt lgkmcnt(9)
    v_mfma_f32_32x32x16_bf16 v[64:79], v[144:147], v[112:115], v[64:79]
    s_waitcnt lgkmcnt(6)
    v_mfma_f32_32x32x16_bf16 v[64:79], v[148:151], v[116:119], v[64:79]
    s_waitcnt lgkmcnt(3)
    v_mfma_f32_32x32x16_bf16 v[64:79], v[152:155], v[120:123], v[64:79]
    s_waitcnt lgkmcnt(0)
    v_mfma_f32_32x32x16_bf16 v[64:79], v[156:159], v[124:127], v[64:79]
    s_waitcnt vmcnt(24)
    s_barrier
    s_add_u32 m0, s53, 32768
    s_nop 0
    buffer_load_dwordx4 v8, s[8:11], s50 offen offset:0 lds
    buffer_load_dwordx4 v8, s[8:11], s50 offen offset:1024 lds
    buffer_load_dwordx4 v8, s[8:11], s50 offen offset:2048 lds
    buffer_load_dwordx4 v8, s[8:11], s50 offen offset:3072 lds
    s_add_u32 m0, s53, 49152
    s_nop 0
    buffer_load_dwordx4 v12, s[12:15], s51 offen lds
    s_add_u32 m0, s53, 50176
    s_nop 0
    buffer_load_dwordx4 v13, s[12:15], s51 offen lds
    s_add_u32 m0, s53, 51200
    s_nop 0
    buffer_load_dwordx4 v14, s[12:15], s51 offen lds
    s_add_u32 m0, s53, 52224
    s_nop 0
    buffer_load_dwordx4 v15, s[12:15], s51 offen lds
    s_add_u32 s50, s50, 8192
    s_add_u32 s51, s51, 0x20000
    ds_read_b128 v[96:99], v34 offset:0
    ds_read_b64_tr_b16 v[128:129], v42 offset:0
    ds_read_b64_tr_b16 v[130:131], v42 offset:1024
    ds_read_b128 v[100:103], v34 offset:1024
    ds_read_b64_tr_b16 v[132:133], v42 offset:2048
    ds_read_b64_tr_b16 v[134:135], v42 offset:3072
    ds_read_b128 v[104:107], v34 offset:2048
    ds_read_b64_tr_b16 v[136:137], v42 offset:4096
    ds_read_b64_tr_b16 v[138:139], v42 offset:5120
    ds_read_b128 v[108:111], v34 offset:3072
    ds_read_b64_tr_b16 v[140:141], v42 offset:6144
    ds_read_b64_tr_b16 v[142:143], v42 offset:7168
    ds_read_b128 v[112:115], v34 offset:4096
    ds_read_b64_tr_b16 v[144:145], v42 offset:8192
    ds_read_b64_tr_b16 v[146:147], v42 offset:9216
    s_waitcnt lgkmcnt(12)
    v_mfma_f32_32x32x16_bf16 v[64:79], v[128:131], v[96:99], v[64:79]
    ds_read_b128 v[116:119], v34 offset:5120
    ds_read_b64_tr_b16 v[148:149], v42 offset:10240
    ds_read_b64_tr_b16 v[150:151], v42 offset:11264
    s_waitcnt lgkmcnt(12)
    v_mfma_f32_32x32x16_bf16 v[64:79], v[132:135], v[100:103], v[64:79]
    ds_read_b128 v[120:123], v34 offset:6144
    ds_read_b64_tr_b16 v[152:153], v42 offset:12288
    ds_read_b64_tr_b16 v[154:155], v42 offset:13312
    s_waitcnt lgkmcnt(12)
    v_mfma_f32_32x32x16_bf16 v[64:79], v[136:139], v[104:107], v[64:79]
    ds_read_b128 v[124:127], v34 offset:7168
    ds_read_b64_tr_b16 v[156:157], v42 offset:14336
    ds_read_b64_tr_b16 v[158:159], v42 offset:15360
    s_waitcnt lgkmcnt(12)
    v_mfma_f32_32x32x16_bf16 v[64:79], v[140:143], v[108:111], v[64:79]
    s_waitcnt lgkmcnt(9)
    v_mfma_f32_32x32x16_bf16 v[64:79], v[144:147], v[112:115], v[64:79]
    s_waitcnt lgkmcnt(6)
    v_mfma_f32_32x32x16_bf16 v[64:79], v[148:151], v[116:119], v[64:79]
    s_waitcnt lgkmcnt(3)
    v_mfma_f32_32x32x16_bf16 v[64:79], v[152:155], v[120:123], v[64:79]
    s_waitcnt lgkmcnt(0)
    v_mfma_f32_32x32x16_bf16 v[64:79], v[156:159], v[124:127], v[64:79]
    s_waitcnt vmcnt(24)
    s_barrier
    s_add_u32 m0, s53, 65536
    s_nop 0
    buffer_load_dwordx4 v8, s[8:11], s50 offen offset:0 lds
    buffer_load_dwordx4 v8, s[8:11], s50 offen offset:1024 lds
    buffer_load_dwordx4 v8, s[8:11], s50 offen offset:2048 lds
    buffer_load_dwordx4 v8, s[8:11], s50 offen offset:3072 lds
    s_add_u32 m0, s53, 81920
    s_nop 0
    buffer_load_dwordx4 v12, s[12:15], s51 offen lds
    s_add_u32 m0, s53, 82944
    s_nop 0
    buffer_load_dwordx4 v13, s[12:15], s51 offen lds
    s_add_u32 m0, s53, 83968
    s_nop 0
    buffer_load_dwordx4 v14, s[12:15], s51 offen lds
    s_add_u32 m0, s53, 84992
    s_nop 0
    buffer_load_dwordx4 v15, s[12:15], s51 offen lds
    s_add_u32 s50, s50, 8192
    s_add_u32 s51, s51, 0x20000
    ds_read_b128 v[96:99], v34 offset:32768
    ds_read_b64_tr_b16 v[128:129], v42 offset:32768
    ds_read_b64_tr_b16 v[130:131], v42 offset:33792
    ds_read_b128 v[100:103], v34 offset:33792
    ds_read_b64_tr_b16 v[132:133], v42 offset:34816
    ds_read_b64_tr_b16 v[134:135], v42 offset:35840
    ds_read_b128 v[104:107], v34 offset:34816
    ds_read_b64_tr_b16 v[136:137], v42 offset:36864
    ds_read_b64_tr_b16 v[138:139], v42 offset:37888
    ds_read_b128 v[108:111], v34 offset:35840
    ds_read_b64_tr_b16 v[140:141], v42 offset:38912
    ds_read_b64_tr_b16 v[142:143], v42 offset:39936
    ds_read_b128 v[112:115], v34 offset:36864
    ds_read_b64_tr_b16 v[144:145], v42 offset:40960
    ds_read_b64_tr_b16 v[146:147], v42 offset:41984
    s_waitcnt lgkmcnt(12)
    v_mfma_f32_32x32x16_bf16 v[64:79], v[128:131], v[96:99], v[64:79]
    ds_read_b128 v[116:119], v34 offset:37888
    ds_read_b64_tr_b16 v[148:149], v42 offset:43008
    ds_read_b64_tr_b16 v[150:151], v42 offset:44032
    s_waitcnt lgkmcnt(12)
    v_mfma_f32_32x32x16_bf16 v[64:79], v[132:135], v[100:103], v[64:79]
    ds_read_b128 v[120:123], v34 offset:38912
    ds_read_b64_tr_b16 v[152:153], v42 offset:45056
    ds_read_b64_tr_b16 v[154:155], v42 offset:46080
    s_waitcnt lgkmcnt(12)
    v_mfma_f32_32x32x16_bf16 v[64:79], v[136:139], v[104:107], v[64:79]
    ds_read_b128 v[124:127], v34 offset:39936
    ds_read_b64_tr_b16 v[156:157], v42 offset:47104
    ds_read_b64_tr_b16 v[158:159], v42 offset:48128
    s_waitcnt lgkmcnt(12)
    v_mfma_f32_32x32x16_bf16 v[64:79], v[140:143], v[108:111], v[64:79]
    s_waitcnt lgkmcnt(9)
    v_mfma_f32_32x32x16_bf16 v[64:79], v[144:147], v[112:115], v[64:79]
    s_waitcnt lgkmcnt(6)
    v_mfma_f32_32x32x16_bf16 v[64:79], v[148:151], v[116:119], v[64:79]
    s_waitcnt lgkmcnt(3)
    v_mfma_f32_32x32x16_bf16 v[64:79], v[152:155], v[120:123], v[64:79]
    s_waitcnt lgkmcnt(0)
    v_mfma_f32_32x32x16_bf16 v[64:79], v[156:159], v[124:127], v[64:79]
    s_waitcnt vmcnt(24)
    s_barrier
    s_add_u32 m0, s53, 98304
    s_nop 0
    buffer_load_dwordx4 v8, s[8:11], s50 offen offset:0 lds
    buffer_load_dwordx4 v8, s[8:11], s50 offen offset:1024 lds
    buffer_load_dwordx4 v8, s[8:11], s50 offen offset:2048 lds
    buffer_load_dwordx4 v8, s[8:11], s50 offen offset:3072 lds
    s_add_u32 m0, s53, 114688
    s_nop 0
    buffer_load_dwordx4 v12, s[12:15], s51 offen lds
    s_add_u32 m0, s53, 115712
    s_nop 0
    buffer_load_dwordx4 v13, s[12:15], s51 offen lds
    s_add_u32 m0, s53, 116736
    s_nop 0
    buffer_load_dwordx4 v14, s[12:15], s51 offen lds
    s_add_u32 m0, s53, 117760
    s_nop 0
    buffer_load_dwordx4 v15, s[12:15], s51 offen lds
    s_add_u32 s50, s50, 8192
    s_add_u32 s51, s51, 0x20000
    ds_read_b128 v[96:99], v52 offset:0
    ds_read_b64_tr_b16 v[128:129], v60 offset:0
    ds_read_b64_tr_b16 v[130:131], v60 offset:1024
    ds_read_b128 v[100:103], v52 offset:1024
    ds_read_b64_tr_b16 v[132:133], v60 offset:2048
    ds_read_b64_tr_b16 v[134:135], v60 offset:3072
    ds_read_b128 v[104:107], v52 offset:2048
    ds_read_b64_tr_b16 v[136:137], v60 offset:4096
    ds_read_b64_tr_b16 v[138:139], v60 offset:5120
    ds_read_b128 v[108:111], v52 offset:3072
    ds_read_b64_tr_b16 v[140:141], v60 offset:6144
    ds_read_b64_tr_b16 v[142:143], v60 offset:7168
    ds_read_b128 v[112:115], v52 offset:4096
    ds_read_b64_tr_b16 v[144:145], v60 offset:8192
    ds_read_b64_tr_b16 v[146:147], v60 offset:9216
    s_waitcnt lgkmcnt(12)
    v_mfma_f32_32x32x16_bf16 v[64:79], v[128:131], v[96:99], v[64:79]
    ds_read_b128 v[116:119], v52 offset:5120
    ds_read_b64_tr_b16 v[148:149], v60 offset:10240
    ds_read_b64_tr_b16 v[150:151], v60 offset:11264
    s_waitcnt lgkmcnt(12)
    v_mfma_f32_32x32x16_bf16 v[64:79], v[132:135], v[100:103], v[64:79]
    ds_read_b128 v[120:123], v52 offset:6144
    ds_read_b64_tr_b16 v[152:153], v60 offset:12288
    ds_read_b64_tr_b16 v[154:155], v60 offset:13312
    s_waitcnt lgkmcnt(12)
    v_mfma_f32_32x32x16_bf16 v[64:79], v[136:139], v[104:107], v[64:79]
    ds_read_b128 v[124:127], v52 offset:7168
    ds_read_b64_tr_b16 v[156:157], v60 offset:14336
    ds_read_b64_tr_b16 v[158:159], v60 offset:15360
    s_waitcnt lgkmcnt(12)
    v_mfma_f32_32x32x16_bf16 v[64:79], v[140:143], v[108:111], v[64:79]
    s_waitcnt lgkmcnt(9)
    v_mfma_f32_32x32x16_bf16 v[64:79], v[144:147], v[112:115], v[64:79]
    s_waitcnt lgkmcnt(6)
    v_mfma_f32_32x32x16_bf16 v[64:79], v[148:151], v[116:119], v[64:79]
    s_waitcnt lgkmcnt(3)
    v_mfma_f32_32x32x16_bf16 v[64:79], v[152:155], v[120:123], v[64:79]
    s_waitcnt lgkmcnt(0)
    v_mfma_f32_32x32x16_bf16 v[64:79], v[156:159], v[124:127], v[64:79]
    s_waitcnt vmcnt(24)
    s_barrier
    s_add_u32 m0, s53, 131072
    s_nop 0
    buffer_load_dwordx4 v8, s[8:11], s50 offen offset:0 lds
    buffer_load_dwordx4 v8, s[8:11], s50 offen offset:1024 lds
    buffer_load_dwordx4 v8, s[8:11], s50 offen offset:2048 lds
    buffer_load_dwordx4 v8, s[8:11], s50 offen offset:3072 lds
    s_add_u32 m0, s53, 147456
    s_nop 0
    buffer_load_dwordx4 v12, s[12:15], s51 offen lds
    s_add_u32 m0, s53, 148480
    s_nop 0
    buffer_load_dwordx4 v13, s[12:15], s51 offen lds
    s_add_u32 m0, s53, 149504
    s_nop 0
    buffer_load_dwordx4 v14, s[12:15], s51 offen lds
    s_add_u32 m0, s53, 150528
    s_nop 0
    buffer_load_dwordx4 v15, s[12:15], s51 offen lds
    s_add_u32 s50, s50, 8192
    s_add_u32 s51, s51, 0x20000
    ds_read_b128 v[96:99], v16 offset:0
    ds_read_b64_tr_b16 v[128:129], v24 offset:0
    ds_read_b64_tr_b16 v[130:131], v24 offset:1024
    ds_read_b128 v[100:103], v16 offset:1024
    ds_read_b64_tr_b16 v[132:133], v24 offset:2048
    ds_read_b64_tr_b16 v[134:135], v24 offset:3072
    ds_read_b128 v[104:107], v16 offset:2048
    ds_read_b64_tr_b16 v[136:137], v24 offset:4096
    ds_read_b64_tr_b16 v[138:139], v24 offset:5120
    ds_read_b128 v[108:111], v16 offset:3072
    ds_read_b64_tr_b16 v[140:141], v24 offset:6144
    ds_read_b64_tr_b16 v[142:143], v24 offset:7168
    ds_read_b128 v[112:115], v16 offset:4096
    ds_read_b64_tr_b16 v[144:145], v24 offset:8192
    ds_read_b64_tr_b16 v[146:147], v24 offset:9216
    s_waitcnt lgkmcnt(12)
    v_mfma_f32_32x32x16_bf16 v[64:79], v[128:131], v[96:99], v[64:79]
    ds_read_b128 v[116:119], v16 offset:5120
    ds_read_b64_tr_b16 v[148:149], v24 offset:10240
    ds_read_b64_tr_b16 v[150:151], v24 offset:11264
    s_waitcnt lgkmcnt(12)
    v_mfma_f32_32x32x16_bf16 v[64:79], v[132:135], v[100:103], v[64:79]
    ds_read_b128 v[120:123], v16 offset:6144
    ds_read_b64_tr_b16 v[152:153], v24 offset:12288
    ds_read_b64_tr_b16 v[154:155], v24 offset:13312
    s_waitcnt lgkmcnt(12)
    v_mfma_f32_32x32x16_bf16 v[64:79], v[136:139], v[104:107], v[64:79]
    ds_read_b128 v[124:127], v16 offset:7168
    ds_read_b64_tr_b16 v[156:157], v24 offset:14336
    ds_read_b64_tr_b16 v[158:159], v24 offset:15360
    s_waitcnt lgkmcnt(12)
    v_mfma_f32_32x32x16_bf16 v[64:79], v[140:143], v[108:111], v[64:79]
    s_waitcnt lgkmcnt(9)
    v_mfma_f32_32x32x16_bf16 v[64:79], v[144:147], v[112:115], v[64:79]
    s_waitcnt lgkmcnt(6)
    v_mfma_f32_32x32x16_bf16 v[64:79], v[148:151], v[116:119], v[64:79]
    s_waitcnt lgkmcnt(3)
    v_mfma_f32_32x32x16_bf16 v[64:79], v[152:155], v[120:123], v[64:79]
    s_waitcnt lgkmcnt(0)
    v_mfma_f32_32x32x16_bf16 v[64:79], v[156:159], v[124:127], v[64:79]
    s_waitcnt vmcnt(24)
    s_barrier
    s_add_u32 m0, s53, 0
    s_nop 0
    buffer_load_dwordx4 v8, s[8:11], s50 offen offset:0 lds
    buffer_load_dwordx4 v8, s[8:11], s50 offen offset:1024 lds
    buffer_load_dwordx4 v8, s[8:11], s50 offen offset:2048 lds
    buffer_load_dwordx4 v8, s[8:11], s50 offen offset:3072 lds
    s_add_u32 m0, s53, 16384
    s_nop 0
    buffer_load_dwordx4 v12, s[12:15], s51 offen lds
    s_add_u32 m0, s53, 17408
    s_nop 0
    buffer_load_dwordx4 v13, s[12:15], s51 offen lds
    s_add_u32 m0, s53, 18432
    s_nop 0
    buffer_load_dwordx4 v14, s[12:15], s51 offen lds
    s_add_u32 m0, s53, 19456
    s_nop 0
    buffer_load_dwordx4 v15, s[12:15], s51 offen lds
    s_add_u32 s50, s50, 8192
    s_add_u32 s51, s51, 0x20000
    ds_read_b128 v[96:99], v16 offset:32768
    ds_read_b64_tr_b16 v[128:129], v24 offset:32768
    ds_read_b64_tr_b16 v[130:131], v24 offset:33792
    ds_read_b128 v[100:103], v16 offset:33792
    ds_read_b64_tr_b16 v[132:133], v24 offset:34816
    ds_read_b64_tr_b16 v[134:135], v24 offset:35840
    ds_read_b128 v[104:107], v16 offset:34816
    ds_read_b64_tr_b16 v[136:137], v24 offset:36864
    ds_read_b64_tr_b16 v[138:139], v24 offset:37888
    ds_read_b128 v[108:111], v16 offset:35840
    ds_read_b64_tr_b16 v[140:141], v24 offset:38912
    ds_read_b64_tr_b16 v[142:143], v24 offset:39936
    ds_read_b128 v[112:115], v16 offset:36864
    ds_read_b64_tr_b16 v[144:145], v24 offset:40960
    ds_read_b64_tr_b16 v[146:147], v24 offset:41984
    s_waitcnt lgkmcnt(12)
    v_mfma_f32_32x32x16_bf16 v[64:79], v[128:131], v[96:99], v[64:79]
    ds_read_b128 v[116:119], v16 offset:37888
    ds_read_b64_tr_b16 v[148:149], v24 offset:43008
    ds_read_b64_tr_b16 v[150:151], v24 offset:44032
    s_waitcnt lgkmcnt(12)
    v_mfma_f32_32x32x16_bf16 v[64:79], v[132:135], v[100:103], v[64:79]
    ds_read_b128 v[120:123], v16 offset:38912
    ds_read_b64_tr_b16 v[152:153], v24 offset:45056
    ds_read_b64_tr_b16 v[154:155], v24 offset:46080
    s_waitcnt lgkmcnt(12)
    v_mfma_f32_32x32x16_bf16 v[64:79], v[136:139], v[104:107], v[64:79]
    ds_read_b128 v[124:127], v16 offset:39936
    ds_read_b64_tr_b16 v[156:157], v24 offset:47104
    ds_read_b64_tr_b16 v[158:159], v24 offset:48128
    s_waitcnt lgkmcnt(12)
    v_mfma_f32_32x32x16_bf16 v[64:79], v[140:143], v[108:111], v[64:79]
    s_waitcnt lgkmcnt(9)
    v_mfma_f32_32x32x16_bf16 v[64:79], v[144:147], v[112:115], v[64:79]
    s_waitcnt lgkmcnt(6)
    v_mfma_f32_32x32x16_bf16 v[64:79], v[148:151], v[116:119], v[64:79]
    s_waitcnt lgkmcnt(3)
    v_mfma_f32_32x32x16_bf16 v[64:79], v[152:155], v[120:123], v[64:79]
    s_waitcnt lgkmcnt(0)
    v_mfma_f32_32x32x16_bf16 v[64:79], v[156:159], v[124:127], v[64:79]
    s_waitcnt vmcnt(24)
    s_barrier
    s_add_u32 m0, s53, 32768
    s_nop 0
    buffer_load_dwordx4 v8, s[8:11], s50 offen offset:0 lds
    buffer_load_dwordx4 v8, s[8:11], s50 offen offset:1024 lds
    buffer_load_dwordx4 v8, s[8:11], s50 offen offset:2048 lds
    buffer_load_dwordx4 v8, s[8:11], s50 offen offset:3072 lds
    s_add_u32 m0, s53, 49152
    s_nop 0
    buffer_load_dwordx4 v12, s[12:15], s51 offen lds
    s_add_u32 m0, s53, 50176
    s_nop 0
    buffer_load_dwordx4 v13, s[12:15], s51 offen lds
    s_add_u32 m0, s53, 51200
    s_nop 0
    buffer_load_dwordx4 v14, s[12:15], s51 offen lds
    s_add_u32 m0, s53, 52224
    s_nop 0
    buffer_load_dwordx4 v15, s[12:15], s51 offen lds
    s_add_u32 s50, s50, 8192
    s_add_u32 s51, s51, 0x20000
    ds_read_b128 v[96:99], v34 offset:0
    ds_read_b64_tr_b16 v[128:129], v42 offset:0
    ds_read_b64_tr_b16 v[130:131], v42 offset:1024
    ds_read_b128 v[100:103], v34 offset:1024
    ds_read_b64_tr_b16 v[132:133], v42 offset:2048
    ds_read_b64_tr_b16 v[134:135], v42 offset:3072
    ds_read_b128 v[104:107], v34 offset:2048
    ds_read_b64_tr_b16 v[136:137], v42 offset:4096
    ds_read_b64_tr_b16 v[138:139], v42 offset:5120
    ds_read_b128 v[108:111], v34 offset:3072
    ds_read_b64_tr_b16 v[140:141], v42 offset:6144
    ds_read_b64_tr_b16 v[142:143], v42 offset:7168
    ds_read_b128 v[112:115], v34 offset:4096
    ds_read_b64_tr_b16 v[144:145], v42 offset:8192
    ds_read_b64_tr_b16 v[146:147], v42 offset:9216
    s_waitcnt lgkmcnt(12)
    v_mfma_f32_32x32x16_bf16 v[64:79], v[128:131], v[96:99], v[64:79]
    ds_read_b128 v[116:119], v34 offset:5120
    ds_read_b64_tr_b16 v[148:149], v42 offset:10240
    ds_read_b64_tr_b16 v[150:151], v42 offset:11264
    s_waitcnt lgkmcnt(12)
    v_mfma_f32_32x32x16_bf16 v[64:79], v[132:135], v[100:103], v[64:79]
    ds_read_b128 v[120:123], v34 offset:6144
    ds_read_b64_tr_b16 v[152:153], v42 offset:12288
    ds_read_b64_tr_b16 v[154:155], v42 offset:13312
    s_waitcnt lgkmcnt(12)
    v_mfma_f32_32x32x16_bf16 v[64:79], v[136:139], v[104:107], v[64:79]
    ds_read_b128 v[124:127], v34 offset:7168
    ds_read_b64_tr_b16 v[156:157], v42 offset:14336
    ds_read_b64_tr_b16 v[158:159], v42 offset:15360
    s_waitcnt lgkmcnt(12)
    v_mfma_f32_32x32x16_bf16 v[64:79], v[140:143], v[108:111], v[64:79]
    s_waitcnt lgkmcnt(9)
    v_mfma_f32_32x32x16_bf16 v[64:79], v[144:147], v[112:115], v[64:79]
    s_waitcnt lgkmcnt(6)
    v_mfma_f32_32x32x16_bf16 v[64:79], v[148:151], v[116:119], v[64:79]
    s_waitcnt lgkmcnt(3)
    v_mfma_f32_32x32x16_bf16 v[64:79], v[152:155], v[120:123], v[64:79]
    s_waitcnt lgkmcnt(0)
    v_mfma_f32_32x32x16_bf16 v[64:79], v[156:159], v[124:127], v[64:79]
    s_waitcnt vmcnt(24)
    s_barrier
    s_mov_b32 s51, 0
    s_add_u32 m0, s53, 65536
    s_nop 0
    buffer_load_dwordx4 v8, s[8:11], s50 offen offset:0 lds
    buffer_load_dwordx4 v8, s[8:11], s50 offen offset:1024 lds
    buffer_load_dwordx4 v8, s[8:11], s50 offen offset:2048 lds
    buffer_load_dwordx4 v8, s[8:11], s50 offen offset:3072 lds
    s_add_u32 m0, s53, 81920
    s_nop 0
    buffer_load_dwordx4 v12, s[16:19], s51 offen lds
    s_add_u32 m0, s53, 82944
    s_nop 0
    buffer_load_dwordx4 v13, s[16:19], s51 offen lds
    s_add_u32 m0, s53, 83968
    s_nop 0
    buffer_load_dwordx4 v14, s[16:19], s51 offen lds
    s_add_u32 m0, s53, 84992
    s_nop 0
    buffer_load_dwordx4 v15, s[16:19], s51 offen lds
    s_add_u32 s50, s50, 8192
    s_add_u32 s51, s51, 0x20000
    ds_read_b128 v[96:99], v34 offset:32768
    ds_read_b64_tr_b16 v[128:129], v42 offset:32768
    ds_read_b64_tr_b16 v[130:131], v42 offset:33792
    ds_read_b128 v[100:103], v34 offset:33792
    ds_read_b64_tr_b16 v[132:133], v42 offset:34816
    ds_read_b64_tr_b16 v[134:135], v42 offset:35840
    ds_read_b128 v[104:107], v34 offset:34816
    ds_read_b64_tr_b16 v[136:137], v42 offset:36864
    ds_read_b64_tr_b16 v[138:139], v42 offset:37888
    ds_read_b128 v[108:111], v34 offset:35840
    ds_read_b64_tr_b16 v[140:141], v42 offset:38912
    ds_read_b64_tr_b16 v[142:143], v42 offset:39936
    ds_read_b128 v[112:115], v34 offset:36864
    ds_read_b64_tr_b16 v[144:145], v42 offset:40960
    ds_read_b64_tr_b16 v[146:147], v42 offset:41984
    s_waitcnt lgkmcnt(12)
    v_mfma_f32_32x32x16_bf16 v[64:79], v[128:131], v[96:99], v[64:79]
    ds_read_b128 v[116:119], v34 offset:37888
    ds_read_b64_tr_b16 v[148:149], v42 offset:43008
    ds_read_b64_tr_b16 v[150:151], v42 offset:44032
    s_waitcnt lgkmcnt(12)
    v_mfma_f32_32x32x16_bf16 v[64:79], v[132:135], v[100:103], v[64:79]
    ds_read_b128 v[120:123], v34 offset:38912
    ds_read_b64_tr_b16 v[152:153], v42 offset:45056
    ds_read_b64_tr_b16 v[154:155], v42 offset:46080
    s_waitcnt lgkmcnt(12)
    v_mfma_f32_32x32x16_bf16 v[64:79], v[136:139], v[104:107], v[64:79]
    ds_read_b128 v[124:127], v34 offset:39936
    ds_read_b64_tr_b16 v[156:157], v42 offset:47104
    ds_read_b64_tr_b16 v[158:159], v42 offset:48128
    s_waitcnt lgkmcnt(12)
    v_mfma_f32_32x32x16_bf16 v[64:79], v[140:143], v[108:111], v[64:79]
    s_waitcnt lgkmcnt(9)
    v_mfma_f32_32x32x16_bf16 v[64:79], v[144:147], v[112:115], v[64:79]
    s_waitcnt lgkmcnt(6)
    v_mfma_f32_32x32x16_bf16 v[64:79], v[148:151], v[116:119], v[64:79]
    s_waitcnt lgkmcnt(3)
    v_mfma_f32_32x32x16_bf16 v[64:79], v[152:155], v[120:123], v[64:79]
    s_waitcnt lgkmcnt(0)
    v_mfma_f32_32x32x16_bf16 v[64:79], v[156:159], v[124:127], v[64:79]
    s_waitcnt vmcnt(24)
    s_barrier
    s_add_u32 m0, s53, 98304
    s_nop 0
    buffer_load_dwordx4 v8, s[8:11], s50 offen offset:0 lds
    buffer_load_dwordx4 v8, s[8:11], s50 offen offset:1024 lds
    buffer_load_dwordx4 v8, s[8:11], s50 offen offset:2048 lds
    buffer_load_dwordx4 v8, s[8:11], s50 offen offset:3072 lds
    s_add_u32 m0, s53, 114688
    s_nop 0
    buffer_load_dwordx4 v12, s[16:19], s51 offen lds
    s_add_u32 m0, s53, 115712
    s_nop 0
    buffer_load_dwordx4 v13, s[16:19], s51 offen lds
    s_add_u32 m0, s53, 116736
    s_nop 0
    buffer_load_dwordx4 v14, s[16:19], s51 offen lds
    s_add_u32 m0, s53, 117760
    s_nop 0
    buffer_load_dwordx4 v15, s[16:19], s51 offen lds
    s_add_u32 s50, s50, 8192
    s_add_u32 s51, s51, 0x20000
    ds_read_b128 v[96:99], v52 offset:0
    ds_read_b64_tr_b16 v[128:129], v60 offset:0
    ds_read_b64_tr_b16 v[130:131], v60 offset:1024
    ds_read_b128 v[100:103], v52 offset:1024
    ds_read_b64_tr_b16 v[132:133], v60 offset:2048
    ds_read_b64_tr_b16 v[134:135], v60 offset:3072
    ds_read_b128 v[104:107], v52 offset:2048
    ds_read_b64_tr_b16 v[136:137], v60 offset:4096
    ds_read_b64_tr_b16 v[138:139], v60 offset:5120
    ds_read_b128 v[108:111], v52 offset:3072
    ds_read_b64_tr_b16 v[140:141], v60 offset:6144
    ds_read_b64_tr_b16 v[142:143], v60 offset:7168
    ds_read_b128 v[112:115], v52 offset:4096
    ds_read_b64_tr_b16 v[144:145], v60 offset:8192
    ds_read_b64_tr_b16 v[146:147], v60 offset:9216
    s_waitcnt lgkmcnt(12)
    v_mfma_f32_32x32x16_bf16 v[64:79], v[128:131], v[96:99], v[64:79]
    ds_read_b128 v[116:119], v52 offset:5120
    ds_read_b64_tr_b16 v[148:149], v60 offset:10240
    ds_read_b64_tr_b16 v[150:151], v60 offset:11264
    s_waitcnt lgkmcnt(12)
    v_mfma_f32_32x32x16_bf16 v[64:79], v[132:135], v[100:103], v[64:79]
    ds_read_b128 v[120:123], v52 offset:6144
    ds_read_b64_tr_b16 v[152:153], v60 offset:12288
    ds_read_b64_tr_b16 v[154:155], v60 offset:13312
    s_waitcnt lgkmcnt(12)
    v_mfma_f32_32x32x16_bf16 v[64:79], v[136:139], v[104:107], v[64:79]
    ds_read_b128 v[124:127], v52 offset:7168
    ds_read_b64_tr_b16 v[156:157], v60 offset:14336
    ds_read_b64_tr_b16 v[158:159], v60 offset:15360
    s_waitcnt lgkmcnt(12)
    v_mfma_f32_32x32x16_bf16 v[64:79], v[140:143], v[108:111], v[64:79]
    s_waitcnt lgkmcnt(9)
    v_mfma_f32_32x32x16_bf16 v[64:79], v[144:147], v[112:115], v[64:79]
    s_waitcnt lgkmcnt(6)
    v_mfma_f32_32x32x16_bf16 v[64:79], v[148:151], v[116:119], v[64:79]
    s_waitcnt lgkmcnt(3)
    v_mfma_f32_32x32x16_bf16 v[64:79], v[152:155], v[120:123], v[64:79]
    s_waitcnt lgkmcnt(0)
    v_mfma_f32_32x32x16_bf16 v[64:79], v[156:159], v[124:127], v[64:79]
    s_waitcnt vmcnt(24)
    s_barrier
    s_add_u32 m0, s53, 131072
    s_nop 0
    buffer_load_dwordx4 v8, s[8:11], s50 offen offset:0 lds
    buffer_load_dwordx4 v8, s[8:11], s50 offen offset:1024 lds
    buffer_load_dwordx4 v8, s[8:11], s50 offen offset:2048 lds
    buffer_load_dwordx4 v8, s[8:11], s50 offen offset:3072 lds
    s_add_u32 m0, s53, 147456
    s_nop 0
    buffer_load_dwordx4 v12, s[16:19], s51 offen lds
    s_add_u32 m0, s53, 148480
    s_nop 0
    buffer_load_dwordx4 v13, s[16:19], s51 offen lds
    s_add_u32 m0, s53, 149504
    s_nop 0
    buffer_load_dwordx4 v14, s[16:19], s51 offen lds
    s_add_u32 m0, s53, 150528
    s_nop 0
    buffer_load_dwordx4 v15, s[16:19], s51 offen lds
    s_add_u32 s50, s50, 8192
    s_add_u32 s51, s51, 0x20000
    ds_read_b128 v[96:99], v16 offset:0
    ds_read_b64_tr_b16 v[128:129], v24 offset:0
    ds_read_b64_tr_b16 v[130:131], v24 offset:1024
    ds_read_b128 v[100:103], v16 offset:1024
    ds_read_b64_tr_b16 v[132:133], v24 offset:2048
    ds_read_b64_tr_b16 v[134:135], v24 offset:3072
    ds_read_b128 v[104:107], v16 offset:2048
    ds_read_b64_tr_b16 v[136:137], v24 offset:4096
    ds_read_b64_tr_b16 v[138:139], v24 offset:5120
    ds_read_b128 v[108:111], v16 offset:3072
    ds_read_b64_tr_b16 v[140:141], v24 offset:6144
    ds_read_b64_tr_b16 v[142:143], v24 offset:7168
    ds_read_b128 v[112:115], v16 offset:4096
    ds_read_b64_tr_b16 v[144:145], v24 offset:8192
    ds_read_b64_tr_b16 v[146:147], v24 offset:9216
    s_waitcnt lgkmcnt(12)
    v_mfma_f32_32x32x16_bf16 v[64:79], v[128:131], v[96:99], v[64:79]
    ds_read_b128 v[116:119], v16 offset:5120
    ds_read_b64_tr_b16 v[148:149], v24 offset:10240
    ds_read_b64_tr_b16 v[150:151], v24 offset:11264
    s_waitcnt lgkmcnt(12)
    v_mfma_f32_32x32x16_bf16 v[64:79], v[132:135], v[100:103], v[64:79]
    ds_read_b128 v[120:123], v16 offset:6144
    ds_read_b64_tr_b16 v[152:153], v24 offset:12288
    ds_read_b64_tr_b16 v[154:155], v24 offset:13312
    s_waitcnt lgkmcnt(12)
    v_mfma_f32_32x32x16_bf16 v[64:79], v[136:139], v[104:107], v[64:79]
    ds_read_b128 v[124:127], v16 offset:7168
    ds_read_b64_tr_b16 v[156:157], v24 offset:14336
    ds_read_b64_tr_b16 v[158:159], v24 offset:15360
    s_waitcnt lgkmcnt(12)
    v_mfma_f32_32x32x16_bf16 v[64:79], v[140:143], v[108:111], v[64:79]
    s_waitcnt lgkmcnt(9)
    v_mfma_f32_32x32x16_bf16 v[64:79], v[144:147], v[112:115], v[64:79]
    s_waitcnt lgkmcnt(6)
    v_mfma_f32_32x32x16_bf16 v[64:79], v[148:151], v[116:119], v[64:79]
    s_waitcnt lgkmcnt(3)
    v_mfma_f32_32x32x16_bf16 v[64:79], v[152:155], v[120:123], v[64:79]
    s_waitcnt lgkmcnt(0)
    v_mfma_f32_32x32x16_bf16 v[64:79], v[156:159], v[124:127], v[64:79]
    s_waitcnt vmcnt(24)
    s_barrier
    s_add_u32 m0, s53, 0
    s_nop 0
    buffer_load_dwordx4 v8, s[8:11], s50 offen offset:0 lds
    buffer_load_dwordx4 v8, s[8:11], s50 offen offset:1024 lds
    buffer_load_dwordx4 v8, s[8:11], s50 offen offset:2048 lds
    buffer_load_dwordx4 v8, s[8:11], s50 offen offset:3072 lds
    s_add_u32 m0, s53, 16384
    s_nop 0
    buffer_load_dwordx4 v12, s[16:19], s51 offen lds
    s_add_u32 m0, s53, 17408
    s_nop 0
    buffer_load_dwordx4 v13, s[16:19], s51 offen lds
    s_add_u32 m0, s53, 18432
    s_nop 0
    buffer_load_dwordx4 v14, s[16:19], s51 offen lds
    s_add_u32 m0, s53, 19456
    s_nop 0
    buffer_load_dwordx4 v15, s[16:19], s51 offen lds
    s_add_u32 s50, s50, 8192
    s_add_u32 s51, s51, 0x20000
    ds_read_b128 v[96:99], v16 offset:32768
    ds_read_b64_tr_b16 v[128:129], v24 offset:32768
    ds_read_b64_tr_b16 v[130:131], v24 offset:33792
    ds_read_b128 v[100:103], v16 offset:33792
    ds_read_b64_tr_b16 v[132:133], v24 offset:34816
    ds_read_b64_tr_b16 v[134:135], v24 offset:35840
    ds_read_b128 v[104:107], v16 offset:34816
    ds_read_b64_tr_b16 v[136:137], v24 offset:36864
    ds_read_b64_tr_b16 v[138:139], v24 offset:37888
    ds_read_b128 v[108:111], v16 offset:35840
    ds_read_b64_tr_b16 v[140:141], v24 offset:38912
    ds_read_b64_tr_b16 v[142:143], v24 offset:39936
    ds_read_b128 v[112:115], v16 offset:36864
    ds_read_b64_tr_b16 v[144:145], v24 offset:40960
    ds_read_b64_tr_b16 v[146:147], v24 offset:41984
    s_waitcnt lgkmcnt(12)
    v_mfma_f32_32x32x16_bf16 v[64:79], v[128:131], v[96:99], v[64:79]
    ds_read_b128 v[116:119], v16 offset:37888
    ds_read_b64_tr_b16 v[148:149], v24 offset:43008
    ds_read_b64_tr_b16 v[150:151], v24 offset:44032
    s_waitcnt lgkmcnt(12)
    v_mfma_f32_32x32x16_bf16 v[64:79], v[132:135], v[100:103], v[64:79]
    ds_read_b128 v[120:123], v16 offset:38912
    ds_read_b64_tr_b16 v[152:153], v24 offset:45056
    ds_read_b64_tr_b16 v[154:155], v24 offset:46080
    s_waitcnt lgkmcnt(12)
    v_mfma_f32_32x32x16_bf16 v[64:79], v[136:139], v[104:107], v[64:79]
    ds_read_b128 v[124:127], v16 offset:39936
    ds_read_b64_tr_b16 v[156:157], v24 offset:47104
    ds_read_b64_tr_b16 v[158:159], v24 offset:48128
    s_waitcnt lgkmcnt(12)
    v_mfma_f32_32x32x16_bf16 v[64:79], v[140:143], v[108:111], v[64:79]
    s_waitcnt lgkmcnt(9)
    v_mfma_f32_32x32x16_bf16 v[64:79], v[144:147], v[112:115], v[64:79]
    s_waitcnt lgkmcnt(6)
    v_mfma_f32_32x32x16_bf16 v[64:79], v[148:151], v[116:119], v[64:79]
    s_waitcnt lgkmcnt(3)
    v_mfma_f32_32x32x16_bf16 v[64:79], v[152:155], v[120:123], v[64:79]
    s_waitcnt lgkmcnt(0)
    v_mfma_f32_32x32x16_bf16 v[64:79], v[156:159], v[124:127], v[64:79]
    s_waitcnt vmcnt(24)
    s_barrier
    ds_read_b128 v[96:99], v34 offset:0
    ds_read_b64_tr_b16 v[128:129], v43 offset:0
    ds_read_b64_tr_b16 v[130:131], v43 offset:512
    ds_read_b128 v[100:103], v34 offset:1024
    ds_read_b64_tr_b16 v[132:133], v43 offset:2048
    ds_read_b64_tr_b16 v[134:135], v43 offset:2560
    ds_read_b128 v[104:107], v34 offset:2048
    ds_read_b64_tr_b16 v[136:137], v43 offset:4096
    ds_read_b64_tr_b16 v[138:139], v43 offset:4608
    ds_read_b128 v[108:111], v34 offset:3072
    ds_read_b64_tr_b16 v[140:141], v43 offset:6144
    ds_read_b64_tr_b16 v[142:143], v43 offset:6656
    ds_read_b128 v[112:115], v34 offset:4096
    ds_read_b64_tr_b16 v[144:145], v43 offset:8192
    ds_read_b64_tr_b16 v[146:147], v43 offset:8704
    s_waitcnt lgkmcnt(12)
    v_mfma_f32_32x32x16_bf16 v[80:95], v[128:131], v[96:99], 0
    ds_read_b128 v[116:119], v34 offset:5120
    ds_read_b64_tr_b16 v[148:149], v43 offset:10240
    ds_read_b64_tr_b16 v[150:151], v43 offset:10752
    s_waitcnt lgkmcnt(12)
    v_mfma_f32_32x32x16_bf16 v[80:95], v[132:135], v[100:103], v[80:95]
    ds_read_b128 v[120:123], v34 offset:6144
    ds_read_b64_tr_b16 v[152:153], v43 offset:12288
    ds_read_b64_tr_b16 v[154:155], v43 offset:12800
    s_waitcnt lgkmcnt(12)
    v_mfma_f32_32x32x16_bf16 v[80:95], v[136:139], v[104:107], v[80:95]
    ds_read_b128 v[124:127], v34 offset:7168
    ds_read_b64_tr_b16 v[156:157], v43 offset:14336
    ds_read_b64_tr_b16 v[158:159], v43 offset:14848
    s_waitcnt lgkmcnt(12)
    v_mfma_f32_32x32x16_bf16 v[80:95], v[140:143], v[108:111], v[80:95]
    s_waitcnt lgkmcnt(9)
    v_mfma_f32_32x32x16_bf16 v[80:95], v[144:147], v[112:115], v[80:95]
    s_waitcnt lgkmcnt(6)
    v_mfma_f32_32x32x16_bf16 v[80:95], v[148:151], v[116:119], v[80:95]
    s_waitcnt lgkmcnt(3)
    v_mfma_f32_32x32x16_bf16 v[80:95], v[152:155], v[120:123], v[80:95]
    s_waitcnt lgkmcnt(0)
    v_mfma_f32_32x32x16_bf16 v[80:95], v[156:159], v[124:127], v[80:95]
    s_waitcnt vmcnt(16)
    s_barrier
    ds_read_b128 v[96:99], v34 offset:32768
    ds_read_b64_tr_b16 v[128:129], v43 offset:32768
    ds_read_b64_tr_b16 v[130:131], v43 offset:33280
    ds_read_b128 v[100:103], v34 offset:33792
    ds_read_b64_tr_b16 v[132:133], v43 offset:34816
    ds_read_b64_tr_b16 v[134:135], v43 offset:35328
    ds_read_b128 v[104:107], v34 offset:34816
    ds_read_b64_tr_b16 v[136:137], v43 offset:36864
    ds_read_b64_tr_b16 v[138:139], v43 offset:37376
    ds_read_b128 v[108:111], v34 offset:35840
    ds_read_b64_tr_b16 v[140:141], v43 offset:38912
    ds_read_b64_tr_b16 v[142:143], v43 offset:39424
    ds_read_b128 v[112:115], v34 offset:36864
    ds_read_b64_tr_b16 v[144:145], v43 offset:40960
    ds_read_b64_tr_b16 v[146:147], v43 offset:41472
    s_waitcnt lgkmcnt(12)
    v_mfma_f32_32x32x16_bf16 v[80:95], v[128:131], v[96:99], v[80:95]
    ds_read_b128 v[116:119], v34 offset:37888
    ds_read_b64_tr_b16 v[148:149], v43 offset:43008
    ds_read_b64_tr_b16 v[150:151], v43 offset:43520
    s_waitcnt lgkmcnt(12)
    v_mfma_f32_32x32x16_bf16 v[80:95], v[132:135], v[100:103], v[80:95]
    ds_read_b128 v[120:123], v34 offset:38912
    ds_read_b64_tr_b16 v[152:153], v43 offset:45056
    ds_read_b64_tr_b16 v[154:155], v43 offset:45568
    s_waitcnt lgkmcnt(12)
    v_mfma_f32_32x32x16_bf16 v[80:95], v[136:139], v[104:107], v[80:95]
    ds_read_b128 v[124:127], v34 offset:39936
    ds_read_b64_tr_b16 v[156:157], v43 offset:47104
    ds_read_b64_tr_b16 v[158:159], v43 offset:47616
    s_waitcnt lgkmcnt(12)
    v_mfma_f32_32x32x16_bf16 v[80:95], v[140:143], v[108:111], v[80:95]
    s_waitcnt lgkmcnt(9)
    v_mfma_f32_32x32x16_bf16 v[80:95], v[144:147], v[112:115], v[80:95]
    s_waitcnt lgkmcnt(6)
    v_mfma_f32_32x32x16_bf16 v[80:95], v[148:151], v[116:119], v[80:95]
    s_waitcnt lgkmcnt(3)
    v_mfma_f32_32x32x16_bf16 v[80:95], v[152:155], v[120:123], v[80:95]
    s_waitcnt lgkmcnt(0)
    v_mfma_f32_32x32x16_bf16 v[80:95], v[156:159], v[124:127], v[80:95]
    s_waitcnt vmcnt(8)
    s_barrier
    ds_read_b128 v[96:99], v52 offset:0
    ds_read_b64_tr_b16 v[128:129], v61 offset:0
    ds_read_b64_tr_b16 v[130:131], v61 offset:512
    ds_read_b128 v[100:103], v52 offset:1024
    ds_read_b64_tr_b16 v[132:133], v61 offset:2048
    ds_read_b64_tr_b16 v[134:135], v61 offset:2560
    ds_read_b128 v[104:107], v52 offset:2048
    ds_read_b64_tr_b16 v[136:137], v61 offset:4096
    ds_read_b64_tr_b16 v[138:139], v61 offset:4608
    ds_read_b128 v[108:111], v52 offset:3072
    ds_read_b64_tr_b16 v[140:141], v61 offset:6144
    ds_read_b64_tr_b16 v[142:143], v61 offset:6656
    ds_read_b128 v[112:115], v52 offset:4096
    ds_read_b64_tr_b16 v[144:145], v61 offset:8192
    ds_read_b64_tr_b16 v[146:147], v61 offset:8704
    s_waitcnt lgkmcnt(12)
    v_mfma_f32_32x32x16_bf16 v[80:95], v[128:131], v[96:99], v[80:95]
    ds_read_b128 v[116:119], v52 offset:5120
    ds_read_b64_tr_b16 v[148:149], v61 offset:10240
    ds_read_b64_tr_b16 v[150:151], v61 offset:10752
    s_waitcnt lgkmcnt(12)
    v_mfma_f32_32x32x16_bf16 v[80:95], v[132:135], v[100:103], v[80:95]
    ds_read_b128 v[120:123], v52 offset:6144
    ds_read_b64_tr_b16 v[152:153], v61 offset:12288
    ds_read_b64_tr_b16 v[154:155], v61 offset:12800
    s_waitcnt lgkmcnt(12)
    v_mfma_f32_32x32x16_bf16 v[80:95], v[136:139], v[104:107], v[80:95]
    ds_read_b128 v[124:127], v52 offset:7168
    ds_read_b64_tr_b16 v[156:157], v61 offset:14336
    ds_read_b64_tr_b16 v[158:159], v61 offset:14848
    s_waitcnt lgkmcnt(12)
    v_mfma_f32_32x32x16_bf16 v[80:95], v[140:143], v[108:111], v[80:95]
    s_waitcnt lgkmcnt(9)
    v_mfma_f32_32x32x16_bf16 v[80:95], v[144:147], v[112:115], v[80:95]
    s_waitcnt lgkmcnt(6)
    v_mfma_f32_32x32x16_bf16 v[80:95], v[148:151], v[116:119], v[80:95]
    s_waitcnt lgkmcnt(3)
    v_mfma_f32_32x32x16_bf16 v[80:95], v[152:155], v[120:123], v[80:95]
    s_waitcnt lgkmcnt(0)
    v_mfma_f32_32x32x16_bf16 v[80:95], v[156:159], v[124:127], v[80:95]
    s_waitcnt vmcnt(0)
    s_barrier
    ds_read_b128 v[96:99], v16 offset:0
    ds_read_b64_tr_b16 v[128:129], v25 offset:0
    ds_read_b64_tr_b16 v[130:131], v25 offset:512
    ds_read_b128 v[100:103], v16 offset:1024
    ds_read_b64_tr_b16 v[132:133], v25 offset:2048
    ds_read_b64_tr_b16 v[134:135], v25 offset:2560
    ds_read_b128 v[104:107], v16 offset:2048
    ds_read_b64_tr_b16 v[136:137], v25 offset:4096
    ds_read_b64_tr_b16 v[138:139], v25 offset:4608
    ds_read_b128 v[108:111], v16 offset:3072
    ds_read_b64_tr_b16 v[140:141], v25 offset:6144
    ds_read_b64_tr_b16 v[142:143], v25 offset:6656
    ds_read_b128 v[112:115], v16 offset:4096
    ds_read_b64_tr_b16 v[144:145], v25 offset:8192
    ds_read_b64_tr_b16 v[146:147], v25 offset:8704
    s_waitcnt lgkmcnt(12)
    v_mfma_f32_32x32x16_bf16 v[80:95], v[128:131], v[96:99], v[80:95]
    ds_read_b128 v[116:119], v16 offset:5120
    ds_read_b64_tr_b16 v[148:149], v25 offset:10240
    ds_read_b64_tr_b16 v[150:151], v25 offset:10752
    s_waitcnt lgkmcnt(12)
    v_mfma_f32_32x32x16_bf16 v[80:95], v[132:135], v[100:103], v[80:95]
    ds_read_b128 v[120:123], v16 offset:6144
    ds_read_b64_tr_b16 v[152:153], v25 offset:12288
    ds_read_b64_tr_b16 v[154:155], v25 offset:12800
    s_waitcnt lgkmcnt(12)
    v_mfma_f32_32x32x16_bf16 v[80:95], v[136:139], v[104:107], v[80:95]
    ds_read_b128 v[124:127], v16 offset:7168
    ds_read_b64_tr_b16 v[156:157], v25 offset:14336
    ds_read_b64_tr_b16 v[158:159], v25 offset:14848
    s_waitcnt lgkmcnt(12)
    v_mfma_f32_32x32x16_bf16 v[80:95], v[140:143], v[108:111], v[80:95]
    s_waitcnt lgkmcnt(9)
    v_mfma_f32_32x32x16_bf16 v[80:95], v[144:147], v[112:115], v[80:95]
    s_waitcnt lgkmcnt(6)
    v_mfma_f32_32x32x16_bf16 v[80:95], v[148:151], v[116:119], v[80:95]
    s_waitcnt lgkmcnt(3)
    v_mfma_f32_32x32x16_bf16 v[80:95], v[152:155], v[120:123], v[80:95]
    s_waitcnt lgkmcnt(0)
    v_mfma_f32_32x32x16_bf16 v[80:95], v[156:159], v[124:127], v[80:95]
    s_lshl_b32 s46, s41, 6
    s_lshl_b32 s47, s48, 5
    s_add_u32 s46, s46, s47
    v_add_u32 v5, s46, v3
    v_mov_b32 v7, v62
    v_lshlrev_b32 v5, 10, v5
    v_lshl_add_u32 v5, v4, 3, v5
    s_lshl_b32 s46, s40, 7
    s_lshl_b32 s47, s49, 6
    s_add_u32 s46, s46, s47
    v_add_u32 v5, s46, v5
    s_nop 7
    s_waitcnt vmcnt(0)
    v_sub_f32 v6, 1.0, v7
    v_cvt_pk_bf16_f32 v6, v6, v6
    v_and_b32 v6, 0xffff0000, v6

    v_cvt_pk_bf16_f32 v8, v64, v65
    v_lshlrev_b32 v64, 16, v8
    v_and_b32 v65, 0xffff0000, v8
    v_cvt_pk_bf16_f32 v8, v80, v81
    v_lshlrev_b32 v80, 16, v8
    v_and_b32 v81, 0xffff0000, v8
    v_mul_f32 v64, v7, v64
    v_mul_f32 v80, v6, v80
    v_mul_f32 v65, v7, v65
    v_mul_f32 v81, v6, v81
    v_cvt_pk_bf16_f32 v8, v64, v65
    v_lshlrev_b32 v64, 16, v8
    v_and_b32 v65, 0xffff0000, v8
    v_cvt_pk_bf16_f32 v8, v80, v81
    v_lshlrev_b32 v80, 16, v8
    v_and_b32 v81, 0xffff0000, v8
    v_add_f32 v64, v64, v80
    v_add_f32 v65, v65, v81
    v_cvt_pk_bf16_f32 v96, v64, v65
    v_cvt_pk_bf16_f32 v8, v66, v67
    v_lshlrev_b32 v66, 16, v8
    v_and_b32 v67, 0xffff0000, v8
    v_cvt_pk_bf16_f32 v8, v82, v83
    v_lshlrev_b32 v82, 16, v8
    v_and_b32 v83, 0xffff0000, v8
    v_mul_f32 v66, v7, v66
    v_mul_f32 v82, v6, v82
    v_mul_f32 v67, v7, v67
    v_mul_f32 v83, v6, v83
    v_cvt_pk_bf16_f32 v8, v66, v67
    v_lshlrev_b32 v66, 16, v8
    v_and_b32 v67, 0xffff0000, v8
    v_cvt_pk_bf16_f32 v8, v82, v83
    v_lshlrev_b32 v82, 16, v8
    v_and_b32 v83, 0xffff0000, v8
    v_add_f32 v66, v66, v82
    v_add_f32 v67, v67, v83
    v_cvt_pk_bf16_f32 v97, v66, v67
    v_cvt_pk_bf16_f32 v8, v68, v69
    v_lshlrev_b32 v68, 16, v8
    v_and_b32 v69, 0xffff0000, v8
    v_cvt_pk_bf16_f32 v8, v84, v85
    v_lshlrev_b32 v84, 16, v8
    v_and_b32 v85, 0xffff0000, v8
    v_mul_f32 v68, v7, v68
    v_mul_f32 v84, v6, v84
    v_mul_f32 v69, v7, v69
    v_mul_f32 v85, v6, v85
    v_cvt_pk_bf16_f32 v8, v68, v69
    v_lshlrev_b32 v68, 16, v8
    v_and_b32 v69, 0xffff0000, v8
    v_cvt_pk_bf16_f32 v8, v84, v85
    v_lshlrev_b32 v84, 16, v8
    v_and_b32 v85, 0xffff0000, v8
    v_add_f32 v68, v68, v84
    v_add_f32 v69, v69, v85
    v_cvt_pk_bf16_f32 v98, v68, v69
    v_cvt_pk_bf16_f32 v8, v70, v71
    v_lshlrev_b32 v70, 16, v8
    v_and_b32 v71, 0xffff0000, v8
    v_cvt_pk_bf16_f32 v8, v86, v87
    v_lshlrev_b32 v86, 16, v8
    v_and_b32 v87, 0xffff0000, v8
    v_mul_f32 v70, v7, v70
    v_mul_f32 v86, v6, v86
    v_mul_f32 v71, v7, v71
    v_mul_f32 v87, v6, v87
    v_cvt_pk_bf16_f32 v8, v70, v71
    v_lshlrev_b32 v70, 16, v8
    v_and_b32 v71, 0xffff0000, v8
    v_cvt_pk_bf16_f32 v8, v86, v87
    v_lshlrev_b32 v86, 16, v8
    v_and_b32 v87, 0xffff0000, v8
    v_add_f32 v70, v70, v86
    v_add_f32 v71, v71, v87
    v_cvt_pk_bf16_f32 v99, v70, v71
    v_cvt_pk_bf16_f32 v8, v72, v73
    v_lshlrev_b32 v72, 16, v8
    v_and_b32 v73, 0xffff0000, v8
    v_cvt_pk_bf16_f32 v8, v88, v89
    v_lshlrev_b32 v88, 16, v8
    v_and_b32 v89, 0xffff0000, v8
    v_mul_f32 v72, v7, v72
    v_mul_f32 v88, v6, v88
    v_mul_f32 v73, v7, v73
    v_mul_f32 v89, v6, v89
    v_cvt_pk_bf16_f32 v8, v72, v73
    v_lshlrev_b32 v72, 16, v8
    v_and_b32 v73, 0xffff0000, v8
    v_cvt_pk_bf16_f32 v8, v88, v89
    v_lshlrev_b32 v88, 16, v8
    v_and_b32 v89, 0xffff0000, v8
    v_add_f32 v72, v72, v88
    v_add_f32 v73, v73, v89
    v_cvt_pk_bf16_f32 v100, v72, v73
    v_cvt_pk_bf16_f32 v8, v74, v75
    v_lshlrev_b32 v74, 16, v8
    v_and_b32 v75, 0xffff0000, v8
    v_cvt_pk_bf16_f32 v8, v90, v91
    v_lshlrev_b32 v90, 16, v8
    v_and_b32 v91, 0xffff0000, v8
    v_mul_f32 v74, v7, v74
    v_mul_f32 v90, v6, v90
    v_mul_f32 v75, v7, v75
    v_mul_f32 v91, v6, v91
    v_cvt_pk_bf16_f32 v8, v74, v75
    v_lshlrev_b32 v74, 16, v8
    v_and_b32 v75, 0xffff0000, v8
    v_cvt_pk_bf16_f32 v8, v90, v91
    v_lshlrev_b32 v90, 16, v8
    v_and_b32 v91, 0xffff0000, v8
    v_add_f32 v74, v74, v90
    v_add_f32 v75, v75, v91
    v_cvt_pk_bf16_f32 v101, v74, v75
    v_cvt_pk_bf16_f32 v8, v76, v77
    v_lshlrev_b32 v76, 16, v8
    v_and_b32 v77, 0xffff0000, v8
    v_cvt_pk_bf16_f32 v8, v92, v93
    v_lshlrev_b32 v92, 16, v8
    v_and_b32 v93, 0xffff0000, v8
    v_mul_f32 v76, v7, v76
    v_mul_f32 v92, v6, v92
    v_mul_f32 v77, v7, v77
    v_mul_f32 v93, v6, v93
    v_cvt_pk_bf16_f32 v8, v76, v77
    v_lshlrev_b32 v76, 16, v8
    v_and_b32 v77, 0xffff0000, v8
    v_cvt_pk_bf16_f32 v8, v92, v93
    v_lshlrev_b32 v92, 16, v8
    v_and_b32 v93, 0xffff0000, v8
    v_add_f32 v76, v76, v92
    v_add_f32 v77, v77, v93
    v_cvt_pk_bf16_f32 v102, v76, v77
    v_cvt_pk_bf16_f32 v8, v78, v79
    v_lshlrev_b32 v78, 16, v8
    v_and_b32 v79, 0xffff0000, v8
    v_cvt_pk_bf16_f32 v8, v94, v95
    v_lshlrev_b32 v94, 16, v8
    v_and_b32 v95, 0xffff0000, v8
    v_mul_f32 v78, v7, v78
    v_mul_f32 v94, v6, v94
    v_mul_f32 v79, v7, v79
    v_mul_f32 v95, v6, v95
    v_cvt_pk_bf16_f32 v8, v78, v79
    v_lshlrev_b32 v78, 16, v8
    v_and_b32 v79, 0xffff0000, v8
    v_cvt_pk_bf16_f32 v8, v94, v95
    v_lshlrev_b32 v94, 16, v8
    v_and_b32 v95, 0xffff0000, v8
    v_add_f32 v78, v78, v94
    v_add_f32 v79, v79, v95
    v_cvt_pk_bf16_f32 v103, v78, v79
    buffer_store_dwordx2 v[96:97], v5, s[20:23], 0 offen offset:0
    buffer_store_dwordx2 v[98:99], v5, s[20:23], 0 offen offset:16
    buffer_store_dwordx2 v[100:101], v5, s[20:23], 0 offen offset:32
    buffer_store_dwordx2 v[102:103], v5, s[20:23], 0 offen offset:48
L_k4_end:
    s_endpgm
.section .rodata,"a"
.p2align 6
.amdhsa_kernel proj_kernel
  .amdhsa_next_free_vgpr 256
  .amdhsa_next_free_sgpr 102
  .amdhsa_accum_offset 256
  .amdhsa_group_segment_fixed_size 0
  .amdhsa_kernarg_size 112
  .amdhsa_user_sgpr_count 2
  .amdhsa_user_sgpr_kernarg_segment_ptr 1
  .amdhsa_system_sgpr_workgroup_id_x 1
.end_amdhsa_kernel
.p2align 6
.amdhsa_kernel attn_kernel
  .amdhsa_next_free_vgpr 248
  .amdhsa_next_free_sgpr 102
  .amdhsa_accum_offset 248
  .amdhsa_group_segment_fixed_size 0
  .amdhsa_kernarg_size 112
  .amdhsa_user_sgpr_count 2
  .amdhsa_user_sgpr_kernarg_segment_ptr 1
  .amdhsa_system_sgpr_workgroup_id_x 1
.end_amdhsa_kernel
.p2align 6
.amdhsa_kernel oproj_kernel
  .amdhsa_next_free_vgpr 160
  .amdhsa_next_free_sgpr 102
  .amdhsa_accum_offset 160
  .amdhsa_group_segment_fixed_size 0
  .amdhsa_kernarg_size 112
  .amdhsa_user_sgpr_count 2
  .amdhsa_user_sgpr_kernarg_segment_ptr 1
  .amdhsa_system_sgpr_workgroup_id_x 1
.end_amdhsa_kernel
```
